```python
import torch

def _softmax(x, axis=-1):
    return torch.softmax(x, dim=axis)
def _gelu(x):
    return torch.nn.functional.gelu(x, approximate="tanh")
def _silu(x):
    return torch.nn.functional.silu(x)
def _sigmoid(x):
    return torch.sigmoid(x)
def _layernorm(x, axis=-1, eps=1e-5):
    m = x.mean(dim=axis, keepdim=True)
    v = x.var(dim=axis, keepdim=True, unbiased=False)
    return (x - m) / torch.sqrt(v + eps)
def _scatter_add(tgt, idx, src, axis=0):
    return tgt.clone().index_add_(axis, idx, src)
def _segment_sum(src, seg, n):
    out = torch.zeros((n,) + src.shape[1:], dtype=src.dtype)
    return out.index_add_(0, seg, src)
def _pad(x, pw):
    flat = tuple(v for pair in reversed(pw) for v in pair)
    return torch.nn.functional.pad(x, flat)

kernel_name = 'gated_mix__grouped_kv_mqa__mixer_token_mlp__prompt'

def setup_inputs():

    _w = (lambda a: (lambda t: t.to(torch.bfloat16) if t.is_floating_point() else t)(torch.as_tensor(a)))
    def _A_setup():
        B, S, D, H = 1, 2048, 640, 32
        Dh = D // H
        return {
            "x": _w((lambda *s: torch.randn(*s, dtype=torch.bfloat16) * 0.05)(B, S, D)),
            "wq": _w((lambda *s: torch.randn(*s, dtype=torch.bfloat16) * 0.8)(D, H * Dh)),
            "wk": _w((lambda *s: torch.randn(*s, dtype=torch.bfloat16) * 0.8)(D, Dh)),
            "wv": _w((lambda *s: torch.randn(*s, dtype=torch.bfloat16) * 0.05)(D, Dh)),
            "wo": _w((lambda *s: torch.randn(*s, dtype=torch.bfloat16) * 0.05)(H * Dh, D)),
        }
    _A_in = _A_setup()

    def _B_setup():
        B, S, D, F = 1, 2048, 640, 1728
        return {
            "x": _w((lambda *s: torch.randn(*s, dtype=torch.bfloat16) * 0.05)(B, S, D)),
            "w1": _w((lambda *s: torch.randn(*s, dtype=torch.bfloat16) * 0.2)(S, F) * (S ** -0.5)),
            "b1": _w((lambda *s: torch.randn(*s, dtype=torch.bfloat16) * 3.2)(F) * 0.02),
            "w2": _w((lambda *s: torch.randn(*s, dtype=torch.bfloat16) * 0.05)(F, S) * (F ** -0.5)),
            "b2": _w((lambda *s: torch.randn(*s, dtype=torch.bfloat16) * 0.1)(S) * 0.02),
        }
    _B_in = _B_setup()

    return {
        "A_x": _A_in["x"],
        "A_wq": _A_in["wq"],
        "A_wk": _A_in["wk"],
        "A_wv": _A_in["wv"],
        "A_wo": _A_in["wo"],
        "B_x": _B_in["x"],
        "B_w1": _B_in["w1"],
        "B_b1": _B_in["b1"],
        "B_w2": _B_in["w2"],
        "B_b2": _B_in["b2"],
        "gate_w": _w((lambda *s: torch.randn(*s, dtype=torch.bfloat16) * 0.05)(640) * 16.0),
    }

def reference(A_x, A_wq, A_wk, A_wv, A_wo, B_x, B_w1, B_b1, B_w2, B_b2, gate_w):
    def _A_ref(x, wq, wk, wv, wo):
        B, S, D = x.shape
        H = 32
        Dh = D // H
        q = (lambda x, *d: x.permute(*d))((x @ wq).reshape(B, S, H, Dh), 0, 2, 1, 3)
        k = x @ wk
        v = x @ wv
        scores = torch.einsum("bhqd,bkd->bhqk", q, k) * (Dh ** -0.5)
        p = _softmax(scores, axis=-1)
        o = torch.einsum("bhqk,bkd->bhqd", p, v)
        return (lambda x, *d: x.permute(*d))(o, 0, 2, 1, 3).reshape(B, S, H * Dh) @ wo

    def _B_ref(x, w1, b1, w2, b2):
        B, S, D = x.shape
        h = _layernorm(x, axis=-1)
        u = torch.einsum("bsd,sf->bdf", h, w1) + b1
        u = _gelu(u)
        y = torch.einsum("bdf,fs->bds", u, w2) + b2
        return (lambda x, *d: x.permute(*d))(y, 0, 2, 1)

    x = A_x
    g = _sigmoid((x * gate_w).sum(-1, keepdims=True))
    a = _A_ref(x, A_wq, A_wk, A_wv, A_wo)
    b = _B_ref(x, B_w1, B_b1, B_w2, B_b2)
    return g * a + (1 - g) * b
```

```asm
; @launch grid=(256,1,1) block=(512,1,1) lds=163840
.amdgcn_target "amdgcn-amd-amdhsa--gfx950"
.text
.globl gated_mix__grouped_kv_mqa__mixer_token_mlp__prompt_kernel
.p2align 8
.type gated_mix__grouped_kv_mqa__mixer_token_mlp__prompt_kernel,@function
gated_mix__grouped_kv_mqa__mixer_token_mlp__prompt_kernel:
    s_cmp_ge_u32 s2, 256
    s_cbranch_scc1 L_end
    v_and_b32 v1, 63, v0
    v_lshlrev_b32 v1, 2, v1
    v_add_u32 v1, 161792, v1
    v_mov_b32 v2, 0
    ds_write_b32 v1, v2
    s_waitcnt lgkmcnt(0)
    s_load_dwordx16 s[4:19], s[0:1], 0
    s_load_dwordx8 s[20:27], s[0:1], 64
    s_load_dwordx4 s[28:31], s[0:1], 96
    s_getpc_b64 s[92:93]
L_pc:
    s_lshr_b32 s36, s2, 3
    s_mul_i32 s36, s36, 1792
    v_min_u32 v1, 13, v0
    v_lshl_add_u32 v1, v1, 7, s36
    v_min_u32 v1, L_end-L_pc, v1
    v_cmp_gt_u32 vcc, 64, v0
    s_and_saveexec_b64 s[94:95], vcc
    s_cbranch_execz L_nocpf
    global_load_dword v43, v1, s[92:93]
L_nocpf:
    s_mov_b64 exec, -1
    v_lshrrev_b32 v1, 6, v0
    v_and_b32 v0, 63, v0
    v_readfirstlane_b32 s32, v1
    s_and_b32 s35, s2, 7
    s_lshl_b32 s33, s35, 2
    s_bfe_u32 s36, s2, 0x20003
    s_add_u32 s33, s33, s36
    s_lshr_b32 s34, s2, 5
    s_sub_u32 s37, s32, 4
    s_barrier
    s_cmp_lt_u32 s32, 4
    s_cbranch_scc1 L_q
    s_setprio 3
    s_lshl_b32 s35, s33, 6
    s_lshr_b32 s36, s34, 1
    s_lshl_b32 s36, s36, 4
    s_add_u32 s64, s35, s36
    s_lshl_b32 s36, s37, 1
    v_lshrrev_b32 v54, 5, v0
    v_lshl_add_u32 v54, v54, 3, s36
    v_bfe_u32 v55, v0, 4, 1
    v_add_u32 v54, v54, v55
    v_and_b32 v55, 15, v0
    v_xor_b32 v55, v55, v54
    v_mul_u32_u24 v54, 1280, v54
    v_lshl_add_u32 v54, v55, 4, v54
    s_mul_i32 s66, s64, 1280
    s_lshl_b32 s38, s37, 10
    v_lshlrev_b32 v55, 4, v0
    s_mul_i32 s67, s37, 6144
    s_lshl_b32 s65, s2, 2
    s_add_u32 s65, s65, s37
    s_mul_i32 s65, s65, 896
    v_min_u32 v56, 6, v0
    v_lshlrev_b32 v56, 7, v56
    s_mov_b32 s50, 25600
    s_mov_b32 s51, 0x20000
    s_and_b32 s36, s34, 1
    s_cmp_eq_u32 s36, 0
    s_waitcnt lgkmcnt(0)
    s_cselect_b32 s48, s8, s10
    s_cselect_b32 s49, s9, s11
    s_add_u32 s72, s30, 8519680
    s_addc_u32 s73, s31, 0
    s_mov_b32 s74, 196864
    s_mov_b32 s75, 0x20000
    s_load_dword s3, s[72:73], 196608
    s_mov_b32 s40, s4
    s_mov_b32 s41, s5
    s_mov_b32 s42, 2621440
    s_mov_b32 s43, 0x20000
    s_add_u32 m0, s38, 102400
    s_nop 0
    buffer_load_dwordx4 v54, s[40:43], s66 offen offset:0 lds
    s_add_u32 m0, s38, 106240
    s_nop 0
    buffer_load_dwordx4 v54, s[40:43], s66 offen offset:256 lds
    s_add_u32 m0, s38, 110080
    s_nop 0
    buffer_load_dwordx4 v54, s[40:43], s66 offen offset:512 lds
    s_add_u32 m0, s38, 113920
    s_nop 0
    buffer_load_dwordx4 v54, s[40:43], s66 offen offset:768 lds
    s_add_u32 m0, s38, 117760
    s_nop 0
    buffer_load_dwordx4 v54, s[40:43], s66 offen offset:1024 lds
    s_mov_b32 s44, s6
    s_mov_b32 s45, s7
    s_mov_b32 s46, 819200
    s_mov_b32 s47, 0x20000
    s_mov_b64 exec, 0x7f
    buffer_load_dword v62, v56, s[44:47], s65 offen
    s_mov_b64 exec, -1
    s_add_u32 m0, s67, 122880
    s_nop 0
    buffer_load_dwordx4 v55, s[48:51], s67 offen offset:0 lds
    buffer_load_dwordx4 v55, s[48:51], s67 offen offset:1024 lds
    buffer_load_dwordx4 v55, s[48:51], s67 offen offset:2048 lds
    s_add_u32 s67, s67, 3072
    s_add_u32 m0, s67, 122880
    s_nop 0
    buffer_load_dwordx4 v55, s[48:51], s67 offen offset:0 lds
    buffer_load_dwordx4 v55, s[48:51], s67 offen offset:1024 lds
    buffer_load_dwordx4 v55, s[48:51], s67 offen offset:2048 lds
    s_cmp_lg_u32 s37, 3
    s_cbranch_scc1 L_r1
    buffer_load_dwordx4 v55, s[48:51], s67 offen offset:3072 lds
L_r1:
    s_mov_b32 s44, s24
    s_mov_b32 s45, s25
    s_mov_b32 s46, 1280
    s_mov_b32 s47, 0x20000
    s_cmp_ge_u32 s37, 2
    s_cbranch_scc1 L_r2
    s_add_u32 m0, s38, 98304
    s_nop 0
    buffer_load_dwordx4 v55, s[44:47], s38 offen lds
L_r2:
    s_lshl_b32 s36, s33, 3
    s_add_u32 s36, s36, s34
    s_lshl_b32 s36, s36, 6
    s_lshl_b32 s39, s37, 14
    v_mov_b32 v57, s39
    s_mov_b32 s39, 65536
    s_nop 0
    v_writelane_b32 v57, s39, 1
    s_mov_b64 exec, 3
    buffer_load_dword v63, v57, s[72:75], s36 offen sc1
    s_mov_b64 exec, -1
    v_and_b32 v52, 31, v0
    v_lshrrev_b32 v53, 5, v0
    s_and_b32 s36, s34, 1
    s_lshl_b32 s39, s36, 2
    s_add_u32 s39, s39, s37
    s_lshl_b32 s39, s39, 1
    v_add_u32 v1, s39, v53
    v_lshlrev_b32 v1, 1, v1
    v_xor_b32 v1, v1, v52
    v_lshlrev_b32 v1, 3, v1
    v_lshl_add_u32 v1, v53, 8, v1
    s_lshl_b32 s36, s36, 9
    s_add_u32 s36, s36, s38
    s_add_u32 s36, s36, 102400
    v_add_u32 v1, s36, v1
    v_lshlrev_b32 v52, 3, v52
    s_waitcnt vmcnt(8)
    ds_read_b64 v[2:3], v1 offset:0
    ds_read_b64 v[4:5], v1 offset:4096
    ds_read_b64 v[6:7], v1 offset:8192
    ds_read_b64 v[8:9], v1 offset:12288
    ds_read_b64 v[10:11], v1 offset:16384
    s_waitcnt lgkmcnt(0)
    v_lshlrev_b32 v12, 16, v2
    v_and_b32 v13, 0xffff0000, v2
    v_lshlrev_b32 v14, 16, v3
    v_and_b32 v15, 0xffff0000, v3
    v_lshlrev_b32 v16, 16, v4
    v_and_b32 v17, 0xffff0000, v4
    v_lshlrev_b32 v18, 16, v5
    v_and_b32 v19, 0xffff0000, v5
    v_lshlrev_b32 v20, 16, v6
    v_and_b32 v21, 0xffff0000, v6
    v_lshlrev_b32 v22, 16, v7
    v_and_b32 v23, 0xffff0000, v7
    v_lshlrev_b32 v24, 16, v8
    v_and_b32 v25, 0xffff0000, v8
    v_lshlrev_b32 v26, 16, v9
    v_and_b32 v27, 0xffff0000, v9
    v_lshlrev_b32 v28, 16, v10
    v_and_b32 v29, 0xffff0000, v10
    v_lshlrev_b32 v30, 16, v11
    v_and_b32 v31, 0xffff0000, v11
    v_pk_add_f32 v[56:57], v[12:13], v[14:15]
    v_pk_add_f32 v[58:59], v[16:17], v[18:19]
    v_pk_add_f32 v[56:57], v[56:57], v[20:21]
    v_pk_add_f32 v[58:59], v[58:59], v[22:23]
    v_pk_add_f32 v[56:57], v[56:57], v[24:25]
    v_pk_add_f32 v[58:59], v[58:59], v[26:27]
    v_pk_add_f32 v[56:57], v[56:57], v[28:29]
    v_pk_add_f32 v[58:59], v[58:59], v[30:31]
    v_pk_add_f32 v[56:57], v[56:57], v[58:59]
    v_add_f32 v56, v56, v57
    s_nop 1
    v_add_f32_dpp v56, v56, v56 quad_perm:[1,0,3,2] row_mask:0xf bank_mask:0xf
    s_nop 1
    v_add_f32_dpp v56, v56, v56 quad_perm:[2,3,0,1] row_mask:0xf bank_mask:0xf
    s_nop 1
    v_add_f32_dpp v56, v56, v56 row_half_mirror row_mask:0xf bank_mask:0xf
    s_nop 1
    v_add_f32_dpp v56, v56, v56 row_mirror row_mask:0xf bank_mask:0xf
    v_mov_b32 v57, v56
    s_nop 1
    v_permlane16_swap_b32 v56, v57
    v_add_f32 v56, v56, v57
    v_mul_f32 v56, 0x3acccccd, v56
    v_pk_add_f32 v[32:33], v[12:13], v[56:57] op_sel_hi:[1,0] neg_lo:[0,1] neg_hi:[0,1]
    v_pk_add_f32 v[34:35], v[14:15], v[56:57] op_sel_hi:[1,0] neg_lo:[0,1] neg_hi:[0,1]
    v_pk_add_f32 v[36:37], v[16:17], v[56:57] op_sel_hi:[1,0] neg_lo:[0,1] neg_hi:[0,1]
    v_pk_add_f32 v[38:39], v[18:19], v[56:57] op_sel_hi:[1,0] neg_lo:[0,1] neg_hi:[0,1]
    v_pk_add_f32 v[40:41], v[20:21], v[56:57] op_sel_hi:[1,0] neg_lo:[0,1] neg_hi:[0,1]
    v_pk_add_f32 v[42:43], v[22:23], v[56:57] op_sel_hi:[1,0] neg_lo:[0,1] neg_hi:[0,1]
    v_pk_add_f32 v[44:45], v[24:25], v[56:57] op_sel_hi:[1,0] neg_lo:[0,1] neg_hi:[0,1]
    v_pk_add_f32 v[46:47], v[26:27], v[56:57] op_sel_hi:[1,0] neg_lo:[0,1] neg_hi:[0,1]
    v_pk_add_f32 v[48:49], v[28:29], v[56:57] op_sel_hi:[1,0] neg_lo:[0,1] neg_hi:[0,1]
    v_pk_add_f32 v[50:51], v[30:31], v[56:57] op_sel_hi:[1,0] neg_lo:[0,1] neg_hi:[0,1]
    v_pk_mul_f32 v[58:59], v[32:33], v[32:33]
    v_pk_mul_f32 v[60:61], v[34:35], v[34:35]
    v_pk_fma_f32 v[58:59], v[36:37], v[36:37], v[58:59]
    v_pk_fma_f32 v[60:61], v[38:39], v[38:39], v[60:61]
    v_pk_fma_f32 v[58:59], v[40:41], v[40:41], v[58:59]
    v_pk_fma_f32 v[60:61], v[42:43], v[42:43], v[60:61]
    v_pk_fma_f32 v[58:59], v[44:45], v[44:45], v[58:59]
    v_pk_fma_f32 v[60:61], v[46:47], v[46:47], v[60:61]
    v_pk_fma_f32 v[58:59], v[48:49], v[48:49], v[58:59]
    v_pk_fma_f32 v[60:61], v[50:51], v[50:51], v[60:61]
    v_pk_add_f32 v[58:59], v[58:59], v[60:61]
    v_add_f32 v58, v58, v59
    v_cvt_pk_bf16_f32 v56, v56, v56
    v_lshlrev_b32 v56, 16, v56
    v_pk_add_f32 v[32:33], v[12:13], v[56:57] op_sel_hi:[1,0] neg_lo:[0,1] neg_hi:[0,1]
    v_pk_add_f32 v[34:35], v[14:15], v[56:57] op_sel_hi:[1,0] neg_lo:[0,1] neg_hi:[0,1]
    v_add_f32_dpp v58, v58, v58 quad_perm:[1,0,3,2] row_mask:0xf bank_mask:0xf
    v_pk_add_f32 v[36:37], v[16:17], v[56:57] op_sel_hi:[1,0] neg_lo:[0,1] neg_hi:[0,1]
    v_pk_add_f32 v[38:39], v[18:19], v[56:57] op_sel_hi:[1,0] neg_lo:[0,1] neg_hi:[0,1]
    v_add_f32_dpp v58, v58, v58 quad_perm:[2,3,0,1] row_mask:0xf bank_mask:0xf
    v_pk_add_f32 v[40:41], v[20:21], v[56:57] op_sel_hi:[1,0] neg_lo:[0,1] neg_hi:[0,1]
    v_pk_add_f32 v[42:43], v[22:23], v[56:57] op_sel_hi:[1,0] neg_lo:[0,1] neg_hi:[0,1]
    v_add_f32_dpp v58, v58, v58 row_half_mirror row_mask:0xf bank_mask:0xf
    v_pk_add_f32 v[44:45], v[24:25], v[56:57] op_sel_hi:[1,0] neg_lo:[0,1] neg_hi:[0,1]
    v_pk_add_f32 v[46:47], v[26:27], v[56:57] op_sel_hi:[1,0] neg_lo:[0,1] neg_hi:[0,1]
    v_add_f32_dpp v58, v58, v58 row_mirror row_mask:0xf bank_mask:0xf
    v_mov_b32 v59, v58
    v_pk_add_f32 v[48:49], v[28:29], v[56:57] op_sel_hi:[1,0] neg_lo:[0,1] neg_hi:[0,1]
    v_pk_add_f32 v[50:51], v[30:31], v[56:57] op_sel_hi:[1,0] neg_lo:[0,1] neg_hi:[0,1]
    v_permlane16_swap_b32 v58, v59
    v_add_f32 v58, v58, v59
    v_mul_f32 v58, 0x3acccccd, v58
    v_cvt_pk_bf16_f32 v58, v58, v58
    v_lshlrev_b32 v58, 16, v58
    v_add_f32 v58, 0x3727c5ac, v58
    v_cvt_pk_bf16_f32 v58, v58, v58
    v_lshlrev_b32 v58, 16, v58
    v_sqrt_f32 v58, v58
    v_cvt_pk_bf16_f32 v2, v32, v33
    v_cvt_pk_bf16_f32 v3, v34, v35
    v_cvt_pk_bf16_f32 v4, v36, v37
    v_cvt_pk_bf16_f32 v5, v38, v39
    v_cvt_pk_bf16_f32 v6, v40, v41
    v_cvt_pk_bf16_f32 v7, v42, v43
    v_cvt_pk_bf16_f32 v8, v44, v45
    v_cvt_pk_bf16_f32 v9, v46, v47
    v_cvt_pk_bf16_f32 v10, v48, v49
    v_cvt_pk_bf16_f32 v11, v50, v51
    v_cvt_pk_bf16_f32 v58, v58, v58
    v_lshlrev_b32 v58, 16, v58
    v_rcp_f32 v58, v58
    v_lshlrev_b32 v32, 16, v2
    v_and_b32 v33, 0xffff0000, v2
    v_lshlrev_b32 v34, 16, v3
    v_and_b32 v35, 0xffff0000, v3
    v_lshlrev_b32 v36, 16, v4
    v_and_b32 v37, 0xffff0000, v4
    v_lshlrev_b32 v38, 16, v5
    v_and_b32 v39, 0xffff0000, v5
    v_lshlrev_b32 v40, 16, v6
    v_and_b32 v41, 0xffff0000, v6
    v_lshlrev_b32 v42, 16, v7
    v_and_b32 v43, 0xffff0000, v7
    v_lshlrev_b32 v44, 16, v8
    v_and_b32 v45, 0xffff0000, v8
    v_lshlrev_b32 v46, 16, v9
    v_and_b32 v47, 0xffff0000, v9
    v_lshlrev_b32 v48, 16, v10
    v_and_b32 v49, 0xffff0000, v10
    v_lshlrev_b32 v50, 16, v11
    v_and_b32 v51, 0xffff0000, v11
    v_pk_mul_f32 v[32:33], v[32:33], v[58:59] op_sel_hi:[1,0]
    v_pk_mul_f32 v[34:35], v[34:35], v[58:59] op_sel_hi:[1,0]
    v_pk_mul_f32 v[36:37], v[36:37], v[58:59] op_sel_hi:[1,0]
    v_pk_mul_f32 v[38:39], v[38:39], v[58:59] op_sel_hi:[1,0]
    v_pk_mul_f32 v[40:41], v[40:41], v[58:59] op_sel_hi:[1,0]
    v_pk_mul_f32 v[42:43], v[42:43], v[58:59] op_sel_hi:[1,0]
    v_pk_mul_f32 v[44:45], v[44:45], v[58:59] op_sel_hi:[1,0]
    v_pk_mul_f32 v[46:47], v[46:47], v[58:59] op_sel_hi:[1,0]
    v_pk_mul_f32 v[48:49], v[48:49], v[58:59] op_sel_hi:[1,0]
    v_pk_mul_f32 v[50:51], v[50:51], v[58:59] op_sel_hi:[1,0]
    v_cvt_pk_bf16_f32 v2, v32, v33
    v_cvt_pk_bf16_f32 v3, v34, v35
    v_cvt_pk_bf16_f32 v4, v36, v37
    v_cvt_pk_bf16_f32 v5, v38, v39
    v_cvt_pk_bf16_f32 v6, v40, v41
    v_cvt_pk_bf16_f32 v7, v42, v43
    v_cvt_pk_bf16_f32 v8, v44, v45
    v_cvt_pk_bf16_f32 v9, v46, v47
    v_cvt_pk_bf16_f32 v10, v48, v49
    v_cvt_pk_bf16_f32 v11, v50, v51
    s_mul_i32 s36, s37, 2688
    s_add_u32 s36, s36, 148480
    v_mul_u32_u24 v56, 1344, v53
    v_add3_u32 v56, v56, v52, s36
    ds_write_b64 v56, v[2:3] offset:0
    ds_write_b64 v56, v[4:5] offset:256
    ds_write_b64 v56, v[6:7] offset:512
    ds_write_b64 v56, v[8:9] offset:768
    ds_write_b64 v56, v[10:11] offset:1024
    s_waitcnt lgkmcnt(0)
    s_mul_i32 s3, s3, 1664525
    s_add_u32 s3, s3, 1013904223
    v_mov_b32 v56, 161812
    v_mov_b32 v57, s3
    ds_write_b32 v56, v57
    s_waitcnt vmcnt(0)
    v_mov_b32 v58, 161792
    v_mov_b32 v59, 1
    s_waitcnt lgkmcnt(0)
    s_mov_b64 exec, 1
    ds_add_u32 v58, v59
    s_mov_b64 exec, -1
    s_cmp_lt_u32 s37, 2
    s_cbranch_scc1 L_kv
    s_mov_b32 s52, s30
    s_mov_b32 s53, s31
    s_mov_b32 s54, 2621440
    s_mov_b32 s55, 0x20000
    v_bfe_u32 v2, v0, 2, 2
    v_mul_u32_u24 v2, 1344, v2
    v_lshrrev_b32 v3, 4, v0
    v_lshl_add_u32 v2, v3, 5, v2
    v_and_b32 v4, 3, v0
    v_lshl_add_u32 v2, v4, 3, v2
    s_sub_u32 s36, s37, 2
    s_mul_i32 s65, s36, 640
    s_add_u32 s65, s65, 148480
    v_add_u32 v2, s65, v2
    v_and_b32 v4, 15, v0
    v_lshlrev_b32 v4, 4, v4
    v_lshl_add_u32 v4, v3, 10, v4
    s_lshr_b32 s66, s64, 5
    s_mul_i32 s66, s66, 40960
    s_and_b32 s65, s34, 3
    s_lshl_b32 s65, s65, 8
    s_add_u32 s66, s66, s65
    s_mul_i32 s36, s36, 20480
    s_add_u32 s66, s66, s36
    v_mov_b32 v56, 161792
    s_mov_b32 s95, 0x400000
L_spin1:
    ds_read_b32 v57, v56
    s_waitcnt lgkmcnt(0)
    v_readfirstlane_b32 s94, v57
    s_nop 0
    s_cmp_ge_u32 s94, 4
    s_cbranch_scc1 L_spun1
    s_sub_u32 s95, s95, 1
    s_cbranch_scc0 L_spin1
L_spun1:
    ds_read_b64_tr_b16 v[64:65], v2 offset:0
    ds_read_b64_tr_b16 v[66:67], v2 offset:5376
    ds_read_b64_tr_b16 v[68:69], v2 offset:128
    ds_read_b64_tr_b16 v[70:71], v2 offset:5504
    ds_read_b64_tr_b16 v[72:73], v2 offset:256
    ds_read_b64_tr_b16 v[74:75], v2 offset:5632
    ds_read_b64_tr_b16 v[76:77], v2 offset:384
    ds_read_b64_tr_b16 v[78:79], v2 offset:5760
    ds_read_b64_tr_b16 v[80:81], v2 offset:512
    ds_read_b64_tr_b16 v[82:83], v2 offset:5888
    s_waitcnt lgkmcnt(8)
    buffer_store_dwordx4 v[64:67], v4, s[52:55], s66 offen sc1
    s_add_u32 s66, s66, 4096
    s_waitcnt lgkmcnt(6)
    buffer_store_dwordx4 v[68:71], v4, s[52:55], s66 offen sc1
    s_add_u32 s66, s66, 4096
    s_waitcnt lgkmcnt(4)
    buffer_store_dwordx4 v[72:75], v4, s[52:55], s66 offen sc1
    s_add_u32 s66, s66, 4096
    s_waitcnt lgkmcnt(2)
    buffer_store_dwordx4 v[76:79], v4, s[52:55], s66 offen sc1
    s_add_u32 s66, s66, 4096
    s_waitcnt lgkmcnt(0)
    buffer_store_dwordx4 v[80:83], v4, s[52:55], s66 offen sc1
    s_waitcnt vmcnt(5)
    s_branch L_gate
L_kv:
    s_add_u32 s52, s30, 2621440
    s_addc_u32 s53, s31, 0
    s_mov_b32 s54, 163840
    s_mov_b32 s55, 0x20000
    v_lshrrev_b32 v3, 4, v0
    v_lshlrev_b32 v2, 3, v3
    v_bfe_u32 v4, v0, 2, 2
    v_add_u32 v2, v2, v4
    v_mul_u32_u24 v2, 40, v2
    v_and_b32 v4, 3, v0
    v_lshlrev_b32 v4, 3, v4
    v_mov_b32 v5, 32
    s_cmp_eq_u32 s37, 1
    s_cselect_b64 vcc, -1, 0
    v_cndmask_b32 v4, v4, v5, vcc
    v_add_u32 v2, v2, v4
    v_add_u32 v2, 122880, v2
    v_and_b32 v6, 15, v0
    v_and_b32 v56, 15, v0
    v_lshrrev_b32 v57, 4, v0
    v_xor_b32 v57, v57, v56
    v_bfe_u32 v58, v0, 1, 2
    v_bfe_u32 v56, v0, 3, 1
    v_lshl_add_u32 v58, v58, 1, v56
    v_and_b32 v56, 1, v0
    v_lshl_add_u32 v58, v58, 1, v56
    v_lshlrev_b32 v58, 8, v58
    v_add_u32 v58, 102400, v58
    v_xor_b32 v56, 0, v57
    v_lshl_add_u32 v60, v56, 4, v58
    v_xor_b32 v56, 4, v57
    v_lshl_add_u32 v61, v56, 4, v58
    v_xor_b32 v56, 8, v57
    v_lshl_add_u32 v62, v56, 4, v58
    v_xor_b32 v56, 12, v57
    v_lshl_add_u32 v63, v56, 4, v58
    s_lshr_b32 s65, s64, 5
    s_mul_i32 s65, s65, 2560
    s_bfe_u32 s66, s64, 0x10004
    v_mov_b32 v56, 161792
    s_mov_b32 s95, 0x400000
L_spin2:
    ds_read_b32 v57, v56
    s_waitcnt lgkmcnt(0)
    v_readfirstlane_b32 s94, v57
    s_nop 0
    s_cmp_ge_u32 s94, 4
    s_cbranch_scc1 L_spun2
    s_sub_u32 s95, s95, 1
    s_cbranch_scc0 L_spin2
L_spun2:
    s_and_b32 s36, s34, 1
    s_cbranch_scc1 L_v
    ds_read_b128 v[64:67], v60 offset:0
    ds_read_b64_tr_b16 v[144:145], v2 offset:0
    ds_read_b64_tr_b16 v[146:147], v2 offset:160
    ds_read_b128 v[68:71], v61 offset:0
    ds_read_b64_tr_b16 v[148:149], v2 offset:1280
    ds_read_b64_tr_b16 v[150:151], v2 offset:1440
    ds_read_b128 v[72:75], v62 offset:0
    ds_read_b64_tr_b16 v[152:153], v2 offset:2560
    ds_read_b64_tr_b16 v[154:155], v2 offset:2720
    ds_read_b128 v[76:79], v63 offset:0
    ds_read_b64_tr_b16 v[156:157], v2 offset:3840
    ds_read_b64_tr_b16 v[158:159], v2 offset:4000
    ds_read_b128 v[80:83], v60 offset:4096
    ds_read_b64_tr_b16 v[160:161], v2 offset:5120
    ds_read_b64_tr_b16 v[162:163], v2 offset:5280
    s_waitcnt lgkmcnt(9)
    v_mfma_f32_16x16x32_bf16 v[32:35], v[144:147], v[64:67], 0
    ds_read_b128 v[84:87], v61 offset:4096
    ds_read_b64_tr_b16 v[164:165], v2 offset:6400
    ds_read_b64_tr_b16 v[166:167], v2 offset:6560
    v_mfma_f32_16x16x32_bf16 v[36:39], v[148:151], v[68:71], 0
    ds_read_b128 v[88:91], v62 offset:4096
    ds_read_b64_tr_b16 v[144:145], v2 offset:7680
    ds_read_b64_tr_b16 v[146:147], v2 offset:7840
    s_waitcnt lgkmcnt(9)
    v_mfma_f32_16x16x32_bf16 v[32:35], v[152:155], v[72:75], v[32:35]
    ds_read_b128 v[92:95], v63 offset:4096
    ds_read_b64_tr_b16 v[148:149], v2 offset:8960
    ds_read_b64_tr_b16 v[150:151], v2 offset:9120
    v_mfma_f32_16x16x32_bf16 v[36:39], v[156:159], v[76:79], v[36:39]
    ds_read_b128 v[96:99], v60 offset:8192
    ds_read_b64_tr_b16 v[152:153], v2 offset:10240
    ds_read_b64_tr_b16 v[154:155], v2 offset:10400
    s_waitcnt lgkmcnt(9)
    v_mfma_f32_16x16x32_bf16 v[32:35], v[160:163], v[80:83], v[32:35]
    ds_read_b128 v[100:103], v61 offset:8192
    ds_read_b64_tr_b16 v[156:157], v2 offset:11520
    ds_read_b64_tr_b16 v[158:159], v2 offset:11680
    v_mfma_f32_16x16x32_bf16 v[36:39], v[164:167], v[84:87], v[36:39]
    ds_read_b128 v[104:107], v62 offset:8192
    ds_read_b64_tr_b16 v[160:161], v2 offset:12800
    ds_read_b64_tr_b16 v[162:163], v2 offset:12960
    s_waitcnt lgkmcnt(9)
    v_mfma_f32_16x16x32_bf16 v[32:35], v[144:147], v[88:91], v[32:35]
    ds_read_b128 v[108:111], v63 offset:8192
    ds_read_b64_tr_b16 v[164:165], v2 offset:14080
    ds_read_b64_tr_b16 v[166:167], v2 offset:14240
    v_mfma_f32_16x16x32_bf16 v[36:39], v[148:151], v[92:95], v[36:39]
    ds_read_b128 v[112:115], v60 offset:12288
    ds_read_b64_tr_b16 v[144:145], v2 offset:15360
    ds_read_b64_tr_b16 v[146:147], v2 offset:15520
    s_waitcnt lgkmcnt(9)
    v_mfma_f32_16x16x32_bf16 v[32:35], v[152:155], v[96:99], v[32:35]
    ds_read_b128 v[116:119], v61 offset:12288
    ds_read_b64_tr_b16 v[148:149], v2 offset:16640
    ds_read_b64_tr_b16 v[150:151], v2 offset:16800
    v_mfma_f32_16x16x32_bf16 v[36:39], v[156:159], v[100:103], v[36:39]
    ds_read_b128 v[120:123], v62 offset:12288
    ds_read_b64_tr_b16 v[152:153], v2 offset:17920
    ds_read_b64_tr_b16 v[154:155], v2 offset:18080
    s_waitcnt lgkmcnt(9)
    v_mfma_f32_16x16x32_bf16 v[32:35], v[160:163], v[104:107], v[32:35]
    ds_read_b128 v[124:127], v63 offset:12288
    ds_read_b64_tr_b16 v[156:157], v2 offset:19200
    ds_read_b64_tr_b16 v[158:159], v2 offset:19360
    v_mfma_f32_16x16x32_bf16 v[36:39], v[164:167], v[108:111], v[36:39]
    ds_read_b128 v[128:131], v60 offset:16384
    ds_read_b64_tr_b16 v[160:161], v2 offset:20480
    ds_read_b64_tr_b16 v[162:163], v2 offset:20640
    s_waitcnt lgkmcnt(9)
    v_mfma_f32_16x16x32_bf16 v[32:35], v[144:147], v[112:115], v[32:35]
    ds_read_b128 v[132:135], v61 offset:16384
    ds_read_b64_tr_b16 v[164:165], v2 offset:21760
    ds_read_b64_tr_b16 v[166:167], v2 offset:21920
    v_mfma_f32_16x16x32_bf16 v[36:39], v[148:151], v[116:119], v[36:39]
    ds_read_b128 v[136:139], v62 offset:16384
    ds_read_b64_tr_b16 v[144:145], v2 offset:23040
    ds_read_b64_tr_b16 v[146:147], v2 offset:23200
    s_waitcnt lgkmcnt(9)
    v_mfma_f32_16x16x32_bf16 v[32:35], v[152:155], v[120:123], v[32:35]
    ds_read_b128 v[140:143], v63 offset:16384
    ds_read_b64_tr_b16 v[148:149], v2 offset:24320
    ds_read_b64_tr_b16 v[150:151], v2 offset:24480
    v_mfma_f32_16x16x32_bf16 v[36:39], v[156:159], v[124:127], v[36:39]
    s_waitcnt lgkmcnt(6)
    v_mfma_f32_16x16x32_bf16 v[32:35], v[160:163], v[128:131], v[32:35]
    v_mfma_f32_16x16x32_bf16 v[36:39], v[164:167], v[132:135], v[36:39]
    s_waitcnt lgkmcnt(0)
    v_mfma_f32_16x16x32_bf16 v[32:35], v[144:147], v[136:139], v[32:35]
    v_mfma_f32_16x16x32_bf16 v[36:39], v[148:151], v[140:143], v[36:39]
    s_lshl_b32 s67, s66, 4
    v_add_u32 v7, s67, v6
    v_lshrrev_b32 v4, 1, v3
    v_lshlrev_b32 v4, 9, v4
    v_lshl_add_u32 v4, v7, 4, v4
    v_and_b32 v5, 1, v3
    v_lshl_add_u32 v4, v5, 3, v4
    s_nop 0
    v_pk_add_f32 v[32:33], v[32:33], v[36:37]
    v_pk_add_f32 v[34:35], v[34:35], v[38:39]
    v_cvt_pk_bf16_f32 v8, v32, v33
    v_cvt_pk_bf16_f32 v9, v34, v35
    s_cmp_eq_u32 s37, 0
    s_cbranch_scc1 L_kvst
    s_lshl_b32 s66, s66, 7
    s_add_u32 s65, s65, s66
    v_lshlrev_b32 v4, 2, v0
    s_mov_b64 exec, 0xffff
    v_mov_b32 v9, v8
    s_mov_b32 exec_lo, -1
    buffer_store_dword v9, v4, s[52:55], s65 offen offset:1024 sc1
    s_branch L_kvdone
L_v:
    ds_read_b128 v[64:67], v60 offset:0
    ds_read_b64_tr_b16 v[144:145], v2 offset:0
    ds_read_b64_tr_b16 v[146:147], v2 offset:160
    ds_read_b128 v[68:71], v61 offset:0
    ds_read_b64_tr_b16 v[148:149], v2 offset:1280
    ds_read_b64_tr_b16 v[150:151], v2 offset:1440
    ds_read_b128 v[72:75], v62 offset:0
    ds_read_b64_tr_b16 v[152:153], v2 offset:2560
    ds_read_b64_tr_b16 v[154:155], v2 offset:2720
    ds_read_b128 v[76:79], v63 offset:0
    ds_read_b64_tr_b16 v[156:157], v2 offset:3840
    ds_read_b64_tr_b16 v[158:159], v2 offset:4000
    ds_read_b128 v[80:83], v60 offset:4096
    ds_read_b64_tr_b16 v[160:161], v2 offset:5120
    ds_read_b64_tr_b16 v[162:163], v2 offset:5280
    s_waitcnt lgkmcnt(9)
    v_mfma_f32_16x16x32_bf16 v[32:35], v[64:67], v[144:147], 0
    ds_read_b128 v[84:87], v61 offset:4096
    ds_read_b64_tr_b16 v[164:165], v2 offset:6400
    ds_read_b64_tr_b16 v[166:167], v2 offset:6560
    v_mfma_f32_16x16x32_bf16 v[36:39], v[68:71], v[148:151], 0
    ds_read_b128 v[88:91], v62 offset:4096
    ds_read_b64_tr_b16 v[144:145], v2 offset:7680
    ds_read_b64_tr_b16 v[146:147], v2 offset:7840
    s_waitcnt lgkmcnt(9)
    v_mfma_f32_16x16x32_bf16 v[32:35], v[72:75], v[152:155], v[32:35]
    ds_read_b128 v[92:95], v63 offset:4096
    ds_read_b64_tr_b16 v[148:149], v2 offset:8960
    ds_read_b64_tr_b16 v[150:151], v2 offset:9120
    v_mfma_f32_16x16x32_bf16 v[36:39], v[76:79], v[156:159], v[36:39]
    ds_read_b128 v[96:99], v60 offset:8192
    ds_read_b64_tr_b16 v[152:153], v2 offset:10240
    ds_read_b64_tr_b16 v[154:155], v2 offset:10400
    s_waitcnt lgkmcnt(9)
    v_mfma_f32_16x16x32_bf16 v[32:35], v[80:83], v[160:163], v[32:35]
    ds_read_b128 v[100:103], v61 offset:8192
    ds_read_b64_tr_b16 v[156:157], v2 offset:11520
    ds_read_b64_tr_b16 v[158:159], v2 offset:11680
    v_mfma_f32_16x16x32_bf16 v[36:39], v[84:87], v[164:167], v[36:39]
    ds_read_b128 v[104:107], v62 offset:8192
    ds_read_b64_tr_b16 v[160:161], v2 offset:12800
    ds_read_b64_tr_b16 v[162:163], v2 offset:12960
    s_waitcnt lgkmcnt(9)
    v_mfma_f32_16x16x32_bf16 v[32:35], v[88:91], v[144:147], v[32:35]
    ds_read_b128 v[108:111], v63 offset:8192
    ds_read_b64_tr_b16 v[164:165], v2 offset:14080
    ds_read_b64_tr_b16 v[166:167], v2 offset:14240
    v_mfma_f32_16x16x32_bf16 v[36:39], v[92:95], v[148:151], v[36:39]
    ds_read_b128 v[112:115], v60 offset:12288
    ds_read_b64_tr_b16 v[144:145], v2 offset:15360
    ds_read_b64_tr_b16 v[146:147], v2 offset:15520
    s_waitcnt lgkmcnt(9)
    v_mfma_f32_16x16x32_bf16 v[32:35], v[96:99], v[152:155], v[32:35]
    ds_read_b128 v[116:119], v61 offset:12288
    ds_read_b64_tr_b16 v[148:149], v2 offset:16640
    ds_read_b64_tr_b16 v[150:151], v2 offset:16800
    v_mfma_f32_16x16x32_bf16 v[36:39], v[100:103], v[156:159], v[36:39]
    ds_read_b128 v[120:123], v62 offset:12288
    ds_read_b64_tr_b16 v[152:153], v2 offset:17920
    ds_read_b64_tr_b16 v[154:155], v2 offset:18080
    s_waitcnt lgkmcnt(9)
    v_mfma_f32_16x16x32_bf16 v[32:35], v[104:107], v[160:163], v[32:35]
    ds_read_b128 v[124:127], v63 offset:12288
    ds_read_b64_tr_b16 v[156:157], v2 offset:19200
    ds_read_b64_tr_b16 v[158:159], v2 offset:19360
    v_mfma_f32_16x16x32_bf16 v[36:39], v[108:111], v[164:167], v[36:39]
    ds_read_b128 v[128:131], v60 offset:16384
    ds_read_b64_tr_b16 v[160:161], v2 offset:20480
    ds_read_b64_tr_b16 v[162:163], v2 offset:20640
    s_waitcnt lgkmcnt(9)
    v_mfma_f32_16x16x32_bf16 v[32:35], v[112:115], v[144:147], v[32:35]
    ds_read_b128 v[132:135], v61 offset:16384
    ds_read_b64_tr_b16 v[164:165], v2 offset:21760
    ds_read_b64_tr_b16 v[166:167], v2 offset:21920
    v_mfma_f32_16x16x32_bf16 v[36:39], v[116:119], v[148:151], v[36:39]
    ds_read_b128 v[136:139], v62 offset:16384
    ds_read_b64_tr_b16 v[144:145], v2 offset:23040
    ds_read_b64_tr_b16 v[146:147], v2 offset:23200
    s_waitcnt lgkmcnt(9)
    v_mfma_f32_16x16x32_bf16 v[32:35], v[120:123], v[152:155], v[32:35]
    ds_read_b128 v[140:143], v63 offset:16384
    ds_read_b64_tr_b16 v[148:149], v2 offset:24320
    ds_read_b64_tr_b16 v[150:151], v2 offset:24480
    v_mfma_f32_16x16x32_bf16 v[36:39], v[124:127], v[156:159], v[36:39]
    s_waitcnt lgkmcnt(6)
    v_mfma_f32_16x16x32_bf16 v[32:35], v[128:131], v[160:163], v[32:35]
    v_mfma_f32_16x16x32_bf16 v[36:39], v[132:135], v[164:167], v[36:39]
    s_waitcnt lgkmcnt(0)
    v_mfma_f32_16x16x32_bf16 v[32:35], v[136:139], v[144:147], v[32:35]
    v_mfma_f32_16x16x32_bf16 v[36:39], v[140:143], v[148:151], v[36:39]
    s_mul_i32 s66, s66, 640
    s_add_u32 s65, s65, s66
    s_add_u32 s65, s65, 1280
    s_lshl_b32 s36, s37, 9
    s_add_u32 s65, s65, s36
    s_lshl_b32 s36, s37, 1
    s_sub_u32 s36, 8, s36
    v_lshrrev_b32 v4, 1, v3
    v_lshlrev_b32 v4, s36, v4
    v_lshl_add_u32 v4, v6, 4, v4
    v_and_b32 v5, 1, v3
    v_lshl_add_u32 v4, v5, 3, v4
    v_pk_add_f32 v[32:33], v[32:33], v[36:37]
    v_pk_add_f32 v[34:35], v[34:35], v[38:39]
    v_cvt_pk_bf16_f32 v8, v32, v33
    v_cvt_pk_bf16_f32 v9, v34, v35
    s_cmp_eq_u32 s37, 0
    s_cbranch_scc1 L_kvst
    s_mov_b32 exec_lo, 0x000f000f
    s_mov_b32 exec_hi, 0x000f000f
L_kvst:
    buffer_store_dwordx2 v[8:9], v4, s[52:55], s65 offen sc1
L_kvdone:
    s_mov_b64 exec, -1
    v_mov_b32 v56, 161892
    v_mov_b32 v57, 1
    s_waitcnt lgkmcnt(0)
    s_mov_b64 exec, 1
    ds_add_u32 v56, v57
    s_mov_b64 exec, -1
    s_waitcnt vmcnt(1)
L_gate:
    v_add_u32 v56, 98304, v52
    ds_read_b64 v[168:169], v56 offset:0
    ds_read_b64 v[170:171], v56 offset:256
    ds_read_b64 v[172:173], v56 offset:512
    ds_read_b64 v[174:175], v56 offset:768
    ds_read_b64 v[176:177], v56 offset:1024
    s_waitcnt lgkmcnt(0)
    v_lshlrev_b32 v32, 16, v168
    v_and_b32 v33, 0xffff0000, v168
    v_lshlrev_b32 v34, 16, v169
    v_and_b32 v35, 0xffff0000, v169
    v_lshlrev_b32 v36, 16, v170
    v_and_b32 v37, 0xffff0000, v170
    v_lshlrev_b32 v38, 16, v171
    v_and_b32 v39, 0xffff0000, v171
    v_lshlrev_b32 v40, 16, v172
    v_and_b32 v41, 0xffff0000, v172
    v_lshlrev_b32 v42, 16, v173
    v_and_b32 v43, 0xffff0000, v173
    v_lshlrev_b32 v44, 16, v174
    v_and_b32 v45, 0xffff0000, v174
    v_lshlrev_b32 v46, 16, v175
    v_and_b32 v47, 0xffff0000, v175
    v_lshlrev_b32 v48, 16, v176
    v_and_b32 v49, 0xffff0000, v176
    v_lshlrev_b32 v50, 16, v177
    v_and_b32 v51, 0xffff0000, v177
    v_pk_mul_f32 v[32:33], v[32:33], v[12:13]
    v_pk_mul_f32 v[34:35], v[34:35], v[14:15]
    v_pk_mul_f32 v[36:37], v[36:37], v[16:17]
    v_pk_mul_f32 v[38:39], v[38:39], v[18:19]
    v_pk_mul_f32 v[40:41], v[40:41], v[20:21]
    v_pk_mul_f32 v[42:43], v[42:43], v[22:23]
    v_pk_mul_f32 v[44:45], v[44:45], v[24:25]
    v_pk_mul_f32 v[46:47], v[46:47], v[26:27]
    v_pk_mul_f32 v[48:49], v[48:49], v[28:29]
    v_pk_mul_f32 v[50:51], v[50:51], v[30:31]
    v_cvt_pk_bf16_f32 v168, v32, v33
    v_cvt_pk_bf16_f32 v169, v34, v35
    v_cvt_pk_bf16_f32 v170, v36, v37
    v_cvt_pk_bf16_f32 v171, v38, v39
    v_cvt_pk_bf16_f32 v172, v40, v41
    v_cvt_pk_bf16_f32 v173, v42, v43
    v_cvt_pk_bf16_f32 v174, v44, v45
    v_cvt_pk_bf16_f32 v175, v46, v47
    v_cvt_pk_bf16_f32 v176, v48, v49
    v_cvt_pk_bf16_f32 v177, v50, v51
    v_lshlrev_b32 v32, 16, v168
    v_and_b32 v33, 0xffff0000, v168
    v_lshlrev_b32 v34, 16, v169
    v_and_b32 v35, 0xffff0000, v169
    v_lshlrev_b32 v36, 16, v170
    v_and_b32 v37, 0xffff0000, v170
    v_lshlrev_b32 v38, 16, v171
    v_and_b32 v39, 0xffff0000, v171
    v_lshlrev_b32 v40, 16, v172
    v_and_b32 v41, 0xffff0000, v172
    v_lshlrev_b32 v42, 16, v173
    v_and_b32 v43, 0xffff0000, v173
    v_lshlrev_b32 v44, 16, v174
    v_and_b32 v45, 0xffff0000, v174
    v_lshlrev_b32 v46, 16, v175
    v_and_b32 v47, 0xffff0000, v175
    v_lshlrev_b32 v48, 16, v176
    v_and_b32 v49, 0xffff0000, v176
    v_lshlrev_b32 v50, 16, v177
    v_and_b32 v51, 0xffff0000, v177
    v_pk_add_f32 v[32:33], v[32:33], v[36:37]
    v_pk_add_f32 v[34:35], v[34:35], v[38:39]
    v_pk_add_f32 v[32:33], v[32:33], v[40:41]
    v_pk_add_f32 v[34:35], v[34:35], v[42:43]
    v_pk_add_f32 v[32:33], v[32:33], v[44:45]
    v_pk_add_f32 v[34:35], v[34:35], v[46:47]
    v_pk_add_f32 v[32:33], v[32:33], v[48:49]
    v_pk_add_f32 v[34:35], v[34:35], v[50:51]
    v_pk_add_f32 v[56:57], v[32:33], v[34:35]
    v_add_f32 v56, v56, v57
    s_nop 1
    v_add_f32_dpp v56, v56, v56 quad_perm:[1,0,3,2] row_mask:0xf bank_mask:0xf
    s_nop 1
    v_add_f32_dpp v56, v56, v56 quad_perm:[2,3,0,1] row_mask:0xf bank_mask:0xf
    s_nop 1
    v_add_f32_dpp v56, v56, v56 row_half_mirror row_mask:0xf bank_mask:0xf
    s_nop 1
    v_add_f32_dpp v56, v56, v56 row_mirror row_mask:0xf bank_mask:0xf
    v_mov_b32 v57, v56
    s_nop 1
    v_permlane16_swap_b32 v56, v57
    v_add_f32 v56, v56, v57
    v_cvt_pk_bf16_f32 v56, v56, v56
    v_lshlrev_b32 v56, 16, v56
    v_mul_f32 v56, 0xbfb8aa3b, v56
    v_exp_f32 v56, v56
    s_nop 0
    v_add_f32 v56, 1.0, v56
    v_rcp_f32 v56, v56
    s_nop 0
    v_cvt_pk_bf16_f32 v56, v56, v56
    v_lshlrev_b32 v56, 16, v56
    v_sub_f32 v57, 1.0, v56
    v_cvt_pk_bf16_f32 v56, v56, v57
    v_mov_b32 v57, s3
    v_lshlrev_b32 v58, 3, v53
    s_lshl_b32 s36, s33, 3
    s_add_u32 s36, s36, s34
    s_lshl_b32 s36, s36, 6
    s_lshl_b32 s38, s37, 14
    s_add_u32 s36, s36, s38
    s_mov_b32 s69, s36
    s_lshl_b32 s39, s33, 3
    s_add_u32 s39, s39, s34
    s_lshl_b32 s39, s39, 6
    s_add_u32 s39, s39, 65536
    v_mov_b32 v60, 161824
    v_mov_b32 v61, 1
    s_waitcnt vmcnt(0) lgkmcnt(0)
    s_mov_b64 exec, 1
    ds_add_rtn_u32 v61, v60, v61
    s_waitcnt lgkmcnt(0)
    v_readfirstlane_b32 s94, v61
    s_mov_b64 exec, -1
    s_cmp_eq_u32 s94, 3
    s_cbranch_scc0 L_j1
    v_mov_b32 v60, 0
    v_mov_b32 v61, s3
    s_waitcnt vmcnt(0)
    s_mov_b64 exec, 1
    buffer_store_dword v61, v60, s[72:75], s39 offen sc1
    s_mov_b64 exec, -1
L_j1:
    s_mov_b32 s89, s69
    s_setprio 0
    s_mul_i32 s38, s37, 10240
    s_cmp_ge_u32 s37, 2
    s_cselect_b32 s36, 122880, 0
    s_add_u32 s38, s38, s36
    s_and_b32 s35, s2, 7
    s_lshr_b32 s36, s2, 3
    s_and_b32 s64, s35, 1
    s_lshl_b32 s64, s64, 2
    s_and_b32 s65, s36, 3
    s_add_u32 s64, s64, s65
    s_lshr_b32 s65, s35, 1
    s_mul_i32 s65, s65, 7
    s_lshr_b32 s36, s36, 2
    s_add_u32 s65, s65, s36
    s_cmp_ge_u32 s36, 7
    s_cselect_b32 s65, 28, s65
    v_lshlrev_b32 v252, 6, v0
    s_lshl_b32 s78, s37, 12
    s_add_u32 s78, s78, 65536
    s_mov_b32 s48, s18
    s_mov_b32 s49, s19
    s_mov_b32 s50, 3456
    s_mov_b32 s51, 0x20000
    s_xor_b32 s88, s37, 3
    v_lshrrev_b32 v15, 4, v0
    v_lshlrev_b32 v15, 3, v15
    s_lshl_b32 s36, s65, 7
    v_add_u32 v15, s36, v15
    v_lshrrev_b32 v11, 2, v0
    v_lshlrev_b32 v12, 7, v11
    v_and_b32 v13, 3, v0
    v_lshl_add_u32 v12, v13, 3, v12
    v_add_u32 v12, s38, v12
    v_bfe_u32 v13, v0, 3, 2
    v_xor_b32 v13, s88, v13
    v_xor_b32 v14, 0, v13
    v_lshl_add_u32 v5, v14, 5, v12
    v_xor_b32 v14, 1, v13
    v_lshl_add_u32 v6, v14, 5, v12
    v_xor_b32 v14, 2, v13
    v_lshl_add_u32 v7, v14, 5, v12
    v_xor_b32 v14, 3, v13
    v_lshl_add_u32 v8, v14, 5, v12
    v_lshlrev_b32 v9, 4, v0
    v_add_u32 v10, 4096, v9
    s_mov_b32 s40, s16
    s_mov_b32 s41, s17
    s_mov_b32 s42, 7077888
    s_mov_b32 s43, 0x20000
    s_mov_b32 s44, s30
    s_mov_b32 s45, s31
    s_mov_b32 s46, 2621440
    s_mov_b32 s47, 0x20000
    s_mov_b32 s56, s20
    s_mov_b32 s57, s21
    s_mov_b32 s58, 7077888
    s_mov_b32 s59, 0x20000
    s_add_u32 s52, s30, 5439488
    s_addc_u32 s53, s31, 0
    s_mov_b32 s54, 2211840
    s_mov_b32 s55, 0x20000
    s_add_u32 s60, s30, 2621440
    s_addc_u32 s61, s31, 0
    s_mov_b32 s62, 163840
    s_mov_b32 s63, 0x20000
    s_add_u32 s80, s30, 7667712
    s_addc_u32 s81, s31, 0
    s_mov_b32 s82, 819200
    s_mov_b32 s83, 0x20000
    v_bfe_u32 v12, v0, 4, 2
    v_lshlrev_b32 v12, 1, v12
    v_and_b32 v13, 7, v0
    v_xor_b32 v12, v12, v13
    v_lshrrev_b32 v11, 3, v0
    v_and_b32 v13, 4, v11
    v_add_u32 v11, v11, v13
    v_mul_u32_u24 v11, 3456, v11
    v_lshl_add_u32 v1, v12, 4, v11
    v_add_u32 v2, 54272, v1
    v_add_u32 v3, 11776, v1
    v_add_u32 v4, 66048, v1
    s_mul_i32 s66, s37, 110592
    s_lshl_b32 s36, s65, 7
    s_add_u32 s66, s66, s36
    s_mul_i32 s67, s37, 40960
    s_mul_i32 s36, s64, 5120
    s_add_u32 s67, s67, s36
    s_lshl_b32 s76, s37, 17
    s_lshl_b32 s36, s33, 7
    s_add_u32 s76, s76, s36
    s_mul_i32 s77, s37, 40960
    s_mul_i32 s36, s34, 5120
    s_add_u32 s77, s77, s36
    s_lshl_b32 s36, s34, 2
    s_add_u32 s36, s36, s37
    s_mul_i32 s84, s36, 25600
    s_mul_i32 s85, s36, 640
    s_add_u32 s85, s85, 163840
    s_mul_i32 s69, s37, 40960
    s_mul_i32 s70, s37, 5120
    s_and_b32 s36, s64, 3
    s_lshl_b32 s86, s35, 2
    s_add_u32 s86, s86, s36
    s_add_u32 s87, s64, 32
    s_cmp_eq_u32 s65, 27
    s_cselect_b32 s86, s87, s86
    s_lshl_b32 s36, s86, 2
    s_add_u32 s36, s36, s37
    s_lshl_b32 s39, s36, 13
    v_lshlrev_b32 v251, 7, v0
    s_lshl_b32 s36, s37, 2
    s_add_u32 s36, s36, 161872
    v_mov_b32 v250, s36
    v_mov_b32 v12, 161900
    s_mov_b32 s95, 0x400000
L_spin3:
    ds_read_b32 v13, v12
    s_waitcnt lgkmcnt(0)
    v_readfirstlane_b32 s94, v13
    s_nop 0
    s_cmp_ge_u32 s94, 4
    s_cbranch_scc1 L_spun3
    s_sleep 1
    s_sub_u32 s95, s95, 1
    s_cbranch_scc0 L_spin3
L_spun3:
    s_setprio 2
    s_mov_b32 exec_lo, 1
    s_mov_b32 exec_hi, 1
    buffer_store_dwordx2 v[56:57], v58, s[72:75], s89 offen offset:0 sc1
    s_mov_b64 exec, -1
    s_mov_b32 s95, 0x20000
L_poll4:
    buffer_load_dword v253, v252, s[72:75], s78 offen sc1
L_pollw4:
    s_waitcnt vmcnt(0)
    v_cmp_ne_u32 vcc, s3, v253
    s_nop 0
    s_cmp_eq_u64 vcc, 0
    s_cbranch_scc1 L_polled4
    s_sleep 4
    s_sub_u32 s95, s95, 1
    s_cbranch_scc0 L_poll4
L_polled4:
    s_add_u32 m0, s70, 20480
    s_add_u32 s68, s69, 0
    buffer_load_dwordx4 v9, s[60:63], s68 offen offset:0 sc1 lds
    buffer_load_dwordx4 v9, s[60:63], s68 offen offset:1024 sc1 lds
    buffer_load_dwordx4 v9, s[60:63], s68 offen offset:2048 sc1 lds
    buffer_load_dwordx4 v9, s[60:63], s68 offen offset:3072 sc1 lds
    s_add_u32 m0, s70, 24576
    s_nop 0
    buffer_load_dwordx4 v10, s[60:63], s68 offen offset:0 sc1 lds
    s_xor_b32 s36, s88, 0
    s_lshl_b32 s36, s36, 5
    buffer_load_dwordx2 v[204:205], v15, s[48:51], s36 offen
    s_xor_b32 s36, s88, 1
    s_lshl_b32 s36, s36, 5
    buffer_load_dwordx2 v[206:207], v15, s[48:51], s36 offen
    s_xor_b32 s36, s88, 2
    s_lshl_b32 s36, s36, 5
    buffer_load_dwordx2 v[208:209], v15, s[48:51], s36 offen
    s_xor_b32 s36, s88, 3
    s_lshl_b32 s36, s36, 5
    buffer_load_dwordx2 v[210:211], v15, s[48:51], s36 offen
    v_min_u32 v252, 4, v0
    v_lshlrev_b32 v252, 7, v252
    s_waitcnt vmcnt(4)
    s_barrier
    s_add_u32 m0, s70, 122880
    s_add_u32 s68, s69, 5120
    buffer_load_dwordx4 v9, s[60:63], s68 offen offset:0 sc1 lds
    buffer_load_dwordx4 v9, s[60:63], s68 offen offset:1024 sc1 lds
    buffer_load_dwordx4 v9, s[60:63], s68 offen offset:2048 sc1 lds
    buffer_load_dwordx4 v9, s[60:63], s68 offen offset:3072 sc1 lds
    s_add_u32 m0, s70, 126976
    s_nop 0
    buffer_load_dwordx4 v10, s[60:63], s68 offen offset:0 sc1 lds
    s_cmp_ge_u32 s65, 27
    s_cbranch_scc1 L_nog1
    s_add_u32 m0, s38, 0
    s_nop 0
    buffer_load_dwordx4 v1, s[40:43], s66 offen offset:0 lds
    buffer_load_dwordx4 v2, s[40:43], s66 offen offset:1024 lds
    buffer_load_dwordx4 v3, s[40:43], s66 offen offset:2048 lds
    buffer_load_dwordx4 v4, s[40:43], s66 offen offset:3072 lds
    buffer_load_dwordx4 v[96:99], v9, s[44:47], s67 offen offset:0 sc1
    buffer_load_dwordx4 v[100:103], v9, s[44:47], s67 offen offset:1024 sc1
    buffer_load_dwordx4 v[104:107], v9, s[44:47], s67 offen offset:2048 sc1
    buffer_load_dwordx4 v[108:111], v9, s[44:47], s67 offen offset:3072 sc1
    buffer_load_dwordx4 v[112:115], v10, s[44:47], s67 offen offset:0 sc1
    v_mov_b32 v13, 1
    s_waitcnt vmcnt(9)
    ds_write_b32 v250, v13
    s_add_u32 m0, s38, 4096
    s_add_u32 s66, s66, 442368
    buffer_load_dwordx4 v1, s[40:43], s66 offen offset:0 lds
    buffer_load_dwordx4 v2, s[40:43], s66 offen offset:1024 lds
    buffer_load_dwordx4 v3, s[40:43], s66 offen offset:2048 lds
    buffer_load_dwordx4 v4, s[40:43], s66 offen offset:3072 lds
    s_add_u32 s67, s67, 163840
    buffer_load_dwordx4 v[116:119], v9, s[44:47], s67 offen offset:0 sc1
    buffer_load_dwordx4 v[120:123], v9, s[44:47], s67 offen offset:1024 sc1
    buffer_load_dwordx4 v[124:127], v9, s[44:47], s67 offen offset:2048 sc1
    buffer_load_dwordx4 v[128:131], v9, s[44:47], s67 offen offset:3072 sc1
    buffer_load_dwordx4 v[132:135], v10, s[44:47], s67 offen offset:0 sc1
    v_mov_b32 v12, 161820
    s_mov_b32 s95, 0x400000
L_spin5:
    ds_read_b32 v13, v12
    s_waitcnt lgkmcnt(0)
    v_readfirstlane_b32 s94, v13
    s_nop 0
    s_cmp_ge_u32 s94, 4
    s_cbranch_scc1 L_spun5
    s_sub_u32 s95, s95, 1
    s_cbranch_scc0 L_spin5
L_spun5:
    s_add_u32 m0, s70, 20480
    s_add_u32 s68, s69, 10240
    buffer_load_dwordx4 v9, s[60:63], s68 offen offset:0 sc1 lds
    buffer_load_dwordx4 v9, s[60:63], s68 offen offset:1024 sc1 lds
    buffer_load_dwordx4 v9, s[60:63], s68 offen offset:2048 sc1 lds
    buffer_load_dwordx4 v9, s[60:63], s68 offen offset:3072 sc1 lds
    s_add_u32 m0, s70, 24576
    s_nop 0
    buffer_load_dwordx4 v10, s[60:63], s68 offen offset:0 sc1 lds
    s_add_u32 s67, s67, 163840
    buffer_load_dwordx4 v[136:139], v9, s[44:47], s67 offen offset:0 sc1
    buffer_load_dwordx4 v[140:143], v9, s[44:47], s67 offen offset:1024 sc1
    buffer_load_dwordx4 v[144:147], v9, s[44:47], s67 offen offset:2048 sc1
    buffer_load_dwordx4 v[148:151], v9, s[44:47], s67 offen offset:3072 sc1
    buffer_load_dwordx4 v[152:155], v10, s[44:47], s67 offen offset:0 sc1
    v_lshlrev_b32 v188, 16, v204
    v_and_b32 v189, 0xffff0000, v204
    v_lshlrev_b32 v190, 16, v205
    v_and_b32 v191, 0xffff0000, v205
    v_lshlrev_b32 v192, 16, v206
    v_and_b32 v193, 0xffff0000, v206
    v_lshlrev_b32 v194, 16, v207
    v_and_b32 v195, 0xffff0000, v207
    v_lshlrev_b32 v196, 16, v208
    v_and_b32 v197, 0xffff0000, v208
    v_lshlrev_b32 v198, 16, v209
    v_and_b32 v199, 0xffff0000, v209
    v_lshlrev_b32 v200, 16, v210
    v_and_b32 v201, 0xffff0000, v210
    v_lshlrev_b32 v202, 16, v211
    v_and_b32 v203, 0xffff0000, v211
    v_mul_f32 v188, 0x3e800000, v188
    v_mul_f32 v189, 0x3e800000, v189
    v_mul_f32 v190, 0x3e800000, v190
    v_mul_f32 v191, 0x3e800000, v191
    v_mul_f32 v192, 0x3e800000, v192
    v_mul_f32 v193, 0x3e800000, v193
    v_mul_f32 v194, 0x3e800000, v194
    v_mul_f32 v195, 0x3e800000, v195
    v_mul_f32 v196, 0x3e800000, v196
    v_mul_f32 v197, 0x3e800000, v197
    v_mul_f32 v198, 0x3e800000, v198
    v_mul_f32 v199, 0x3e800000, v199
    v_mul_f32 v200, 0x3e800000, v200
    v_mul_f32 v201, 0x3e800000, v201
    v_mul_f32 v202, 0x3e800000, v202
    v_mul_f32 v203, 0x3e800000, v203
    s_waitcnt vmcnt(24)
    ds_read_b64_tr_b16 v[156:157], v5 offset:0
    ds_read_b64_tr_b16 v[158:159], v5 offset:2048
    ds_read_b64_tr_b16 v[160:161], v6 offset:0
    ds_read_b64_tr_b16 v[162:163], v6 offset:2048
    ds_read_b64_tr_b16 v[164:165], v7 offset:0
    ds_read_b64_tr_b16 v[166:167], v7 offset:2048
    ds_read_b64_tr_b16 v[168:169], v8 offset:0
    ds_read_b64_tr_b16 v[170:171], v8 offset:2048
    s_waitcnt vmcnt(19) lgkmcnt(0)
    s_add_u32 m0, s38, 0
    s_add_u32 s66, s66, 442368
    buffer_load_dwordx4 v1, s[40:43], s66 offen offset:0 lds
    s_setprio 0
    v_mfma_f32_16x16x32_bf16 v[16:19], v[156:159], v[96:99], v[188:191]
    s_setprio 2
    v_mfma_f32_16x16x32_bf16 v[20:23], v[160:163], v[96:99], v[192:195]
    buffer_load_dwordx4 v2, s[40:43], s66 offen offset:1024 lds
    s_setprio 0
    v_mfma_f32_16x16x32_bf16 v[24:27], v[164:167], v[96:99], v[196:199]
    s_setprio 2
    v_mfma_f32_16x16x32_bf16 v[28:31], v[168:171], v[96:99], v[200:203]
    buffer_load_dwordx4 v3, s[40:43], s66 offen offset:2048 lds
    s_setprio 0
    v_mfma_f32_16x16x32_bf16 v[44:47], v[168:171], v[100:103], v[200:203]
    s_setprio 2
    v_mfma_f32_16x16x32_bf16 v[40:43], v[164:167], v[100:103], v[196:199]
    buffer_load_dwordx4 v4, s[40:43], s66 offen offset:3072 lds
    s_setprio 0
    v_mfma_f32_16x16x32_bf16 v[36:39], v[160:163], v[100:103], v[192:195]
    s_setprio 2
    v_mfma_f32_16x16x32_bf16 v[32:35], v[156:159], v[100:103], v[188:191]
    s_add_u32 s67, s67, 163840
    buffer_load_dwordx4 v[96:99], v9, s[44:47], s67 offen offset:0 sc1
    s_setprio 0
    v_mfma_f32_16x16x32_bf16 v[48:51], v[156:159], v[104:107], v[188:191]
    s_setprio 2
    v_mfma_f32_16x16x32_bf16 v[52:55], v[160:163], v[104:107], v[192:195]
    buffer_load_dwordx4 v[100:103], v9, s[44:47], s67 offen offset:1024 sc1
    s_setprio 0
    v_mfma_f32_16x16x32_bf16 v[56:59], v[164:167], v[104:107], v[196:199]
    s_setprio 2
    v_mfma_f32_16x16x32_bf16 v[60:63], v[168:171], v[104:107], v[200:203]
    s_waitcnt vmcnt(21)
    ds_read_b64_tr_b16 v[172:173], v5 offset:4096
    ds_read_b64_tr_b16 v[174:175], v5 offset:6144
    buffer_load_dwordx4 v[104:107], v9, s[44:47], s67 offen offset:2048 sc1
    s_setprio 0
    v_mfma_f32_16x16x32_bf16 v[76:79], v[168:171], v[108:111], v[200:203]
    s_setprio 2
    v_mfma_f32_16x16x32_bf16 v[72:75], v[164:167], v[108:111], v[196:199]
    ds_read_b64_tr_b16 v[176:177], v6 offset:4096
    ds_read_b64_tr_b16 v[178:179], v6 offset:6144
    s_setprio 0
    v_mfma_f32_16x16x32_bf16 v[68:71], v[160:163], v[108:111], v[192:195]
    s_setprio 2
    v_mfma_f32_16x16x32_bf16 v[64:67], v[156:159], v[108:111], v[188:191]
    ds_read_b64_tr_b16 v[180:181], v7 offset:4096
    ds_read_b64_tr_b16 v[182:183], v7 offset:6144
    buffer_load_dwordx4 v[108:111], v9, s[44:47], s67 offen offset:3072 sc1
    s_setprio 0
    v_mfma_f32_16x16x32_bf16 v[80:83], v[156:159], v[112:115], v[188:191]
    s_setprio 2
    v_mfma_f32_16x16x32_bf16 v[84:87], v[160:163], v[112:115], v[192:195]
    ds_read_b64_tr_b16 v[184:185], v8 offset:4096
    ds_read_b64_tr_b16 v[186:187], v8 offset:6144
    s_setprio 0
    v_mfma_f32_16x16x32_bf16 v[88:91], v[164:167], v[112:115], v[196:199]
    s_setprio 2
    v_mfma_f32_16x16x32_bf16 v[92:95], v[168:171], v[112:115], v[200:203]
    buffer_load_dwordx4 v[112:115], v10, s[44:47], s67 offen offset:0 sc1
    s_waitcnt vmcnt(19) lgkmcnt(0)
    s_add_u32 m0, s38, 4096
    s_add_u32 s66, s66, 442368
    buffer_load_dwordx4 v1, s[40:43], s66 offen offset:0 lds
    s_setprio 0
    v_mfma_f32_16x16x32_bf16 v[16:19], v[172:175], v[116:119], v[16:19]
    s_setprio 2
    v_mfma_f32_16x16x32_bf16 v[20:23], v[176:179], v[116:119], v[20:23]
    buffer_load_dwordx4 v2, s[40:43], s66 offen offset:1024 lds
    s_setprio 0
    v_mfma_f32_16x16x32_bf16 v[24:27], v[180:183], v[116:119], v[24:27]
    s_setprio 2
    v_mfma_f32_16x16x32_bf16 v[28:31], v[184:187], v[116:119], v[28:31]
    buffer_load_dwordx4 v3, s[40:43], s66 offen offset:2048 lds
    s_setprio 0
    v_mfma_f32_16x16x32_bf16 v[44:47], v[184:187], v[120:123], v[44:47]
    s_setprio 2
    v_mfma_f32_16x16x32_bf16 v[40:43], v[180:183], v[120:123], v[40:43]
    buffer_load_dwordx4 v4, s[40:43], s66 offen offset:3072 lds
    s_setprio 0
    v_mfma_f32_16x16x32_bf16 v[36:39], v[176:179], v[120:123], v[36:39]
    s_setprio 2
    v_mfma_f32_16x16x32_bf16 v[32:35], v[172:175], v[120:123], v[32:35]
    s_add_u32 s67, s67, 163840
    buffer_load_dwordx4 v[116:119], v9, s[44:47], s67 offen offset:0 sc1
    s_setprio 0
    v_mfma_f32_16x16x32_bf16 v[48:51], v[172:175], v[124:127], v[48:51]
    s_setprio 2
    v_mfma_f32_16x16x32_bf16 v[52:55], v[176:179], v[124:127], v[52:55]
    buffer_load_dwordx4 v[120:123], v9, s[44:47], s67 offen offset:1024 sc1
    s_setprio 0
    v_mfma_f32_16x16x32_bf16 v[56:59], v[180:183], v[124:127], v[56:59]
    s_setprio 2
    v_mfma_f32_16x16x32_bf16 v[60:63], v[184:187], v[124:127], v[60:63]
    s_waitcnt vmcnt(11)
    ds_read_b64_tr_b16 v[156:157], v5 offset:0
    ds_read_b64_tr_b16 v[158:159], v5 offset:2048
    buffer_load_dwordx4 v[124:127], v9, s[44:47], s67 offen offset:2048 sc1
    v_mov_b32 v13, 2
    ds_write_b32 v250, v13
    s_setprio 0
    v_mfma_f32_16x16x32_bf16 v[76:79], v[184:187], v[128:131], v[76:79]
    s_setprio 2
    v_mfma_f32_16x16x32_bf16 v[72:75], v[180:183], v[128:131], v[72:75]
    ds_read_b64_tr_b16 v[160:161], v6 offset:0
    ds_read_b64_tr_b16 v[162:163], v6 offset:2048
    s_add_u32 m0, s70, 40960
    s_add_u32 s68, s69, 15360
    buffer_load_dwordx4 v9, s[60:63], s68 offen offset:0 sc1 lds
    s_setprio 0
    v_mfma_f32_16x16x32_bf16 v[68:71], v[176:179], v[128:131], v[68:71]
    s_setprio 2
    v_mfma_f32_16x16x32_bf16 v[64:67], v[172:175], v[128:131], v[64:67]
    ds_read_b64_tr_b16 v[164:165], v7 offset:0
    ds_read_b64_tr_b16 v[166:167], v7 offset:2048
    buffer_load_dwordx4 v[128:131], v9, s[44:47], s67 offen offset:3072 sc1
    s_setprio 0
    v_mfma_f32_16x16x32_bf16 v[80:83], v[172:175], v[132:135], v[80:83]
    s_setprio 2
    v_mfma_f32_16x16x32_bf16 v[84:87], v[176:179], v[132:135], v[84:87]
    ds_read_b64_tr_b16 v[168:169], v8 offset:0
    ds_read_b64_tr_b16 v[170:171], v8 offset:2048
    s_add_u32 m0, s70, 40960
    s_nop 0
    buffer_load_dwordx4 v9, s[60:63], s68 offen offset:1024 sc1 lds
    s_setprio 0
    v_mfma_f32_16x16x32_bf16 v[88:91], v[180:183], v[132:135], v[88:91]
    s_setprio 2
    v_mfma_f32_16x16x32_bf16 v[92:95], v[184:187], v[132:135], v[92:95]
    buffer_load_dwordx4 v[132:135], v10, s[44:47], s67 offen offset:0 sc1
    s_waitcnt lgkmcnt(0)
    s_add_u32 m0, s38, 0
    s_add_u32 s66, s66, 442368
    buffer_load_dwordx4 v1, s[40:43], s66 offen offset:0 lds
    s_setprio 0
    v_mfma_f32_16x16x32_bf16 v[16:19], v[156:159], v[136:139], v[16:19]
    s_setprio 2
    v_mfma_f32_16x16x32_bf16 v[20:23], v[160:163], v[136:139], v[20:23]
    buffer_load_dwordx4 v2, s[40:43], s66 offen offset:1024 lds
    s_setprio 0
    v_mfma_f32_16x16x32_bf16 v[24:27], v[164:167], v[136:139], v[24:27]
    s_setprio 2
    v_mfma_f32_16x16x32_bf16 v[28:31], v[168:171], v[136:139], v[28:31]
    buffer_load_dwordx4 v3, s[40:43], s66 offen offset:2048 lds
    s_setprio 0
    v_mfma_f32_16x16x32_bf16 v[44:47], v[168:171], v[140:143], v[44:47]
    s_setprio 2
    v_mfma_f32_16x16x32_bf16 v[40:43], v[164:167], v[140:143], v[40:43]
    buffer_load_dwordx4 v4, s[40:43], s66 offen offset:3072 lds
    s_setprio 0
    v_mfma_f32_16x16x32_bf16 v[36:39], v[160:163], v[140:143], v[36:39]
    s_setprio 2
    v_mfma_f32_16x16x32_bf16 v[32:35], v[156:159], v[140:143], v[32:35]
    s_add_u32 s67, s67, 163840
    buffer_load_dwordx4 v[136:139], v9, s[44:47], s67 offen offset:0 sc1
    s_setprio 0
    v_mfma_f32_16x16x32_bf16 v[48:51], v[156:159], v[144:147], v[48:51]
    s_setprio 2
    v_mfma_f32_16x16x32_bf16 v[52:55], v[160:163], v[144:147], v[52:55]
    buffer_load_dwordx4 v[140:143], v9, s[44:47], s67 offen offset:1024 sc1
    s_setprio 0
    v_mfma_f32_16x16x32_bf16 v[56:59], v[164:167], v[144:147], v[56:59]
    s_setprio 2
    v_mfma_f32_16x16x32_bf16 v[60:63], v[168:171], v[144:147], v[60:63]
    s_waitcnt vmcnt(13)
    ds_read_b64_tr_b16 v[172:173], v5 offset:4096
    ds_read_b64_tr_b16 v[174:175], v5 offset:6144
    buffer_load_dwordx4 v[144:147], v9, s[44:47], s67 offen offset:2048 sc1
    s_setprio 0
    v_mfma_f32_16x16x32_bf16 v[76:79], v[168:171], v[148:151], v[76:79]
    s_setprio 2
    v_mfma_f32_16x16x32_bf16 v[72:75], v[164:167], v[148:151], v[72:75]
    ds_read_b64_tr_b16 v[176:177], v6 offset:4096
    ds_read_b64_tr_b16 v[178:179], v6 offset:6144
    s_add_u32 m0, s70, 40960
    s_nop 0
    buffer_load_dwordx4 v9, s[60:63], s68 offen offset:2048 sc1 lds
    s_setprio 0
    v_mfma_f32_16x16x32_bf16 v[68:71], v[160:163], v[148:151], v[68:71]
    s_setprio 2
    v_mfma_f32_16x16x32_bf16 v[64:67], v[156:159], v[148:151], v[64:67]
    ds_read_b64_tr_b16 v[180:181], v7 offset:4096
    ds_read_b64_tr_b16 v[182:183], v7 offset:6144
    buffer_load_dwordx4 v[148:151], v9, s[44:47], s67 offen offset:3072 sc1
    s_setprio 0
    v_mfma_f32_16x16x32_bf16 v[80:83], v[156:159], v[152:155], v[80:83]
    s_setprio 2
    v_mfma_f32_16x16x32_bf16 v[84:87], v[160:163], v[152:155], v[84:87]
    ds_read_b64_tr_b16 v[184:185], v8 offset:4096
    ds_read_b64_tr_b16 v[186:187], v8 offset:6144
    s_add_u32 m0, s70, 40960
    s_nop 0
    buffer_load_dwordx4 v9, s[60:63], s68 offen offset:3072 sc1 lds
    s_setprio 0
    v_mfma_f32_16x16x32_bf16 v[88:91], v[164:167], v[152:155], v[88:91]
    s_setprio 2
    v_mfma_f32_16x16x32_bf16 v[92:95], v[168:171], v[152:155], v[92:95]
    buffer_load_dwordx4 v[152:155], v10, s[44:47], s67 offen offset:0 sc1
    s_waitcnt lgkmcnt(0)
    s_add_u32 m0, s38, 4096
    s_add_u32 s66, s66, 442368
    buffer_load_dwordx4 v1, s[40:43], s66 offen offset:0 lds
    s_setprio 0
    v_mfma_f32_16x16x32_bf16 v[16:19], v[172:175], v[96:99], v[16:19]
    s_setprio 2
    v_mfma_f32_16x16x32_bf16 v[20:23], v[176:179], v[96:99], v[20:23]
    buffer_load_dwordx4 v2, s[40:43], s66 offen offset:1024 lds
    s_setprio 0
    v_mfma_f32_16x16x32_bf16 v[24:27], v[180:183], v[96:99], v[24:27]
    s_setprio 2
    v_mfma_f32_16x16x32_bf16 v[28:31], v[184:187], v[96:99], v[28:31]
    buffer_load_dwordx4 v3, s[40:43], s66 offen offset:2048 lds
    s_setprio 0
    v_mfma_f32_16x16x32_bf16 v[44:47], v[184:187], v[100:103], v[44:47]
    s_setprio 2
    v_mfma_f32_16x16x32_bf16 v[40:43], v[180:183], v[100:103], v[40:43]
    buffer_load_dwordx4 v4, s[40:43], s66 offen offset:3072 lds
    s_setprio 0
    v_mfma_f32_16x16x32_bf16 v[36:39], v[176:179], v[100:103], v[36:39]
    s_setprio 2
    v_mfma_f32_16x16x32_bf16 v[32:35], v[172:175], v[100:103], v[32:35]
    s_add_u32 s67, s67, 163840
    buffer_load_dwordx4 v[96:99], v9, s[44:47], s67 offen offset:0 sc1
    s_setprio 0
    v_mfma_f32_16x16x32_bf16 v[48:51], v[172:175], v[104:107], v[48:51]
    s_setprio 2
    v_mfma_f32_16x16x32_bf16 v[52:55], v[176:179], v[104:107], v[52:55]
    buffer_load_dwordx4 v[100:103], v9, s[44:47], s67 offen offset:1024 sc1
    s_setprio 0
    v_mfma_f32_16x16x32_bf16 v[56:59], v[180:183], v[104:107], v[56:59]
    s_setprio 2
    v_mfma_f32_16x16x32_bf16 v[60:63], v[184:187], v[104:107], v[60:63]
    s_waitcnt vmcnt(13)
    ds_read_b64_tr_b16 v[156:157], v5 offset:0
    ds_read_b64_tr_b16 v[158:159], v5 offset:2048
    buffer_load_dwordx4 v[104:107], v9, s[44:47], s67 offen offset:2048 sc1
    s_setprio 0
    v_mfma_f32_16x16x32_bf16 v[76:79], v[184:187], v[108:111], v[76:79]
    s_setprio 2
    v_mfma_f32_16x16x32_bf16 v[72:75], v[180:183], v[108:111], v[72:75]
    ds_read_b64_tr_b16 v[160:161], v6 offset:0
    ds_read_b64_tr_b16 v[162:163], v6 offset:2048
    s_add_u32 m0, s70, 45056
    s_nop 0
    buffer_load_dwordx4 v10, s[60:63], s68 offen offset:0 sc1 lds
    s_setprio 0
    v_mfma_f32_16x16x32_bf16 v[68:71], v[176:179], v[108:111], v[68:71]
    s_setprio 2
    v_mfma_f32_16x16x32_bf16 v[64:67], v[172:175], v[108:111], v[64:67]
    ds_read_b64_tr_b16 v[164:165], v7 offset:0
    ds_read_b64_tr_b16 v[166:167], v7 offset:2048
    buffer_load_dwordx4 v[108:111], v9, s[44:47], s67 offen offset:3072 sc1
    s_setprio 0
    v_mfma_f32_16x16x32_bf16 v[80:83], v[172:175], v[112:115], v[80:83]
    s_setprio 2
    v_mfma_f32_16x16x32_bf16 v[84:87], v[176:179], v[112:115], v[84:87]
    ds_read_b64_tr_b16 v[168:169], v8 offset:0
    ds_read_b64_tr_b16 v[170:171], v8 offset:2048
    s_add_u32 m0, s70, 61440
    s_add_u32 s68, s69, 20480
    buffer_load_dwordx4 v9, s[60:63], s68 offen offset:0 sc1 lds
    s_setprio 0
    v_mfma_f32_16x16x32_bf16 v[88:91], v[180:183], v[112:115], v[88:91]
    s_setprio 2
    v_mfma_f32_16x16x32_bf16 v[92:95], v[184:187], v[112:115], v[92:95]
    buffer_load_dwordx4 v[112:115], v10, s[44:47], s67 offen offset:0 sc1
    s_waitcnt lgkmcnt(0)
    s_add_u32 m0, s38, 0
    s_add_u32 s66, s66, 442368
    buffer_load_dwordx4 v1, s[40:43], s66 offen offset:0 lds
    s_setprio 0
    v_mfma_f32_16x16x32_bf16 v[16:19], v[156:159], v[116:119], v[16:19]
    s_setprio 2
    v_mfma_f32_16x16x32_bf16 v[20:23], v[160:163], v[116:119], v[20:23]
    buffer_load_dwordx4 v2, s[40:43], s66 offen offset:1024 lds
    s_setprio 0
    v_mfma_f32_16x16x32_bf16 v[24:27], v[164:167], v[116:119], v[24:27]
    s_setprio 2
    v_mfma_f32_16x16x32_bf16 v[28:31], v[168:171], v[116:119], v[28:31]
    buffer_load_dwordx4 v3, s[40:43], s66 offen offset:2048 lds
    s_setprio 0
    v_mfma_f32_16x16x32_bf16 v[44:47], v[168:171], v[120:123], v[44:47]
    s_setprio 2
    v_mfma_f32_16x16x32_bf16 v[40:43], v[164:167], v[120:123], v[40:43]
    buffer_load_dwordx4 v4, s[40:43], s66 offen offset:3072 lds
    s_setprio 0
    v_mfma_f32_16x16x32_bf16 v[36:39], v[160:163], v[120:123], v[36:39]
    s_setprio 2
    v_mfma_f32_16x16x32_bf16 v[32:35], v[156:159], v[120:123], v[32:35]
    s_add_u32 s67, s67, 163840
    buffer_load_dwordx4 v[116:119], v9, s[44:47], s67 offen offset:0 sc1
    s_setprio 0
    v_mfma_f32_16x16x32_bf16 v[48:51], v[156:159], v[124:127], v[48:51]
    s_setprio 2
    v_mfma_f32_16x16x32_bf16 v[52:55], v[160:163], v[124:127], v[52:55]
    buffer_load_dwordx4 v[120:123], v9, s[44:47], s67 offen offset:1024 sc1
    s_setprio 0
    v_mfma_f32_16x16x32_bf16 v[56:59], v[164:167], v[124:127], v[56:59]
    s_setprio 2
    v_mfma_f32_16x16x32_bf16 v[60:63], v[168:171], v[124:127], v[60:63]
    s_waitcnt vmcnt(13)
    ds_read_b64_tr_b16 v[172:173], v5 offset:4096
    ds_read_b64_tr_b16 v[174:175], v5 offset:6144
    buffer_load_dwordx4 v[124:127], v9, s[44:47], s67 offen offset:2048 sc1
    s_setprio 0
    v_mfma_f32_16x16x32_bf16 v[76:79], v[168:171], v[128:131], v[76:79]
    s_setprio 2
    v_mfma_f32_16x16x32_bf16 v[72:75], v[164:167], v[128:131], v[72:75]
    ds_read_b64_tr_b16 v[176:177], v6 offset:4096
    ds_read_b64_tr_b16 v[178:179], v6 offset:6144
    s_add_u32 m0, s70, 61440
    s_nop 0
    buffer_load_dwordx4 v9, s[60:63], s68 offen offset:1024 sc1 lds
    s_setprio 0
    v_mfma_f32_16x16x32_bf16 v[68:71], v[160:163], v[128:131], v[68:71]
    s_setprio 2
    v_mfma_f32_16x16x32_bf16 v[64:67], v[156:159], v[128:131], v[64:67]
    ds_read_b64_tr_b16 v[180:181], v7 offset:4096
    ds_read_b64_tr_b16 v[182:183], v7 offset:6144
    buffer_load_dwordx4 v[128:131], v9, s[44:47], s67 offen offset:3072 sc1
    s_setprio 0
    v_mfma_f32_16x16x32_bf16 v[80:83], v[156:159], v[132:135], v[80:83]
    s_setprio 2
    v_mfma_f32_16x16x32_bf16 v[84:87], v[160:163], v[132:135], v[84:87]
    ds_read_b64_tr_b16 v[184:185], v8 offset:4096
    ds_read_b64_tr_b16 v[186:187], v8 offset:6144
    s_add_u32 m0, s70, 61440
    s_nop 0
    buffer_load_dwordx4 v9, s[60:63], s68 offen offset:2048 sc1 lds
    s_setprio 0
    v_mfma_f32_16x16x32_bf16 v[88:91], v[164:167], v[132:135], v[88:91]
    s_setprio 2
    v_mfma_f32_16x16x32_bf16 v[92:95], v[168:171], v[132:135], v[92:95]
    buffer_load_dwordx4 v[132:135], v10, s[44:47], s67 offen offset:0 sc1
    s_waitcnt lgkmcnt(0)
    s_add_u32 m0, s38, 4096
    s_add_u32 s66, s66, 442368
    buffer_load_dwordx4 v1, s[40:43], s66 offen offset:0 lds
    s_setprio 0
    v_mfma_f32_16x16x32_bf16 v[16:19], v[172:175], v[136:139], v[16:19]
    s_setprio 2
    v_mfma_f32_16x16x32_bf16 v[20:23], v[176:179], v[136:139], v[20:23]
    buffer_load_dwordx4 v2, s[40:43], s66 offen offset:1024 lds
    s_setprio 0
    v_mfma_f32_16x16x32_bf16 v[24:27], v[180:183], v[136:139], v[24:27]
    s_setprio 2
    v_mfma_f32_16x16x32_bf16 v[28:31], v[184:187], v[136:139], v[28:31]
    buffer_load_dwordx4 v3, s[40:43], s66 offen offset:2048 lds
    s_setprio 0
    v_mfma_f32_16x16x32_bf16 v[44:47], v[184:187], v[140:143], v[44:47]
    s_setprio 2
    v_mfma_f32_16x16x32_bf16 v[40:43], v[180:183], v[140:143], v[40:43]
    buffer_load_dwordx4 v4, s[40:43], s66 offen offset:3072 lds
    s_setprio 0
    v_mfma_f32_16x16x32_bf16 v[36:39], v[176:179], v[140:143], v[36:39]
    s_setprio 2
    v_mfma_f32_16x16x32_bf16 v[32:35], v[172:175], v[140:143], v[32:35]
    s_add_u32 s67, s67, 163840
    buffer_load_dwordx4 v[136:139], v9, s[44:47], s67 offen offset:0 sc1
    s_setprio 0
    v_mfma_f32_16x16x32_bf16 v[48:51], v[172:175], v[144:147], v[48:51]
    s_setprio 2
    v_mfma_f32_16x16x32_bf16 v[52:55], v[176:179], v[144:147], v[52:55]
    buffer_load_dwordx4 v[140:143], v9, s[44:47], s67 offen offset:1024 sc1
    s_setprio 0
    v_mfma_f32_16x16x32_bf16 v[56:59], v[180:183], v[144:147], v[56:59]
    s_setprio 2
    v_mfma_f32_16x16x32_bf16 v[60:63], v[184:187], v[144:147], v[60:63]
    s_waitcnt vmcnt(13)
    ds_read_b64_tr_b16 v[156:157], v5 offset:0
    ds_read_b64_tr_b16 v[158:159], v5 offset:2048
    buffer_load_dwordx4 v[144:147], v9, s[44:47], s67 offen offset:2048 sc1
    v_mov_b32 v13, 3
    ds_write_b32 v250, v13
    s_setprio 0
    v_mfma_f32_16x16x32_bf16 v[76:79], v[184:187], v[148:151], v[76:79]
    s_setprio 2
    v_mfma_f32_16x16x32_bf16 v[72:75], v[180:183], v[148:151], v[72:75]
    ds_read_b64_tr_b16 v[160:161], v6 offset:0
    ds_read_b64_tr_b16 v[162:163], v6 offset:2048
    s_add_u32 m0, s70, 61440
    s_nop 0
    buffer_load_dwordx4 v9, s[60:63], s68 offen offset:3072 sc1 lds
    s_setprio 0
    v_mfma_f32_16x16x32_bf16 v[68:71], v[176:179], v[148:151], v[68:71]
    s_setprio 2
    v_mfma_f32_16x16x32_bf16 v[64:67], v[172:175], v[148:151], v[64:67]
    ds_read_b64_tr_b16 v[164:165], v7 offset:0
    ds_read_b64_tr_b16 v[166:167], v7 offset:2048
    buffer_load_dwordx4 v[148:151], v9, s[44:47], s67 offen offset:3072 sc1
    s_setprio 0
    v_mfma_f32_16x16x32_bf16 v[80:83], v[172:175], v[152:155], v[80:83]
    s_setprio 2
    v_mfma_f32_16x16x32_bf16 v[84:87], v[176:179], v[152:155], v[84:87]
    ds_read_b64_tr_b16 v[168:169], v8 offset:0
    ds_read_b64_tr_b16 v[170:171], v8 offset:2048
    s_add_u32 m0, s70, 65536
    s_nop 0
    buffer_load_dwordx4 v10, s[60:63], s68 offen offset:0 sc1 lds
    s_setprio 0
    v_mfma_f32_16x16x32_bf16 v[88:91], v[180:183], v[152:155], v[88:91]
    s_setprio 2
    v_mfma_f32_16x16x32_bf16 v[92:95], v[184:187], v[152:155], v[92:95]
    buffer_load_dwordx4 v[152:155], v10, s[44:47], s67 offen offset:0 sc1
    s_waitcnt lgkmcnt(0)
    s_add_u32 m0, s38, 0
    s_add_u32 s66, s66, 442368
    buffer_load_dwordx4 v1, s[40:43], s66 offen offset:0 lds
    s_setprio 0
    v_mfma_f32_16x16x32_bf16 v[16:19], v[156:159], v[96:99], v[16:19]
    s_setprio 2
    v_mfma_f32_16x16x32_bf16 v[20:23], v[160:163], v[96:99], v[20:23]
    buffer_load_dwordx4 v2, s[40:43], s66 offen offset:1024 lds
    s_setprio 0
    v_mfma_f32_16x16x32_bf16 v[24:27], v[164:167], v[96:99], v[24:27]
    s_setprio 2
    v_mfma_f32_16x16x32_bf16 v[28:31], v[168:171], v[96:99], v[28:31]
    buffer_load_dwordx4 v3, s[40:43], s66 offen offset:2048 lds
    s_setprio 0
    v_mfma_f32_16x16x32_bf16 v[44:47], v[168:171], v[100:103], v[44:47]
    s_setprio 2
    v_mfma_f32_16x16x32_bf16 v[40:43], v[164:167], v[100:103], v[40:43]
    buffer_load_dwordx4 v4, s[40:43], s66 offen offset:3072 lds
    s_setprio 0
    v_mfma_f32_16x16x32_bf16 v[36:39], v[160:163], v[100:103], v[36:39]
    s_setprio 2
    v_mfma_f32_16x16x32_bf16 v[32:35], v[156:159], v[100:103], v[32:35]
    s_add_u32 s67, s67, 163840
    buffer_load_dwordx4 v[96:99], v9, s[44:47], s67 offen offset:0 sc1
    s_setprio 0
    v_mfma_f32_16x16x32_bf16 v[48:51], v[156:159], v[104:107], v[48:51]
    s_setprio 2
    v_mfma_f32_16x16x32_bf16 v[52:55], v[160:163], v[104:107], v[52:55]
    buffer_load_dwordx4 v[100:103], v9, s[44:47], s67 offen offset:1024 sc1
    s_setprio 0
    v_mfma_f32_16x16x32_bf16 v[56:59], v[164:167], v[104:107], v[56:59]
    s_setprio 2
    v_mfma_f32_16x16x32_bf16 v[60:63], v[168:171], v[104:107], v[60:63]
    s_waitcnt vmcnt(13)
    ds_read_b64_tr_b16 v[172:173], v5 offset:4096
    ds_read_b64_tr_b16 v[174:175], v5 offset:6144
    buffer_load_dwordx4 v[104:107], v9, s[44:47], s67 offen offset:2048 sc1
    s_setprio 0
    v_mfma_f32_16x16x32_bf16 v[76:79], v[168:171], v[108:111], v[76:79]
    s_setprio 2
    v_mfma_f32_16x16x32_bf16 v[72:75], v[164:167], v[108:111], v[72:75]
    ds_read_b64_tr_b16 v[176:177], v6 offset:4096
    ds_read_b64_tr_b16 v[178:179], v6 offset:6144
    s_add_u32 m0, s70, 81920
    s_add_u32 s68, s69, 25600
    buffer_load_dwordx4 v9, s[60:63], s68 offen offset:0 sc1 lds
    s_setprio 0
    v_mfma_f32_16x16x32_bf16 v[68:71], v[160:163], v[108:111], v[68:71]
    s_setprio 2
    v_mfma_f32_16x16x32_bf16 v[64:67], v[156:159], v[108:111], v[64:67]
    ds_read_b64_tr_b16 v[180:181], v7 offset:4096
    ds_read_b64_tr_b16 v[182:183], v7 offset:6144
    buffer_load_dwordx4 v[108:111], v9, s[44:47], s67 offen offset:3072 sc1
    s_setprio 0
    v_mfma_f32_16x16x32_bf16 v[80:83], v[156:159], v[112:115], v[80:83]
    s_setprio 2
    v_mfma_f32_16x16x32_bf16 v[84:87], v[160:163], v[112:115], v[84:87]
    ds_read_b64_tr_b16 v[184:185], v8 offset:4096
    ds_read_b64_tr_b16 v[186:187], v8 offset:6144
    s_add_u32 m0, s70, 81920
    s_nop 0
    buffer_load_dwordx4 v9, s[60:63], s68 offen offset:1024 sc1 lds
    s_setprio 0
    v_mfma_f32_16x16x32_bf16 v[88:91], v[164:167], v[112:115], v[88:91]
    s_setprio 2
    v_mfma_f32_16x16x32_bf16 v[92:95], v[168:171], v[112:115], v[92:95]
    buffer_load_dwordx4 v[112:115], v10, s[44:47], s67 offen offset:0 sc1
    s_waitcnt lgkmcnt(0)
    s_add_u32 m0, s38, 4096
    s_add_u32 s66, s66, 442368
    buffer_load_dwordx4 v1, s[40:43], s66 offen offset:0 lds
    s_setprio 0
    v_mfma_f32_16x16x32_bf16 v[16:19], v[172:175], v[116:119], v[16:19]
    s_setprio 2
    v_mfma_f32_16x16x32_bf16 v[20:23], v[176:179], v[116:119], v[20:23]
    buffer_load_dwordx4 v2, s[40:43], s66 offen offset:1024 lds
    s_setprio 0
    v_mfma_f32_16x16x32_bf16 v[24:27], v[180:183], v[116:119], v[24:27]
    s_setprio 2
    v_mfma_f32_16x16x32_bf16 v[28:31], v[184:187], v[116:119], v[28:31]
    buffer_load_dwordx4 v3, s[40:43], s66 offen offset:2048 lds
    s_setprio 0
    v_mfma_f32_16x16x32_bf16 v[44:47], v[184:187], v[120:123], v[44:47]
    s_setprio 2
    v_mfma_f32_16x16x32_bf16 v[40:43], v[180:183], v[120:123], v[40:43]
    buffer_load_dwordx4 v4, s[40:43], s66 offen offset:3072 lds
    s_setprio 0
    v_mfma_f32_16x16x32_bf16 v[36:39], v[176:179], v[120:123], v[36:39]
    s_setprio 2
    v_mfma_f32_16x16x32_bf16 v[32:35], v[172:175], v[120:123], v[32:35]
    s_add_u32 s67, s67, 163840
    buffer_load_dwordx4 v[116:119], v9, s[44:47], s67 offen offset:0 sc1
    s_setprio 0
    v_mfma_f32_16x16x32_bf16 v[48:51], v[172:175], v[124:127], v[48:51]
    s_setprio 2
    v_mfma_f32_16x16x32_bf16 v[52:55], v[176:179], v[124:127], v[52:55]
    buffer_load_dwordx4 v[120:123], v9, s[44:47], s67 offen offset:1024 sc1
    s_setprio 0
    v_mfma_f32_16x16x32_bf16 v[56:59], v[180:183], v[124:127], v[56:59]
    s_setprio 2
    v_mfma_f32_16x16x32_bf16 v[60:63], v[184:187], v[124:127], v[60:63]
    s_waitcnt vmcnt(13)
    ds_read_b64_tr_b16 v[156:157], v5 offset:0
    ds_read_b64_tr_b16 v[158:159], v5 offset:2048
    buffer_load_dwordx4 v[124:127], v9, s[44:47], s67 offen offset:2048 sc1
    v_mov_b32 v13, 4
    ds_write_b32 v250, v13
    s_setprio 0
    v_mfma_f32_16x16x32_bf16 v[76:79], v[184:187], v[128:131], v[76:79]
    s_setprio 2
    v_mfma_f32_16x16x32_bf16 v[72:75], v[180:183], v[128:131], v[72:75]
    ds_read_b64_tr_b16 v[160:161], v6 offset:0
    ds_read_b64_tr_b16 v[162:163], v6 offset:2048
    s_add_u32 m0, s70, 81920
    s_nop 0
    buffer_load_dwordx4 v9, s[60:63], s68 offen offset:2048 sc1 lds
    s_setprio 0
    v_mfma_f32_16x16x32_bf16 v[68:71], v[176:179], v[128:131], v[68:71]
    s_setprio 2
    v_mfma_f32_16x16x32_bf16 v[64:67], v[172:175], v[128:131], v[64:67]
    ds_read_b64_tr_b16 v[164:165], v7 offset:0
    ds_read_b64_tr_b16 v[166:167], v7 offset:2048
    buffer_load_dwordx4 v[128:131], v9, s[44:47], s67 offen offset:3072 sc1
    s_setprio 0
    v_mfma_f32_16x16x32_bf16 v[80:83], v[172:175], v[132:135], v[80:83]
    s_setprio 2
    v_mfma_f32_16x16x32_bf16 v[84:87], v[176:179], v[132:135], v[84:87]
    ds_read_b64_tr_b16 v[168:169], v8 offset:0
    ds_read_b64_tr_b16 v[170:171], v8 offset:2048
    s_add_u32 m0, s70, 81920
    s_nop 0
    buffer_load_dwordx4 v9, s[60:63], s68 offen offset:3072 sc1 lds
    s_setprio 0
    v_mfma_f32_16x16x32_bf16 v[88:91], v[180:183], v[132:135], v[88:91]
    s_setprio 2
    v_mfma_f32_16x16x32_bf16 v[92:95], v[184:187], v[132:135], v[92:95]
    buffer_load_dwordx4 v[132:135], v10, s[44:47], s67 offen offset:0 sc1
    s_waitcnt lgkmcnt(0)
    s_add_u32 m0, s38, 0
    s_add_u32 s66, s66, 442368
    buffer_load_dwordx4 v1, s[40:43], s66 offen offset:0 lds
    s_setprio 0
    v_mfma_f32_16x16x32_bf16 v[16:19], v[156:159], v[136:139], v[16:19]
    s_setprio 2
    v_mfma_f32_16x16x32_bf16 v[20:23], v[160:163], v[136:139], v[20:23]
    buffer_load_dwordx4 v2, s[40:43], s66 offen offset:1024 lds
    s_setprio 0
    v_mfma_f32_16x16x32_bf16 v[24:27], v[164:167], v[136:139], v[24:27]
    s_setprio 2
    v_mfma_f32_16x16x32_bf16 v[28:31], v[168:171], v[136:139], v[28:31]
    buffer_load_dwordx4 v3, s[40:43], s66 offen offset:2048 lds
    s_setprio 0
    v_mfma_f32_16x16x32_bf16 v[44:47], v[168:171], v[140:143], v[44:47]
    s_setprio 2
    v_mfma_f32_16x16x32_bf16 v[40:43], v[164:167], v[140:143], v[40:43]
    buffer_load_dwordx4 v4, s[40:43], s66 offen offset:3072 lds
    s_setprio 0
    v_mfma_f32_16x16x32_bf16 v[36:39], v[160:163], v[140:143], v[36:39]
    s_setprio 2
    v_mfma_f32_16x16x32_bf16 v[32:35], v[156:159], v[140:143], v[32:35]
    s_add_u32 s67, s67, 163840
    buffer_load_dwordx4 v[136:139], v9, s[44:47], s67 offen offset:0 sc1
    s_setprio 0
    v_mfma_f32_16x16x32_bf16 v[48:51], v[156:159], v[144:147], v[48:51]
    s_setprio 2
    v_mfma_f32_16x16x32_bf16 v[52:55], v[160:163], v[144:147], v[52:55]
    buffer_load_dwordx4 v[140:143], v9, s[44:47], s67 offen offset:1024 sc1
    s_setprio 0
    v_mfma_f32_16x16x32_bf16 v[56:59], v[164:167], v[144:147], v[56:59]
    s_setprio 2
    v_mfma_f32_16x16x32_bf16 v[60:63], v[168:171], v[144:147], v[60:63]
    s_waitcnt vmcnt(13)
    ds_read_b64_tr_b16 v[172:173], v5 offset:4096
    ds_read_b64_tr_b16 v[174:175], v5 offset:6144
    buffer_load_dwordx4 v[144:147], v9, s[44:47], s67 offen offset:2048 sc1
    s_setprio 0
    v_mfma_f32_16x16x32_bf16 v[76:79], v[168:171], v[148:151], v[76:79]
    s_setprio 2
    v_mfma_f32_16x16x32_bf16 v[72:75], v[164:167], v[148:151], v[72:75]
    ds_read_b64_tr_b16 v[176:177], v6 offset:4096
    ds_read_b64_tr_b16 v[178:179], v6 offset:6144
    s_add_u32 m0, s70, 86016
    s_nop 0
    buffer_load_dwordx4 v10, s[60:63], s68 offen offset:0 sc1 lds
    s_setprio 0
    v_mfma_f32_16x16x32_bf16 v[68:71], v[160:163], v[148:151], v[68:71]
    s_setprio 2
    v_mfma_f32_16x16x32_bf16 v[64:67], v[156:159], v[148:151], v[64:67]
    ds_read_b64_tr_b16 v[180:181], v7 offset:4096
    ds_read_b64_tr_b16 v[182:183], v7 offset:6144
    buffer_load_dwordx4 v[148:151], v9, s[44:47], s67 offen offset:3072 sc1
    s_setprio 0
    v_mfma_f32_16x16x32_bf16 v[80:83], v[156:159], v[152:155], v[80:83]
    s_setprio 2
    v_mfma_f32_16x16x32_bf16 v[84:87], v[160:163], v[152:155], v[84:87]
    ds_read_b64_tr_b16 v[184:185], v8 offset:4096
    ds_read_b64_tr_b16 v[186:187], v8 offset:6144
    s_setprio 0
    v_mfma_f32_16x16x32_bf16 v[88:91], v[164:167], v[152:155], v[88:91]
    s_setprio 2
    v_mfma_f32_16x16x32_bf16 v[92:95], v[168:171], v[152:155], v[92:95]
    buffer_load_dwordx4 v[152:155], v10, s[44:47], s67 offen offset:0 sc1
    s_waitcnt lgkmcnt(0)
    s_add_u32 m0, s38, 4096
    s_add_u32 s66, s66, 442368
    buffer_load_dwordx4 v1, s[40:43], s66 offen offset:0 lds
    s_setprio 0
    v_mfma_f32_16x16x32_bf16 v[16:19], v[172:175], v[96:99], v[16:19]
    s_setprio 2
    v_mfma_f32_16x16x32_bf16 v[20:23], v[176:179], v[96:99], v[20:23]
    buffer_load_dwordx4 v2, s[40:43], s66 offen offset:1024 lds
    s_setprio 0
    v_mfma_f32_16x16x32_bf16 v[24:27], v[180:183], v[96:99], v[24:27]
    s_setprio 2
    v_mfma_f32_16x16x32_bf16 v[28:31], v[184:187], v[96:99], v[28:31]
    buffer_load_dwordx4 v3, s[40:43], s66 offen offset:2048 lds
    s_setprio 0
    v_mfma_f32_16x16x32_bf16 v[44:47], v[184:187], v[100:103], v[44:47]
    s_setprio 2
    v_mfma_f32_16x16x32_bf16 v[40:43], v[180:183], v[100:103], v[40:43]
    buffer_load_dwordx4 v4, s[40:43], s66 offen offset:3072 lds
    s_setprio 0
    v_mfma_f32_16x16x32_bf16 v[36:39], v[176:179], v[100:103], v[36:39]
    s_setprio 2
    v_mfma_f32_16x16x32_bf16 v[32:35], v[172:175], v[100:103], v[32:35]
    s_add_u32 s67, s67, 163840
    buffer_load_dwordx4 v[96:99], v9, s[44:47], s67 offen offset:0 sc1
    s_setprio 0
    v_mfma_f32_16x16x32_bf16 v[48:51], v[172:175], v[104:107], v[48:51]
    s_setprio 2
    v_mfma_f32_16x16x32_bf16 v[52:55], v[176:179], v[104:107], v[52:55]
    buffer_load_dwordx4 v[100:103], v9, s[44:47], s67 offen offset:1024 sc1
    s_setprio 0
    v_mfma_f32_16x16x32_bf16 v[56:59], v[180:183], v[104:107], v[56:59]
    s_setprio 2
    v_mfma_f32_16x16x32_bf16 v[60:63], v[184:187], v[104:107], v[60:63]
    s_waitcnt vmcnt(12)
    ds_read_b64_tr_b16 v[156:157], v5 offset:0
    ds_read_b64_tr_b16 v[158:159], v5 offset:2048
    buffer_load_dwordx4 v[104:107], v9, s[44:47], s67 offen offset:2048 sc1
    s_setprio 0
    v_mfma_f32_16x16x32_bf16 v[76:79], v[184:187], v[108:111], v[76:79]
    s_setprio 2
    v_mfma_f32_16x16x32_bf16 v[72:75], v[180:183], v[108:111], v[72:75]
    ds_read_b64_tr_b16 v[160:161], v6 offset:0
    ds_read_b64_tr_b16 v[162:163], v6 offset:2048
    s_setprio 0
    v_mfma_f32_16x16x32_bf16 v[68:71], v[176:179], v[108:111], v[68:71]
    s_setprio 2
    v_mfma_f32_16x16x32_bf16 v[64:67], v[172:175], v[108:111], v[64:67]
    ds_read_b64_tr_b16 v[164:165], v7 offset:0
    ds_read_b64_tr_b16 v[166:167], v7 offset:2048
    buffer_load_dwordx4 v[108:111], v9, s[44:47], s67 offen offset:3072 sc1
    s_setprio 0
    v_mfma_f32_16x16x32_bf16 v[80:83], v[172:175], v[112:115], v[80:83]
    s_setprio 2
    v_mfma_f32_16x16x32_bf16 v[84:87], v[176:179], v[112:115], v[84:87]
    ds_read_b64_tr_b16 v[168:169], v8 offset:0
    ds_read_b64_tr_b16 v[170:171], v8 offset:2048
    s_setprio 0
    v_mfma_f32_16x16x32_bf16 v[88:91], v[180:183], v[112:115], v[88:91]
    s_setprio 2
    v_mfma_f32_16x16x32_bf16 v[92:95], v[184:187], v[112:115], v[92:95]
    buffer_load_dwordx4 v[112:115], v10, s[44:47], s67 offen offset:0 sc1
    s_waitcnt lgkmcnt(0)
    s_add_u32 m0, s38, 0
    s_add_u32 s66, s66, 442368
    buffer_load_dwordx4 v1, s[40:43], s66 offen offset:0 lds
    s_setprio 0
    v_mfma_f32_16x16x32_bf16 v[16:19], v[156:159], v[116:119], v[16:19]
    s_setprio 2
    v_mfma_f32_16x16x32_bf16 v[20:23], v[160:163], v[116:119], v[20:23]
    buffer_load_dwordx4 v2, s[40:43], s66 offen offset:1024 lds
    s_setprio 0
    v_mfma_f32_16x16x32_bf16 v[24:27], v[164:167], v[116:119], v[24:27]
    s_setprio 2
    v_mfma_f32_16x16x32_bf16 v[28:31], v[168:171], v[116:119], v[28:31]
    buffer_load_dwordx4 v3, s[40:43], s66 offen offset:2048 lds
    s_setprio 0
    v_mfma_f32_16x16x32_bf16 v[44:47], v[168:171], v[120:123], v[44:47]
    s_setprio 2
    v_mfma_f32_16x16x32_bf16 v[40:43], v[164:167], v[120:123], v[40:43]
    buffer_load_dwordx4 v4, s[40:43], s66 offen offset:3072 lds
    s_setprio 0
    v_mfma_f32_16x16x32_bf16 v[36:39], v[160:163], v[120:123], v[36:39]
    s_setprio 2
    v_mfma_f32_16x16x32_bf16 v[32:35], v[156:159], v[120:123], v[32:35]
    s_add_u32 s67, s67, 163840
    buffer_load_dwordx4 v[116:119], v9, s[44:47], s67 offen offset:0 sc1
    s_setprio 0
    v_mfma_f32_16x16x32_bf16 v[48:51], v[156:159], v[124:127], v[48:51]
    s_setprio 2
    v_mfma_f32_16x16x32_bf16 v[52:55], v[160:163], v[124:127], v[52:55]
    buffer_load_dwordx4 v[120:123], v9, s[44:47], s67 offen offset:1024 sc1
    s_setprio 0
    v_mfma_f32_16x16x32_bf16 v[56:59], v[164:167], v[124:127], v[56:59]
    s_setprio 2
    v_mfma_f32_16x16x32_bf16 v[60:63], v[168:171], v[124:127], v[60:63]
    s_waitcnt vmcnt(11)
    ds_read_b64_tr_b16 v[172:173], v5 offset:4096
    ds_read_b64_tr_b16 v[174:175], v5 offset:6144
    buffer_load_dwordx4 v[124:127], v9, s[44:47], s67 offen offset:2048 sc1
    v_mov_b32 v13, 5
    ds_write_b32 v250, v13
    s_setprio 0
    v_mfma_f32_16x16x32_bf16 v[76:79], v[168:171], v[128:131], v[76:79]
    s_setprio 2
    v_mfma_f32_16x16x32_bf16 v[72:75], v[164:167], v[128:131], v[72:75]
    ds_read_b64_tr_b16 v[176:177], v6 offset:4096
    ds_read_b64_tr_b16 v[178:179], v6 offset:6144
    s_setprio 0
    v_mfma_f32_16x16x32_bf16 v[68:71], v[160:163], v[128:131], v[68:71]
    s_setprio 2
    v_mfma_f32_16x16x32_bf16 v[64:67], v[156:159], v[128:131], v[64:67]
    ds_read_b64_tr_b16 v[180:181], v7 offset:4096
    ds_read_b64_tr_b16 v[182:183], v7 offset:6144
    buffer_load_dwordx4 v[128:131], v9, s[44:47], s67 offen offset:3072 sc1
    s_setprio 0
    v_mfma_f32_16x16x32_bf16 v[80:83], v[156:159], v[132:135], v[80:83]
    s_setprio 2
    v_mfma_f32_16x16x32_bf16 v[84:87], v[160:163], v[132:135], v[84:87]
    ds_read_b64_tr_b16 v[184:185], v8 offset:4096
    ds_read_b64_tr_b16 v[186:187], v8 offset:6144
    s_setprio 0
    v_mfma_f32_16x16x32_bf16 v[88:91], v[164:167], v[132:135], v[88:91]
    s_setprio 2
    v_mfma_f32_16x16x32_bf16 v[92:95], v[168:171], v[132:135], v[92:95]
    buffer_load_dwordx4 v[132:135], v10, s[44:47], s67 offen offset:0 sc1
    s_waitcnt lgkmcnt(0)
    buffer_load_dword v253, v252, s[72:75], s85 offen sc1
    s_add_u32 m0, s38, 4096
    s_add_u32 s66, s66, 442368
    buffer_load_dwordx4 v1, s[40:43], s66 offen offset:0 lds
    s_setprio 0
    v_mfma_f32_16x16x32_bf16 v[16:19], v[172:175], v[136:139], v[16:19]
    s_setprio 2
    v_mfma_f32_16x16x32_bf16 v[20:23], v[176:179], v[136:139], v[20:23]
    buffer_load_dwordx4 v2, s[40:43], s66 offen offset:1024 lds
    s_setprio 0
    v_mfma_f32_16x16x32_bf16 v[24:27], v[180:183], v[136:139], v[24:27]
    s_setprio 2
    v_mfma_f32_16x16x32_bf16 v[28:31], v[184:187], v[136:139], v[28:31]
    buffer_load_dwordx4 v3, s[40:43], s66 offen offset:2048 lds
    s_setprio 0
    v_mfma_f32_16x16x32_bf16 v[44:47], v[184:187], v[140:143], v[44:47]
    s_setprio 2
    v_mfma_f32_16x16x32_bf16 v[40:43], v[180:183], v[140:143], v[40:43]
    buffer_load_dwordx4 v4, s[40:43], s66 offen offset:3072 lds
    s_setprio 0
    v_mfma_f32_16x16x32_bf16 v[36:39], v[176:179], v[140:143], v[36:39]
    s_setprio 2
    v_mfma_f32_16x16x32_bf16 v[32:35], v[172:175], v[140:143], v[32:35]
    s_add_u32 s67, s67, 163840
    buffer_load_dwordx4 v[136:139], v9, s[44:47], s67 offen offset:0 sc1
    s_setprio 0
    v_mfma_f32_16x16x32_bf16 v[48:51], v[172:175], v[144:147], v[48:51]
    s_setprio 2
    v_mfma_f32_16x16x32_bf16 v[52:55], v[176:179], v[144:147], v[52:55]
    buffer_load_dwordx4 v[140:143], v9, s[44:47], s67 offen offset:1024 sc1
    s_setprio 0
    v_mfma_f32_16x16x32_bf16 v[56:59], v[180:183], v[144:147], v[56:59]
    s_setprio 2
    v_mfma_f32_16x16x32_bf16 v[60:63], v[184:187], v[144:147], v[60:63]
    s_waitcnt vmcnt(12)
    ds_read_b64_tr_b16 v[156:157], v5 offset:0
    ds_read_b64_tr_b16 v[158:159], v5 offset:2048
    buffer_load_dwordx4 v[144:147], v9, s[44:47], s67 offen offset:2048 sc1
    s_setprio 0
    v_mfma_f32_16x16x32_bf16 v[76:79], v[184:187], v[148:151], v[76:79]
    s_setprio 2
    v_mfma_f32_16x16x32_bf16 v[72:75], v[180:183], v[148:151], v[72:75]
    ds_read_b64_tr_b16 v[160:161], v6 offset:0
    ds_read_b64_tr_b16 v[162:163], v6 offset:2048
    s_setprio 0
    v_mfma_f32_16x16x32_bf16 v[68:71], v[176:179], v[148:151], v[68:71]
    s_setprio 2
    v_mfma_f32_16x16x32_bf16 v[64:67], v[172:175], v[148:151], v[64:67]
    ds_read_b64_tr_b16 v[164:165], v7 offset:0
    ds_read_b64_tr_b16 v[166:167], v7 offset:2048
    buffer_load_dwordx4 v[148:151], v9, s[44:47], s67 offen offset:3072 sc1
    s_setprio 0
    v_mfma_f32_16x16x32_bf16 v[80:83], v[172:175], v[152:155], v[80:83]
    s_setprio 2
    v_mfma_f32_16x16x32_bf16 v[84:87], v[176:179], v[152:155], v[84:87]
    ds_read_b64_tr_b16 v[168:169], v8 offset:0
    ds_read_b64_tr_b16 v[170:171], v8 offset:2048
    s_add_u32 m0, s70, 102400
    s_add_u32 s68, s69, 30720
    buffer_load_dwordx4 v9, s[60:63], s68 offen offset:0 sc1 lds
    s_setprio 0
    v_mfma_f32_16x16x32_bf16 v[88:91], v[180:183], v[152:155], v[88:91]
    s_setprio 2
    v_mfma_f32_16x16x32_bf16 v[92:95], v[184:187], v[152:155], v[92:95]
    buffer_load_dwordx4 v[152:155], v10, s[44:47], s67 offen offset:0 sc1
    s_waitcnt lgkmcnt(0)
    s_add_u32 m0, s38, 0
    s_add_u32 s66, s66, 442368
    buffer_load_dwordx4 v1, s[40:43], s66 offen offset:0 lds
    s_setprio 0
    v_mfma_f32_16x16x32_bf16 v[16:19], v[156:159], v[96:99], v[16:19]
    s_setprio 2
    v_mfma_f32_16x16x32_bf16 v[20:23], v[160:163], v[96:99], v[20:23]
    buffer_load_dwordx4 v2, s[40:43], s66 offen offset:1024 lds
    s_setprio 0
    v_mfma_f32_16x16x32_bf16 v[24:27], v[164:167], v[96:99], v[24:27]
    s_setprio 2
    v_mfma_f32_16x16x32_bf16 v[28:31], v[168:171], v[96:99], v[28:31]
    buffer_load_dwordx4 v3, s[40:43], s66 offen offset:2048 lds
    s_setprio 0
    v_mfma_f32_16x16x32_bf16 v[44:47], v[168:171], v[100:103], v[44:47]
    s_setprio 2
    v_mfma_f32_16x16x32_bf16 v[40:43], v[164:167], v[100:103], v[40:43]
    buffer_load_dwordx4 v4, s[40:43], s66 offen offset:3072 lds
    s_setprio 0
    v_mfma_f32_16x16x32_bf16 v[36:39], v[160:163], v[100:103], v[36:39]
    s_setprio 2
    v_mfma_f32_16x16x32_bf16 v[32:35], v[156:159], v[100:103], v[32:35]
    s_add_u32 s67, s67, 163840
    buffer_load_dwordx4 v[96:99], v9, s[44:47], s67 offen offset:0 sc1
    s_setprio 0
    v_mfma_f32_16x16x32_bf16 v[48:51], v[156:159], v[104:107], v[48:51]
    s_setprio 2
    v_mfma_f32_16x16x32_bf16 v[52:55], v[160:163], v[104:107], v[52:55]
    buffer_load_dwordx4 v[100:103], v9, s[44:47], s67 offen offset:1024 sc1
    s_setprio 0
    v_mfma_f32_16x16x32_bf16 v[56:59], v[164:167], v[104:107], v[56:59]
    s_setprio 2
    v_mfma_f32_16x16x32_bf16 v[60:63], v[168:171], v[104:107], v[60:63]
    s_waitcnt vmcnt(12)
    ds_read_b64_tr_b16 v[172:173], v5 offset:4096
    ds_read_b64_tr_b16 v[174:175], v5 offset:6144
    buffer_load_dwordx4 v[104:107], v9, s[44:47], s67 offen offset:2048 sc1
    s_setprio 0
    v_mfma_f32_16x16x32_bf16 v[76:79], v[168:171], v[108:111], v[76:79]
    s_setprio 2
    v_mfma_f32_16x16x32_bf16 v[72:75], v[164:167], v[108:111], v[72:75]
    ds_read_b64_tr_b16 v[176:177], v6 offset:4096
    ds_read_b64_tr_b16 v[178:179], v6 offset:6144
    s_add_u32 m0, s70, 102400
    s_nop 0
    buffer_load_dwordx4 v9, s[60:63], s68 offen offset:1024 sc1 lds
    s_setprio 0
    v_mfma_f32_16x16x32_bf16 v[68:71], v[160:163], v[108:111], v[68:71]
    s_setprio 2
    v_mfma_f32_16x16x32_bf16 v[64:67], v[156:159], v[108:111], v[64:67]
    ds_read_b64_tr_b16 v[180:181], v7 offset:4096
    ds_read_b64_tr_b16 v[182:183], v7 offset:6144
    buffer_load_dwordx4 v[108:111], v9, s[44:47], s67 offen offset:3072 sc1
    s_setprio 0
    v_mfma_f32_16x16x32_bf16 v[80:83], v[156:159], v[112:115], v[80:83]
    s_setprio 2
    v_mfma_f32_16x16x32_bf16 v[84:87], v[160:163], v[112:115], v[84:87]
    ds_read_b64_tr_b16 v[184:185], v8 offset:4096
    ds_read_b64_tr_b16 v[186:187], v8 offset:6144
    s_add_u32 m0, s70, 102400
    s_nop 0
    buffer_load_dwordx4 v9, s[60:63], s68 offen offset:2048 sc1 lds
    s_setprio 0
    v_mfma_f32_16x16x32_bf16 v[88:91], v[164:167], v[112:115], v[88:91]
    s_setprio 2
    v_mfma_f32_16x16x32_bf16 v[92:95], v[168:171], v[112:115], v[92:95]
    buffer_load_dwordx4 v[112:115], v10, s[44:47], s67 offen offset:0 sc1
    s_waitcnt lgkmcnt(0)
    v_cmp_ne_u32 vcc, s3, v253
    s_nop 0
    s_cmp_eq_u64 vcc, 0
    s_cbranch_scc1 L_ok6
    s_mov_b32 s95, 0x20000
L_poll7:
    buffer_load_dword v253, v252, s[72:75], s85 offen sc1
L_pollw7:
    s_waitcnt vmcnt(0)
    v_cmp_ne_u32 vcc, s3, v253
    s_nop 0
    s_cmp_eq_u64 vcc, 0
    s_cbranch_scc1 L_polled7
    s_sleep 2
    s_sub_u32 s95, s95, 1
    s_cbranch_scc0 L_poll7
L_polled7:
L_ok6:
    s_add_u32 m0, s38, 4096
    s_add_u32 s66, s66, 442368
    buffer_load_dwordx4 v1, s[40:43], s66 offen offset:0 lds
    s_setprio 0
    v_mfma_f32_16x16x32_bf16 v[16:19], v[172:175], v[116:119], v[16:19]
    s_setprio 2
    v_mfma_f32_16x16x32_bf16 v[20:23], v[176:179], v[116:119], v[20:23]
    buffer_load_dwordx4 v2, s[40:43], s66 offen offset:1024 lds
    s_setprio 0
    v_mfma_f32_16x16x32_bf16 v[24:27], v[180:183], v[116:119], v[24:27]
    s_setprio 2
    v_mfma_f32_16x16x32_bf16 v[28:31], v[184:187], v[116:119], v[28:31]
    buffer_load_dwordx4 v3, s[40:43], s66 offen offset:2048 lds
    s_setprio 0
    v_mfma_f32_16x16x32_bf16 v[44:47], v[184:187], v[120:123], v[44:47]
    s_setprio 2
    v_mfma_f32_16x16x32_bf16 v[40:43], v[180:183], v[120:123], v[40:43]
    buffer_load_dwordx4 v4, s[40:43], s66 offen offset:3072 lds
    s_setprio 0
    v_mfma_f32_16x16x32_bf16 v[36:39], v[176:179], v[120:123], v[36:39]
    s_setprio 2
    v_mfma_f32_16x16x32_bf16 v[32:35], v[172:175], v[120:123], v[32:35]
    buffer_load_dwordx4 v[188:191], v9, s[80:83], s84 offen offset:0 sc1
    s_setprio 0
    v_mfma_f32_16x16x32_bf16 v[48:51], v[172:175], v[124:127], v[48:51]
    s_setprio 2
    v_mfma_f32_16x16x32_bf16 v[52:55], v[176:179], v[124:127], v[52:55]
    buffer_load_dwordx4 v[192:195], v9, s[80:83], s84 offen offset:1024 sc1
    s_setprio 0
    v_mfma_f32_16x16x32_bf16 v[56:59], v[180:183], v[124:127], v[56:59]
    s_setprio 2
    v_mfma_f32_16x16x32_bf16 v[60:63], v[184:187], v[124:127], v[60:63]
    s_waitcnt vmcnt(13)
    ds_read_b64_tr_b16 v[156:157], v5 offset:0
    ds_read_b64_tr_b16 v[158:159], v5 offset:2048
    buffer_load_dwordx4 v[196:199], v9, s[80:83], s84 offen offset:2048 sc1
    s_setprio 0
    v_mfma_f32_16x16x32_bf16 v[76:79], v[184:187], v[128:131], v[76:79]
    s_setprio 2
    v_mfma_f32_16x16x32_bf16 v[72:75], v[180:183], v[128:131], v[72:75]
    ds_read_b64_tr_b16 v[160:161], v6 offset:0
    ds_read_b64_tr_b16 v[162:163], v6 offset:2048
    s_add_u32 m0, s70, 102400
    s_nop 0
    buffer_load_dwordx4 v9, s[60:63], s68 offen offset:3072 sc1 lds
    s_setprio 0
    v_mfma_f32_16x16x32_bf16 v[68:71], v[176:179], v[128:131], v[68:71]
    s_setprio 2
    v_mfma_f32_16x16x32_bf16 v[64:67], v[172:175], v[128:131], v[64:67]
    ds_read_b64_tr_b16 v[164:165], v7 offset:0
    ds_read_b64_tr_b16 v[166:167], v7 offset:2048
    buffer_load_dwordx4 v[200:203], v9, s[80:83], s84 offen offset:3072 sc1
    s_setprio 0
    v_mfma_f32_16x16x32_bf16 v[80:83], v[172:175], v[132:135], v[80:83]
    s_setprio 2
    v_mfma_f32_16x16x32_bf16 v[84:87], v[176:179], v[132:135], v[84:87]
    ds_read_b64_tr_b16 v[168:169], v8 offset:0
    ds_read_b64_tr_b16 v[170:171], v8 offset:2048
    s_add_u32 m0, s70, 106496
    s_nop 0
    buffer_load_dwordx4 v10, s[60:63], s68 offen offset:0 sc1 lds
    s_setprio 0
    v_mfma_f32_16x16x32_bf16 v[88:91], v[180:183], v[132:135], v[88:91]
    s_setprio 2
    v_mfma_f32_16x16x32_bf16 v[92:95], v[184:187], v[132:135], v[92:95]
    buffer_load_dwordx4 v[204:207], v10, s[80:83], s84 offen offset:0 sc1
    s_add_u32 s84, s84, 5120
    s_waitcnt lgkmcnt(0)
    v_bfe_u32 v12, v0, 4, 2
    v_lshlrev_b32 v12, 1, v12
    v_and_b32 v13, 7, v0
    v_xor_b32 v12, v12, v13
    v_lshrrev_b32 v11, 3, v0
    v_mul_u32_u24 v11, 4096, v11
    v_lshl_add_u32 v1, v12, 4, v11
    v_add_u32 v2, 64512, v1
    v_add_u32 v3, 30720, v1
    v_add_u32 v4, 95232, v1
    s_add_u32 m0, s38, 0
    s_nop 0
    buffer_load_dwordx4 v1, s[56:59], s76 offen offset:0 lds
    s_setprio 0
    v_mfma_f32_16x16x32_bf16 v[16:19], v[156:159], v[136:139], v[16:19]
    s_setprio 2
    v_mfma_f32_16x16x32_bf16 v[20:23], v[160:163], v[136:139], v[20:23]
    buffer_load_dwordx4 v2, s[56:59], s76 offen offset:1024 lds
    s_setprio 0
    v_mfma_f32_16x16x32_bf16 v[24:27], v[164:167], v[136:139], v[24:27]
    s_setprio 2
    v_mfma_f32_16x16x32_bf16 v[28:31], v[168:171], v[136:139], v[28:31]
    buffer_load_dwordx4 v3, s[56:59], s76 offen offset:2048 lds
    s_setprio 0
    v_mfma_f32_16x16x32_bf16 v[44:47], v[168:171], v[140:143], v[44:47]
    s_setprio 2
    v_mfma_f32_16x16x32_bf16 v[40:43], v[164:167], v[140:143], v[40:43]
    buffer_load_dwordx4 v4, s[56:59], s76 offen offset:3072 lds
    s_setprio 0
    v_mfma_f32_16x16x32_bf16 v[36:39], v[160:163], v[140:143], v[36:39]
    s_setprio 2
    v_mfma_f32_16x16x32_bf16 v[32:35], v[156:159], v[140:143], v[32:35]
    buffer_load_dwordx4 v[208:211], v9, s[80:83], s84 offen offset:0 sc1
    s_setprio 0
    v_mfma_f32_16x16x32_bf16 v[48:51], v[156:159], v[144:147], v[48:51]
    s_setprio 2
    v_mfma_f32_16x16x32_bf16 v[52:55], v[160:163], v[144:147], v[52:55]
    buffer_load_dwordx4 v[212:215], v9, s[80:83], s84 offen offset:1024 sc1
    s_setprio 0
    v_mfma_f32_16x16x32_bf16 v[56:59], v[164:167], v[144:147], v[56:59]
    s_setprio 2
    v_mfma_f32_16x16x32_bf16 v[60:63], v[168:171], v[144:147], v[60:63]
    s_waitcnt vmcnt(13)
    ds_read_b64_tr_b16 v[172:173], v5 offset:4096
    ds_read_b64_tr_b16 v[174:175], v5 offset:6144
    buffer_load_dwordx4 v[216:219], v9, s[80:83], s84 offen offset:2048 sc1
    s_setprio 0
    v_mfma_f32_16x16x32_bf16 v[76:79], v[168:171], v[148:151], v[76:79]
    s_setprio 2
    v_mfma_f32_16x16x32_bf16 v[72:75], v[164:167], v[148:151], v[72:75]
    ds_read_b64_tr_b16 v[176:177], v6 offset:4096
    ds_read_b64_tr_b16 v[178:179], v6 offset:6144
    s_setprio 0
    v_mfma_f32_16x16x32_bf16 v[68:71], v[160:163], v[148:151], v[68:71]
    s_setprio 2
    v_mfma_f32_16x16x32_bf16 v[64:67], v[156:159], v[148:151], v[64:67]
    ds_read_b64_tr_b16 v[180:181], v7 offset:4096
    ds_read_b64_tr_b16 v[182:183], v7 offset:6144
    buffer_load_dwordx4 v[220:223], v9, s[80:83], s84 offen offset:3072 sc1
    s_setprio 0
    v_mfma_f32_16x16x32_bf16 v[80:83], v[156:159], v[152:155], v[80:83]
    s_setprio 2
    v_mfma_f32_16x16x32_bf16 v[84:87], v[160:163], v[152:155], v[84:87]
    ds_read_b64_tr_b16 v[184:185], v8 offset:4096
    ds_read_b64_tr_b16 v[186:187], v8 offset:6144
    s_setprio 0
    v_mfma_f32_16x16x32_bf16 v[88:91], v[164:167], v[152:155], v[88:91]
    s_setprio 2
    v_mfma_f32_16x16x32_bf16 v[92:95], v[168:171], v[152:155], v[92:95]
    buffer_load_dwordx4 v[224:227], v10, s[80:83], s84 offen offset:0 sc1
    s_add_u32 s84, s84, 5120
    s_waitcnt lgkmcnt(0)
    s_setprio 2
    v_mov_b32 v11, 161856
    s_mov_b32 s95, 0x400000
L_spin8:
    ds_read_b128 v[12:15], v11
    s_waitcnt lgkmcnt(0)
    v_min_u32 v12, v12, v13
    v_min3_u32 v12, v12, v14, v15
    s_nop 0
    v_readfirstlane_b32 s94, v12
    s_nop 0
    s_cmp_ge_u32 s94, 61440
    s_cbranch_scc1 L_spun8
    s_sleep 2
    s_sub_u32 s95, s95, 1
    s_cbranch_scc0 L_spin8
L_spun8:
    s_add_u32 s36, s70, 20480
    v_add_u32 v11, s36, v9
    v_add_u32 v15, 102400, v11
    s_add_u32 m0, s38, 4096
    s_add_u32 s76, s76, 524288
    buffer_load_dwordx4 v1, s[56:59], s76 offen offset:0 lds
    s_setprio 0
    v_mfma_f32_16x16x32_bf16 v[16:19], v[172:175], v[96:99], v[16:19]
    s_setprio 2
    v_mfma_f32_16x16x32_bf16 v[32:35], v[172:175], v[100:103], v[32:35]
    buffer_load_dwordx4 v2, s[56:59], s76 offen offset:1024 lds
    s_setprio 0
    v_mfma_f32_16x16x32_bf16 v[48:51], v[172:175], v[104:107], v[48:51]
    s_setprio 2
    v_mfma_f32_16x16x32_bf16 v[64:67], v[172:175], v[108:111], v[64:67]
    buffer_load_dwordx4 v3, s[56:59], s76 offen offset:2048 lds
    s_setprio 0
    v_mfma_f32_16x16x32_bf16 v[80:83], v[172:175], v[112:115], v[80:83]
    s_setprio 2
    v_mfma_f32_16x16x32_bf16 v[20:23], v[176:179], v[96:99], v[20:23]
    buffer_load_dwordx4 v4, s[56:59], s76 offen offset:3072 lds
    s_setprio 0
    v_mfma_f32_16x16x32_bf16 v[36:39], v[176:179], v[100:103], v[36:39]
    s_setprio 2
    v_mfma_f32_16x16x32_bf16 v[52:55], v[176:179], v[104:107], v[52:55]
    buffer_load_dwordx4 v[228:231], v9, s[80:83], s84 offen offset:0 sc1
    s_setprio 0
    v_mfma_f32_16x16x32_bf16 v[68:71], v[176:179], v[108:111], v[68:71]
    s_setprio 2
    ds_write_b128 v11, v[16:19] offset:0
    v_mfma_f32_16x16x32_bf16 v[84:87], v[176:179], v[112:115], v[84:87]
    buffer_load_dwordx4 v[232:235], v9, s[80:83], s84 offen offset:1024 sc1
    ds_write_b128 v11, v[32:35] offset:1024
    s_setprio 0
    v_mfma_f32_16x16x32_bf16 v[24:27], v[180:183], v[96:99], v[24:27]
    s_setprio 2
    ds_write_b128 v11, v[48:51] offset:2048
    v_mfma_f32_16x16x32_bf16 v[40:43], v[180:183], v[100:103], v[40:43]
    buffer_load_dwordx4 v[236:239], v9, s[80:83], s84 offen offset:2048 sc1
    ds_write_b128 v11, v[64:67] offset:3072
    s_setprio 0
    v_mfma_f32_16x16x32_bf16 v[56:59], v[180:183], v[104:107], v[56:59]
    s_setprio 2
    ds_write_b128 v11, v[80:83] offset:4096
    v_mfma_f32_16x16x32_bf16 v[72:75], v[180:183], v[108:111], v[72:75]
    ds_write_b128 v11, v[20:23] offset:20480
    s_setprio 0
    v_mfma_f32_16x16x32_bf16 v[88:91], v[180:183], v[112:115], v[88:91]
    s_setprio 2
    ds_write_b128 v11, v[36:39] offset:21504
    v_mfma_f32_16x16x32_bf16 v[28:31], v[184:187], v[96:99], v[28:31]
    buffer_load_dwordx4 v[240:243], v9, s[80:83], s84 offen offset:3072 sc1
    ds_write_b128 v11, v[52:55] offset:22528
    s_setprio 0
    v_mfma_f32_16x16x32_bf16 v[44:47], v[184:187], v[100:103], v[44:47]
    s_setprio 2
    ds_write_b128 v11, v[68:71] offset:23552
    v_mfma_f32_16x16x32_bf16 v[60:63], v[184:187], v[104:107], v[60:63]
    ds_write_b128 v11, v[84:87] offset:24576
    s_setprio 0
    v_mfma_f32_16x16x32_bf16 v[76:79], v[184:187], v[108:111], v[76:79]
    s_setprio 2
    ds_write_b128 v15, v[24:27] offset:0
    v_mfma_f32_16x16x32_bf16 v[92:95], v[184:187], v[112:115], v[92:95]
    buffer_load_dwordx4 v[244:247], v10, s[80:83], s84 offen offset:0 sc1
    s_add_u32 s84, s84, 5120
    v_mov_b32 v13, 6
    s_waitcnt vmcnt(19)
    ds_write_b32 v250, v13
    ds_write_b128 v15, v[40:43] offset:1024
    s_setprio 2
    ds_write_b128 v15, v[56:59] offset:2048
    ds_write_b128 v15, v[72:75] offset:3072
    ds_write_b128 v15, v[88:91] offset:4096
    s_xor_b32 s36, s37, 1
    s_mul_i32 s36, s36, 5120
    s_add_u32 s36, s36, 122880
    v_add_u32 v157, s36, v9
    s_xor_b32 s36, s37, 2
    s_mul_i32 s36, s36, 5120
    s_add_u32 s36, s36, 40960
    v_add_u32 v158, s36, v9
    s_xor_b32 s36, s37, 3
    s_mul_i32 s36, s36, 5120
    s_add_u32 s36, s36, 20480
    v_add_u32 v159, s36, v9
    v_mov_b32 v12, 161796
    v_mov_b32 v13, 1
    s_waitcnt lgkmcnt(0)
    s_mov_b64 exec, 1
    ds_add_u32 v12, v13
    s_mov_b64 exec, -1
    s_mov_b32 s71, 0xbdd2d3e8
    v_mov_b32 v14, 0xc0135761
    s_lshl_b32 s79, s65, 1
    s_lshr_b32 s36, s37, 1
    s_add_u32 s79, s79, s36
    s_mul_i32 s67, s79, 40960
    s_mul_i32 s36, s64, 5120
    s_add_u32 s67, s67, s36
    s_and_b32 s36, s37, 1
    s_lshl_b32 s36, s36, 9
    s_add_u32 s67, s67, s36
    s_add_u32 s66, s67, 4096
    v_lshrrev_b32 v156, 5, v0
    v_lshl_add_u32 v156, v156, 9, v9
    s_mul_i32 s79, s64, 27
    s_add_u32 s79, s79, s65
    s_lshl_b32 s79, s79, 7
    s_add_u32 s79, s79, 98304
    v_mov_b32 v12, 161796
    s_mov_b32 s95, 0x400000
L_spin9:
    ds_read_b32 v13, v12
    s_waitcnt lgkmcnt(0)
    v_readfirstlane_b32 s94, v13
    s_nop 0
    s_cmp_ge_u32 s94, 4
    s_cbranch_scc1 L_spun9
    s_sub_u32 s95, s95, 1
    s_cbranch_scc0 L_spin9
L_spun9:
    ds_read_b128 v[104:107], v159 offset:0
    ds_read_b128 v[100:103], v158 offset:0
    ds_read_b128 v[96:99], v157 offset:0
    ds_read_b128 v[116:119], v159 offset:1024
    ds_read_b128 v[112:115], v158 offset:1024
    ds_read_b128 v[108:111], v157 offset:1024
    ds_read_b128 v[128:131], v159 offset:2048
    ds_read_b128 v[124:127], v158 offset:2048
    ds_read_b128 v[120:123], v157 offset:2048
    ds_read_b128 v[140:143], v159 offset:3072
    ds_read_b128 v[136:139], v158 offset:3072
    ds_read_b128 v[132:135], v157 offset:3072
    ds_read_b128 v[152:155], v159 offset:4096
    ds_read_b128 v[148:151], v158 offset:4096
    ds_read_b128 v[144:147], v157 offset:4096
    s_waitcnt lgkmcnt(9)
    v_add_f32 v28, v28, v96
    v_add_f32 v100, v100, v104
    v_add_f32 v29, v29, v97
    v_add_f32 v101, v101, v105
    v_add_f32 v30, v30, v98
    v_add_f32 v102, v102, v106
    v_add_f32 v31, v31, v99
    v_add_f32 v103, v103, v107
    v_add_f32 v44, v44, v108
    v_add_f32 v112, v112, v116
    v_add_f32 v45, v45, v109
    v_add_f32 v113, v113, v117
    v_add_f32 v46, v46, v110
    v_add_f32 v114, v114, v118
    v_add_f32 v47, v47, v111
    v_add_f32 v115, v115, v119
    v_add_f32 v28, v28, v100
    v_add_f32 v29, v29, v101
    v_add_f32 v30, v30, v102
    v_add_f32 v31, v31, v103
    v_add_f32 v44, v44, v112
    v_add_f32 v45, v45, v113
    v_add_f32 v46, v46, v114
    v_add_f32 v47, v47, v115
    v_mul_f32 v96, v28, v28
    v_mul_f32 v97, v29, v29
    v_mul_f32 v98, v30, v30
    v_mul_f32 v99, v31, v31
    v_mul_f32 v108, v44, v44
    v_mul_f32 v109, v45, v45
    v_mul_f32 v110, v46, v46
    v_mul_f32 v111, v47, v47
    v_fma_f32 v96, v96, s71, v14
    v_fma_f32 v97, v97, s71, v14
    v_fma_f32 v98, v98, s71, v14
    v_fma_f32 v99, v99, s71, v14
    v_fma_f32 v108, v108, s71, v14
    v_fma_f32 v109, v109, s71, v14
    v_fma_f32 v110, v110, s71, v14
    v_fma_f32 v111, v111, s71, v14
    v_mul_f32 v96, v96, v28
    v_mul_f32 v97, v97, v29
    v_mul_f32 v98, v98, v30
    v_mul_f32 v99, v99, v31
    v_mul_f32 v108, v108, v44
    v_mul_f32 v109, v109, v45
    v_mul_f32 v110, v110, v46
    v_mul_f32 v111, v111, v47
    v_exp_f32 v96, v96
    v_exp_f32 v97, v97
    v_exp_f32 v98, v98
    v_exp_f32 v99, v99
    v_exp_f32 v108, v108
    v_exp_f32 v109, v109
    v_exp_f32 v110, v110
    v_exp_f32 v111, v111
    v_add_f32 v96, 1.0, v96
    v_add_f32 v97, 1.0, v97
    v_add_f32 v98, 1.0, v98
    v_add_f32 v99, 1.0, v99
    v_add_f32 v108, 1.0, v108
    v_add_f32 v109, 1.0, v109
    v_add_f32 v110, 1.0, v110
    v_add_f32 v111, 1.0, v111
    v_rcp_f32 v96, v96
    v_rcp_f32 v97, v97
    v_rcp_f32 v98, v98
    v_rcp_f32 v99, v99
    v_rcp_f32 v108, v108
    v_rcp_f32 v109, v109
    v_rcp_f32 v110, v110
    v_rcp_f32 v111, v111
    v_mul_f32 v28, v28, v96
    v_mul_f32 v29, v29, v97
    v_mul_f32 v30, v30, v98
    v_mul_f32 v31, v31, v99
    v_mul_f32 v44, v44, v108
    v_mul_f32 v45, v45, v109
    v_mul_f32 v46, v46, v110
    v_mul_f32 v47, v47, v111
    v_cvt_pk_bf16_f32 v16, v28, v29
    v_cvt_pk_bf16_f32 v17, v30, v31
    v_cvt_pk_bf16_f32 v18, v44, v45
    v_cvt_pk_bf16_f32 v19, v46, v47
    s_nop 1
    v_permlane32_swap_b32 v16, v18
    v_permlane32_swap_b32 v17, v19
    buffer_store_dwordx4 v[16:19], v156, s[52:55], s67 offen offset:0 sc1
    s_waitcnt lgkmcnt(3)
    v_add_f32 v60, v60, v120
    v_add_f32 v124, v124, v128
    v_add_f32 v61, v61, v121
    v_add_f32 v125, v125, v129
    v_add_f32 v62, v62, v122
    v_add_f32 v126, v126, v130
    v_add_f32 v63, v63, v123
    v_add_f32 v127, v127, v131
    v_add_f32 v76, v76, v132
    v_add_f32 v136, v136, v140
    v_add_f32 v77, v77, v133
    v_add_f32 v137, v137, v141
    v_add_f32 v78, v78, v134
    v_add_f32 v138, v138, v142
    v_add_f32 v79, v79, v135
    v_add_f32 v139, v139, v143
    v_add_f32 v60, v60, v124
    v_add_f32 v61, v61, v125
    v_add_f32 v62, v62, v126
    v_add_f32 v63, v63, v127
    v_add_f32 v76, v76, v136
    v_add_f32 v77, v77, v137
    v_add_f32 v78, v78, v138
    v_add_f32 v79, v79, v139
    v_mul_f32 v120, v60, v60
    v_mul_f32 v121, v61, v61
    v_mul_f32 v122, v62, v62
    v_mul_f32 v123, v63, v63
    v_mul_f32 v132, v76, v76
    v_mul_f32 v133, v77, v77
    v_mul_f32 v134, v78, v78
    v_mul_f32 v135, v79, v79
    v_fma_f32 v120, v120, s71, v14
    v_fma_f32 v121, v121, s71, v14
    v_fma_f32 v122, v122, s71, v14
    v_fma_f32 v123, v123, s71, v14
    v_fma_f32 v132, v132, s71, v14
    v_fma_f32 v133, v133, s71, v14
    v_fma_f32 v134, v134, s71, v14
    v_fma_f32 v135, v135, s71, v14
    v_mul_f32 v120, v120, v60
    v_mul_f32 v121, v121, v61
    v_mul_f32 v122, v122, v62
    v_mul_f32 v123, v123, v63
    v_mul_f32 v132, v132, v76
    v_mul_f32 v133, v133, v77
    v_mul_f32 v134, v134, v78
    v_mul_f32 v135, v135, v79
    v_exp_f32 v120, v120
    v_exp_f32 v121, v121
    v_exp_f32 v122, v122
    v_exp_f32 v123, v123
    v_exp_f32 v132, v132
    v_exp_f32 v133, v133
    v_exp_f32 v134, v134
    v_exp_f32 v135, v135
    v_add_f32 v120, 1.0, v120
    v_add_f32 v121, 1.0, v121
    v_add_f32 v122, 1.0, v122
    v_add_f32 v123, 1.0, v123
    v_add_f32 v132, 1.0, v132
    v_add_f32 v133, 1.0, v133
    v_add_f32 v134, 1.0, v134
    v_add_f32 v135, 1.0, v135
    v_rcp_f32 v120, v120
    v_rcp_f32 v121, v121
    v_rcp_f32 v122, v122
    v_rcp_f32 v123, v123
    v_rcp_f32 v132, v132
    v_rcp_f32 v133, v133
    v_rcp_f32 v134, v134
    v_rcp_f32 v135, v135
    v_mul_f32 v60, v60, v120
    v_mul_f32 v61, v61, v121
    v_mul_f32 v62, v62, v122
    v_mul_f32 v63, v63, v123
    v_mul_f32 v76, v76, v132
    v_mul_f32 v77, v77, v133
    v_mul_f32 v78, v78, v134
    v_mul_f32 v79, v79, v135
    v_cvt_pk_bf16_f32 v48, v60, v61
    v_cvt_pk_bf16_f32 v49, v62, v63
    v_cvt_pk_bf16_f32 v50, v76, v77
    v_cvt_pk_bf16_f32 v51, v78, v79
    s_nop 1
    v_permlane32_swap_b32 v48, v50
    v_permlane32_swap_b32 v49, v51
    buffer_store_dwordx4 v[48:51], v156, s[52:55], s67 offen offset:2048 sc1
    s_waitcnt lgkmcnt(0)
    v_add_f32 v92, v92, v144
    v_add_f32 v148, v148, v152
    v_add_f32 v93, v93, v145
    v_add_f32 v149, v149, v153
    v_add_f32 v94, v94, v146
    v_add_f32 v150, v150, v154
    v_add_f32 v95, v95, v147
    v_add_f32 v151, v151, v155
    v_add_f32 v92, v92, v148
    v_add_f32 v93, v93, v149
    v_add_f32 v94, v94, v150
    v_add_f32 v95, v95, v151
    v_mul_f32 v144, v92, v92
    v_mul_f32 v145, v93, v93
    v_mul_f32 v146, v94, v94
    v_mul_f32 v147, v95, v95
    v_fma_f32 v144, v144, s71, v14
    v_fma_f32 v145, v145, s71, v14
    v_fma_f32 v146, v146, s71, v14
    v_fma_f32 v147, v147, s71, v14
    v_mul_f32 v144, v144, v92
    v_mul_f32 v145, v145, v93
    v_mul_f32 v146, v146, v94
    v_mul_f32 v147, v147, v95
    v_exp_f32 v144, v144
    v_exp_f32 v145, v145
    v_exp_f32 v146, v146
    v_exp_f32 v147, v147
    v_add_f32 v144, 1.0, v144
    v_add_f32 v145, 1.0, v145
    v_add_f32 v146, 1.0, v146
    v_add_f32 v147, 1.0, v147
    v_rcp_f32 v144, v144
    v_rcp_f32 v145, v145
    v_rcp_f32 v146, v146
    v_rcp_f32 v147, v147
    v_mul_f32 v92, v92, v144
    v_mul_f32 v93, v93, v145
    v_mul_f32 v94, v94, v146
    v_mul_f32 v95, v95, v147
    v_cvt_pk_bf16_f32 v80, v92, v93
    v_cvt_pk_bf16_f32 v81, v94, v95
    s_nop 1
    v_permlane32_swap_b32 v80, v82
    v_permlane32_swap_b32 v81, v83
    s_mov_b32 exec_hi, 0
    buffer_store_dwordx4 v[80:83], v156, s[52:55], s66 offen sc1
    s_mov_b32 exec_hi, -1
    v_min_u32 v252, 26, v0
    v_lshlrev_b32 v252, 7, v252
    s_mul_i32 s78, s34, 3456
    s_add_u32 s78, s78, 98304
    v_mov_b32 v12, 161828
    v_mov_b32 v13, 1
    s_waitcnt vmcnt(0) lgkmcnt(0)
    s_mov_b64 exec, 1
    ds_add_rtn_u32 v13, v12, v13
    s_waitcnt lgkmcnt(0)
    v_readfirstlane_b32 s94, v13
    s_mov_b64 exec, -1
    s_cmp_eq_u32 s94, 3
    s_cbranch_scc0 L_g1wait
    v_mov_b32 v12, 0
    v_mov_b32 v13, s3
    s_waitcnt vmcnt(0)
    s_mov_b64 exec, 1
    buffer_store_dword v13, v12, s[72:75], s79 offen sc1
    s_mov_b64 exec, -1
    s_branch L_g1poll
L_nog1:
    s_add_u32 s36, s39, 0
    buffer_load_dword v48, v251, s[40:43], s36 offen
    s_add_u32 s36, s39, 1310720
    buffer_load_dword v48, v251, s[40:43], s36 offen
    v_mov_b32 v13, 1
    s_waitcnt vmcnt(2)
    ds_write_b32 v250, v13
    v_mov_b32 v12, 161820
    s_mov_b32 s95, 0x400000
L_spin10:
    ds_read_b32 v13, v12
    s_waitcnt lgkmcnt(0)
    v_readfirstlane_b32 s94, v13
    s_nop 0
    s_cmp_ge_u32 s94, 4
    s_cbranch_scc1 L_spun10
    s_sub_u32 s95, s95, 1
    s_cbranch_scc0 L_spin10
L_spun10:
    s_add_u32 m0, s70, 20480
    s_add_u32 s68, s69, 10240
    buffer_load_dwordx4 v9, s[60:63], s68 offen offset:0 sc1 lds
    buffer_load_dwordx4 v9, s[60:63], s68 offen offset:1024 sc1 lds
    buffer_load_dwordx4 v9, s[60:63], s68 offen offset:2048 sc1 lds
    buffer_load_dwordx4 v9, s[60:63], s68 offen offset:3072 sc1 lds
    s_add_u32 m0, s70, 24576
    s_nop 0
    buffer_load_dwordx4 v10, s[60:63], s68 offen offset:0 sc1 lds
    s_and_b32 s87, s86, 7
    s_lshr_b32 s89, s86, 3
    s_mul_i32 s66, s87, 160
    s_mov_b32 s48, s12
    s_mov_b32 s49, s13
    s_mov_b32 s50, 819200
    s_mov_b32 s51, 0x20000
    s_cmp_eq_u32 s89, 4
    s_cselect_b64 vcc, -1, 0
    s_cselect_b32 s36, 0, s89
    s_mul_i32 s36, s36, 51200
    s_mul_i32 s71, s37, 204800
    s_add_u32 s71, s71, s36
    v_add_u32 v11, 0, v0
    v_mul_u32_u24 v12, 205, v11
    v_lshrrev_b32 v12, 11, v12
    v_mul_u32_u24 v13, 10, v12
    v_sub_u32 v13, v11, v13
    v_lshlrev_b32 v13, 4, v13
    v_lshrrev_b32 v14, 4, v12
    v_lshl_add_u32 v16, v14, 2, v12
    v_bfe_u32 v15, v12, 2, 1
    v_lshl_add_u32 v14, v14, 1, v15
    v_bfe_u32 v15, v12, 3, 1
    v_lshl_add_u32 v14, v14, 1, v15
    v_mul_u32_u24 v14, 20, v14
    v_and_b32 v15, 3, v12
    v_add3_u32 v14, v14, v15, 16
    v_cndmask_b32 v14, v16, v14, vcc
    v_mul_u32_u24 v14, 1280, v14
    v_add3_u32 v14, v14, v13, s66
    s_add_u32 m0, s38, 0
    s_nop 0
    buffer_load_dwordx4 v14, s[48:51], s71 offen lds
    v_add_u32 v11, 64, v0
    v_mul_u32_u24 v12, 205, v11
    v_lshrrev_b32 v12, 11, v12
    v_mul_u32_u24 v13, 10, v12
    v_sub_u32 v13, v11, v13
    v_lshlrev_b32 v13, 4, v13
    v_lshrrev_b32 v14, 4, v12
    v_lshl_add_u32 v16, v14, 2, v12
    v_bfe_u32 v15, v12, 2, 1
    v_lshl_add_u32 v14, v14, 1, v15
    v_bfe_u32 v15, v12, 3, 1
    v_lshl_add_u32 v14, v14, 1, v15
    v_mul_u32_u24 v14, 20, v14
    v_and_b32 v15, 3, v12
    v_add3_u32 v14, v14, v15, 16
    v_cndmask_b32 v14, v16, v14, vcc
    v_mul_u32_u24 v14, 1280, v14
    v_add3_u32 v14, v14, v13, s66
    s_add_u32 m0, s38, 1024
    s_nop 0
    buffer_load_dwordx4 v14, s[48:51], s71 offen lds
    v_add_u32 v11, 128, v0
    v_mul_u32_u24 v12, 205, v11
    v_lshrrev_b32 v12, 11, v12
    v_mul_u32_u24 v13, 10, v12
    v_sub_u32 v13, v11, v13
    v_lshlrev_b32 v13, 4, v13
    v_lshrrev_b32 v14, 4, v12
    v_lshl_add_u32 v16, v14, 2, v12
    v_bfe_u32 v15, v12, 2, 1
    v_lshl_add_u32 v14, v14, 1, v15
    v_bfe_u32 v15, v12, 3, 1
    v_lshl_add_u32 v14, v14, 1, v15
    v_mul_u32_u24 v14, 20, v14
    v_and_b32 v15, 3, v12
    v_add3_u32 v14, v14, v15, 16
    v_cndmask_b32 v14, v16, v14, vcc
    v_mul_u32_u24 v14, 1280, v14
    v_add3_u32 v14, v14, v13, s66
    s_add_u32 m0, s38, 2048
    s_nop 0
    buffer_load_dwordx4 v14, s[48:51], s71 offen lds
    v_add_u32 v11, 192, v0
    v_mul_u32_u24 v12, 205, v11
    v_lshrrev_b32 v12, 11, v12
    v_mul_u32_u24 v13, 10, v12
    v_sub_u32 v13, v11, v13
    v_lshlrev_b32 v13, 4, v13
    v_lshrrev_b32 v14, 4, v12
    v_lshl_add_u32 v16, v14, 2, v12
    v_bfe_u32 v15, v12, 2, 1
    v_lshl_add_u32 v14, v14, 1, v15
    v_bfe_u32 v15, v12, 3, 1
    v_lshl_add_u32 v14, v14, 1, v15
    v_mul_u32_u24 v14, 20, v14
    v_and_b32 v15, 3, v12
    v_add3_u32 v14, v14, v15, 16
    v_cndmask_b32 v14, v16, v14, vcc
    v_mul_u32_u24 v14, 1280, v14
    v_add3_u32 v14, v14, v13, s66
    s_add_u32 m0, s38, 3072
    s_nop 0
    buffer_load_dwordx4 v14, s[48:51], s71 offen lds
    v_add_u32 v11, 256, v0
    v_mul_u32_u24 v12, 205, v11
    v_lshrrev_b32 v12, 11, v12
    v_mul_u32_u24 v13, 10, v12
    v_sub_u32 v13, v11, v13
    v_lshlrev_b32 v13, 4, v13
    v_lshrrev_b32 v14, 4, v12
    v_lshl_add_u32 v16, v14, 2, v12
    v_bfe_u32 v15, v12, 2, 1
    v_lshl_add_u32 v14, v14, 1, v15
    v_bfe_u32 v15, v12, 3, 1
    v_lshl_add_u32 v14, v14, 1, v15
    v_mul_u32_u24 v14, 20, v14
    v_and_b32 v15, 3, v12
    v_add3_u32 v14, v14, v15, 16
    v_cndmask_b32 v14, v16, v14, vcc
    v_mul_u32_u24 v14, 1280, v14
    v_add3_u32 v14, v14, v13, s66
    s_add_u32 m0, s38, 4096
    s_nop 0
    buffer_load_dwordx4 v14, s[48:51], s71 offen lds
    s_add_u32 s36, s39, 2621440
    buffer_load_dword v48, v251, s[40:43], s36 offen
    v_mov_b32 v13, 2
    s_waitcnt vmcnt(6)
    ds_write_b32 v250, v13
    v_lshrrev_b32 v11, 5, v0
    v_lshlrev_b32 v11, 4, v11
    v_bfe_u32 v16, v0, 2, 3
    v_add_u32 v11, v11, v16
    v_mul_u32_u24 v11, 160, v11
    v_and_b32 v16, 3, v0
    v_lshl_add_u32 v16, v16, 3, v11
    v_add_u32 v16, s38, v16
    s_lshl_b32 s36, s87, 2
    s_add_u32 s36, s36, s37
    s_mul_i32 s36, s36, 5
    s_add_u32 s36, s36, s89
    s_mul_i32 s71, s36, 5120
    s_lshl_b32 s79, s36, 7
    s_add_u32 s79, s79, 163840
    s_waitcnt vmcnt(1)
    ds_read_b64_tr_b16 v[20:21], v16 offset:0
    ds_read_b64_tr_b16 v[22:23], v16 offset:1280
    ds_read_b64_tr_b16 v[24:25], v16 offset:32
    ds_read_b64_tr_b16 v[26:27], v16 offset:1312
    ds_read_b64_tr_b16 v[28:29], v16 offset:64
    ds_read_b64_tr_b16 v[30:31], v16 offset:1344
    ds_read_b64_tr_b16 v[32:33], v16 offset:96
    ds_read_b64_tr_b16 v[34:35], v16 offset:1376
    ds_read_b64_tr_b16 v[36:37], v16 offset:128
    ds_read_b64_tr_b16 v[38:39], v16 offset:1408
    s_waitcnt lgkmcnt(0)
    buffer_store_dwordx4 v[20:23], v9, s[80:83], s71 offen offset:0 sc1
    buffer_store_dwordx4 v[24:27], v9, s[80:83], s71 offen offset:1024 sc1
    buffer_store_dwordx4 v[28:31], v9, s[80:83], s71 offen offset:2048 sc1
    buffer_store_dwordx4 v[32:35], v9, s[80:83], s71 offen offset:3072 sc1
    buffer_store_dwordx4 v[36:39], v10, s[80:83], s71 offen offset:0 sc1
    s_add_u32 m0, s70, 40960
    s_add_u32 s68, s69, 15360
    buffer_load_dwordx4 v9, s[60:63], s68 offen offset:0 sc1 lds
    buffer_load_dwordx4 v9, s[60:63], s68 offen offset:1024 sc1 lds
    buffer_load_dwordx4 v9, s[60:63], s68 offen offset:2048 sc1 lds
    buffer_load_dwordx4 v9, s[60:63], s68 offen offset:3072 sc1 lds
    s_add_u32 m0, s70, 45056
    s_nop 0
    buffer_load_dwordx4 v10, s[60:63], s68 offen offset:0 sc1 lds
    s_add_u32 s36, s39, 3932160
    buffer_load_dword v48, v251, s[40:43], s36 offen
    v_mov_b32 v12, 0
    v_mov_b32 v13, s3
    s_waitcnt vmcnt(6)
    s_mov_b64 exec, 1
    buffer_store_dword v13, v12, s[72:75], s79 offen sc1
    s_mov_b64 exec, -1
    s_add_u32 m0, s70, 61440
    s_add_u32 s68, s69, 20480
    buffer_load_dwordx4 v9, s[60:63], s68 offen offset:0 sc1 lds
    buffer_load_dwordx4 v9, s[60:63], s68 offen offset:1024 sc1 lds
    buffer_load_dwordx4 v9, s[60:63], s68 offen offset:2048 sc1 lds
    buffer_load_dwordx4 v9, s[60:63], s68 offen offset:3072 sc1 lds
    s_add_u32 m0, s70, 65536
    s_nop 0
    buffer_load_dwordx4 v10, s[60:63], s68 offen offset:0 sc1 lds
    s_add_u32 s36, s39, 5242880
    buffer_load_dword v48, v251, s[40:43], s36 offen
    s_add_u32 s36, s39, 6553600
    buffer_load_dword v48, v251, s[40:43], s36 offen
    v_mov_b32 v13, 3
    s_waitcnt vmcnt(9)
    ds_write_b32 v250, v13
    v_mov_b32 v13, 4
    s_waitcnt vmcnt(2)
    ds_write_b32 v250, v13
    s_add_u32 m0, s70, 81920
    s_add_u32 s68, s69, 25600
    buffer_load_dwordx4 v9, s[60:63], s68 offen offset:0 sc1 lds
    buffer_load_dwordx4 v9, s[60:63], s68 offen offset:1024 sc1 lds
    buffer_load_dwordx4 v9, s[60:63], s68 offen offset:2048 sc1 lds
    buffer_load_dwordx4 v9, s[60:63], s68 offen offset:3072 sc1 lds
    s_add_u32 m0, s70, 86016
    s_nop 0
    buffer_load_dwordx4 v10, s[60:63], s68 offen offset:0 sc1 lds
    s_add_u32 m0, s70, 102400
    s_add_u32 s68, s69, 30720
    buffer_load_dwordx4 v9, s[60:63], s68 offen offset:0 sc1 lds
    buffer_load_dwordx4 v9, s[60:63], s68 offen offset:1024 sc1 lds
    buffer_load_dwordx4 v9, s[60:63], s68 offen offset:2048 sc1 lds
    buffer_load_dwordx4 v9, s[60:63], s68 offen offset:3072 sc1 lds
    s_add_u32 m0, s70, 106496
    s_nop 0
    buffer_load_dwordx4 v10, s[60:63], s68 offen offset:0 sc1 lds
    v_lshrrev_b32 v49, 2, v0
    v_lshlrev_b32 v49, 12, v49
    v_and_b32 v12, 3, v0
    v_lshl_add_u32 v49, v12, 7, v49
    s_and_b32 s36, s64, 3
    s_lshl_b32 s36, s36, 2
    s_add_u32 s36, s36, s37
    s_lshl_b32 s39, s36, 16
    s_lshl_b32 s36, s35, 9
    s_add_u32 s39, s39, s36
    s_cmp_eq_u32 s65, 27
    s_cselect_b32 s39, 0x1000000, s39
    s_add_u32 s36, s39, 0
    buffer_load_dword v48, v49, s[56:59], s36 offen
    s_add_u32 s36, s39, 1048576
    buffer_load_dword v48, v49, s[56:59], s36 offen
    s_add_u32 s36, s39, 2097152
    buffer_load_dword v48, v49, s[56:59], s36 offen
    v_mov_b32 v13, 6
    s_waitcnt vmcnt(3)
    ds_write_b32 v250, v13
    v_mov_b32 v11, 161856
    s_mov_b32 s95, 0x400000
L_spin11:
    ds_read_b128 v[12:15], v11
    s_waitcnt lgkmcnt(0)
    v_min_u32 v12, v12, v13
    v_min3_u32 v12, v12, v14, v15
    s_nop 0
    v_readfirstlane_b32 s94, v12
    s_nop 0
    s_cmp_ge_u32 s94, 61440
    s_cbranch_scc1 L_spun11
    s_sleep 2
    s_sub_u32 s95, s95, 1
    s_cbranch_scc0 L_spin11
L_spun11:
    s_add_u32 m0, s70, 122880
    s_add_u32 s68, s69, 35840
    buffer_load_dwordx4 v9, s[60:63], s68 offen offset:0 sc1 lds
    buffer_load_dwordx4 v9, s[60:63], s68 offen offset:1024 sc1 lds
    buffer_load_dwordx4 v9, s[60:63], s68 offen offset:2048 sc1 lds
    buffer_load_dwordx4 v9, s[60:63], s68 offen offset:3072 sc1 lds
    s_add_u32 m0, s70, 126976
    s_nop 0
    buffer_load_dwordx4 v10, s[60:63], s68 offen offset:0 sc1 lds
    s_add_u32 s36, s39, 3145728
    buffer_load_dword v48, v49, s[56:59], s36 offen
    s_add_u32 s36, s39, 4194304
    buffer_load_dword v48, v49, s[56:59], s36 offen
    s_add_u32 s36, s39, 5242880
    buffer_load_dword v48, v49, s[56:59], s36 offen
    s_add_u32 s36, s39, 6291456
    buffer_load_dword v48, v49, s[56:59], s36 offen
    v_mov_b32 v13, 64
    s_waitcnt vmcnt(4)
    ds_write_b32 v250, v13
    s_mov_b32 s48, s22
    s_mov_b32 s49, s23
    s_mov_b32 s50, 4096
    s_mov_b32 s51, 0x20000
    buffer_load_dword v48, v251, s[48:51], 0 offen
    s_mov_b32 s95, 0x20000
L_poll12:
    buffer_load_dword v253, v252, s[72:75], s85 offen sc1
L_pollw12:
    s_waitcnt vmcnt(0)
    v_cmp_ne_u32 vcc, s3, v253
    s_nop 0
    s_cmp_eq_u64 vcc, 0
    s_cbranch_scc1 L_polled12
    s_sleep 8
    s_sub_u32 s95, s95, 1
    s_cbranch_scc0 L_poll12
L_polled12:
    buffer_load_dwordx4 v[188:191], v9, s[80:83], s84 offen offset:0 sc1
    buffer_load_dwordx4 v[192:195], v9, s[80:83], s84 offen offset:1024 sc1
    buffer_load_dwordx4 v[196:199], v9, s[80:83], s84 offen offset:2048 sc1
    buffer_load_dwordx4 v[200:203], v9, s[80:83], s84 offen offset:3072 sc1
    buffer_load_dwordx4 v[204:207], v10, s[80:83], s84 offen offset:0 sc1
    s_add_u32 s84, s84, 5120
    buffer_load_dwordx4 v[208:211], v9, s[80:83], s84 offen offset:0 sc1
    buffer_load_dwordx4 v[212:215], v9, s[80:83], s84 offen offset:1024 sc1
    buffer_load_dwordx4 v[216:219], v9, s[80:83], s84 offen offset:2048 sc1
    buffer_load_dwordx4 v[220:223], v9, s[80:83], s84 offen offset:3072 sc1
    buffer_load_dwordx4 v[224:227], v10, s[80:83], s84 offen offset:0 sc1
    s_add_u32 s84, s84, 5120
    buffer_load_dwordx4 v[228:231], v9, s[80:83], s84 offen offset:0 sc1
    buffer_load_dwordx4 v[232:235], v9, s[80:83], s84 offen offset:1024 sc1
    buffer_load_dwordx4 v[236:239], v9, s[80:83], s84 offen offset:2048 sc1
    buffer_load_dwordx4 v[240:243], v9, s[80:83], s84 offen offset:3072 sc1
    buffer_load_dwordx4 v[244:247], v10, s[80:83], s84 offen offset:0 sc1
    s_add_u32 s84, s84, 5120
    v_min_u32 v252, 26, v0
    v_lshlrev_b32 v252, 7, v252
    s_mul_i32 s78, s34, 3456
    s_add_u32 s78, s78, 98304
    v_bfe_u32 v12, v0, 4, 2
    v_lshlrev_b32 v12, 1, v12
    v_and_b32 v13, 7, v0
    v_xor_b32 v12, v12, v13
    v_lshrrev_b32 v11, 3, v0
    v_mul_u32_u24 v11, 4096, v11
    v_lshl_add_u32 v1, v12, 4, v11
    v_add_u32 v2, 64512, v1
    v_add_u32 v3, 30720, v1
    v_add_u32 v4, 95232, v1
    s_add_u32 m0, s38, 0
    s_nop 0
    buffer_load_dwordx4 v1, s[56:59], s76 offen offset:0 lds
    buffer_load_dwordx4 v2, s[56:59], s76 offen offset:1024 lds
    buffer_load_dwordx4 v3, s[56:59], s76 offen offset:2048 lds
    buffer_load_dwordx4 v4, s[56:59], s76 offen offset:3072 lds
    s_add_u32 m0, s38, 4096
    s_add_u32 s76, s76, 524288
    buffer_load_dwordx4 v1, s[56:59], s76 offen offset:0 lds
    buffer_load_dwordx4 v2, s[56:59], s76 offen offset:1024 lds
    buffer_load_dwordx4 v3, s[56:59], s76 offen offset:2048 lds
    buffer_load_dwordx4 v4, s[56:59], s76 offen offset:3072 lds
    v_mov_b32 v12, 161828
    v_mov_b32 v13, 1
    s_waitcnt vmcnt(0) lgkmcnt(0)
    s_mov_b64 exec, 1
    ds_add_rtn_u32 v13, v12, v13
    s_waitcnt lgkmcnt(0)
    v_readfirstlane_b32 s94, v13
    s_mov_b64 exec, -1
    s_cmp_eq_u32 s94, 3
    s_cbranch_scc0 L_g1wait
L_g1poll:
    s_cmp_ge_u32 s65, 27
    s_cbranch_scc1 L_k513
    s_add_u32 m0, s70, 122880
    s_add_u32 s68, s69, 35840
    buffer_load_dwordx4 v9, s[60:63], s68 offen offset:0 sc1 lds
    buffer_load_dwordx4 v9, s[60:63], s68 offen offset:1024 sc1 lds
    buffer_load_dwordx4 v9, s[60:63], s68 offen offset:2048 sc1 lds
    buffer_load_dwordx4 v9, s[60:63], s68 offen offset:3072 sc1 lds
    s_add_u32 m0, s70, 126976
    s_nop 0
    buffer_load_dwordx4 v10, s[60:63], s68 offen offset:0 sc1 lds
L_k513:
    s_mul_i32 s70, s37, 10240
    s_add_u32 m0, s70, 20480
    s_nop 0
    buffer_load_dwordx4 v9, s[80:83], s84 offen offset:0 sc1 lds
    s_add_u32 m0, s70, 20480
    s_nop 0
    buffer_load_dwordx4 v9, s[80:83], s84 offen offset:1024 sc1 lds
    s_add_u32 m0, s70, 20480
    s_nop 0
    buffer_load_dwordx4 v9, s[80:83], s84 offen offset:2048 sc1 lds
    s_add_u32 m0, s70, 20480
    s_nop 0
    buffer_load_dwordx4 v9, s[80:83], s84 offen offset:3072 sc1 lds
    s_add_u32 m0, s70, 24576
    s_nop 0
    buffer_load_dwordx4 v10, s[80:83], s84 offen offset:0 sc1 lds
    s_add_u32 s84, s84, 5120
    s_add_u32 m0, s70, 25600
    s_nop 0
    buffer_load_dwordx4 v9, s[80:83], s84 offen offset:0 sc1 lds
    s_add_u32 m0, s70, 25600
    s_nop 0
    buffer_load_dwordx4 v9, s[80:83], s84 offen offset:1024 sc1 lds
    s_add_u32 m0, s70, 25600
    s_nop 0
    buffer_load_dwordx4 v9, s[80:83], s84 offen offset:2048 sc1 lds
    s_add_u32 m0, s70, 25600
    s_nop 0
    buffer_load_dwordx4 v9, s[80:83], s84 offen offset:3072 sc1 lds
    s_add_u32 m0, s70, 29696
    s_nop 0
    buffer_load_dwordx4 v10, s[80:83], s84 offen offset:0 sc1 lds
    s_add_u32 s84, s84, 5120
    buffer_load_dword v253, v252, s[72:75], s78 offen sc1
    v_mov_b32 v13, 64
    s_waitcnt vmcnt(11)
    ds_write_b32 v250, v13
    s_mov_b32 s95, 0x20000
    s_branch L_pollw14
L_poll14:
    buffer_load_dword v253, v252, s[72:75], s78 offen sc1
L_pollw14:
    s_waitcnt vmcnt(0)
    v_cmp_ne_u32 vcc, s3, v253
    s_nop 0
    s_and_b32 s92, vcc_lo, 255
    s_cmp_eq_u32 s92, 0
    s_cbranch_scc1 L_polled14
    s_sleep 1
    s_sub_u32 s95, s95, 1
    s_cbranch_scc0 L_poll14
L_polled14:
    v_mov_b32 v12, 161840
    ds_write_b32 v12, v12
    s_branch L_g2
L_g1wait:
    s_setprio 0
    v_mov_b32 v12, 161828
    s_mov_b32 s95, 0x400000
L_spin15:
    ds_read_b32 v13, v12
    s_waitcnt lgkmcnt(0)
    v_readfirstlane_b32 s94, v13
    s_nop 0
    s_cmp_ge_u32 s94, 4
    s_cbranch_scc1 L_spun15
    s_sleep 1
    s_sub_u32 s95, s95, 1
    s_cbranch_scc0 L_spin15
L_spun15:
    s_setprio 2
    s_cmp_ge_u32 s65, 27
    s_cbranch_scc1 L_k516
    s_add_u32 m0, s70, 122880
    s_add_u32 s68, s69, 35840
    buffer_load_dwordx4 v9, s[60:63], s68 offen offset:0 sc1 lds
    buffer_load_dwordx4 v9, s[60:63], s68 offen offset:1024 sc1 lds
    buffer_load_dwordx4 v9, s[60:63], s68 offen offset:2048 sc1 lds
    buffer_load_dwordx4 v9, s[60:63], s68 offen offset:3072 sc1 lds
    s_add_u32 m0, s70, 126976
    s_nop 0
    buffer_load_dwordx4 v10, s[60:63], s68 offen offset:0 sc1 lds
L_k516:
    s_mul_i32 s70, s37, 10240
    s_add_u32 m0, s70, 20480
    s_nop 0
    buffer_load_dwordx4 v9, s[80:83], s84 offen offset:0 sc1 lds
    s_add_u32 m0, s70, 20480
    s_nop 0
    buffer_load_dwordx4 v9, s[80:83], s84 offen offset:1024 sc1 lds
    s_add_u32 m0, s70, 20480
    s_nop 0
    buffer_load_dwordx4 v9, s[80:83], s84 offen offset:2048 sc1 lds
    s_add_u32 m0, s70, 20480
    s_nop 0
    buffer_load_dwordx4 v9, s[80:83], s84 offen offset:3072 sc1 lds
    s_add_u32 m0, s70, 24576
    s_nop 0
    buffer_load_dwordx4 v10, s[80:83], s84 offen offset:0 sc1 lds
    s_add_u32 s84, s84, 5120
    s_add_u32 m0, s70, 25600
    s_nop 0
    buffer_load_dwordx4 v9, s[80:83], s84 offen offset:0 sc1 lds
    s_add_u32 m0, s70, 25600
    s_nop 0
    buffer_load_dwordx4 v9, s[80:83], s84 offen offset:1024 sc1 lds
    s_add_u32 m0, s70, 25600
    s_nop 0
    buffer_load_dwordx4 v9, s[80:83], s84 offen offset:2048 sc1 lds
    s_add_u32 m0, s70, 25600
    s_nop 0
    buffer_load_dwordx4 v9, s[80:83], s84 offen offset:3072 sc1 lds
    s_add_u32 m0, s70, 29696
    s_nop 0
    buffer_load_dwordx4 v10, s[80:83], s84 offen offset:0 sc1 lds
    s_add_u32 s84, s84, 5120
    v_mov_b32 v13, 64
    s_waitcnt vmcnt(10)
    ds_write_b32 v250, v13
    v_mov_b32 v12, 161840
    s_mov_b32 s95, 0x400000
L_spin17:
    ds_read_b32 v13, v12
    s_waitcnt lgkmcnt(0)
    v_readfirstlane_b32 s94, v13
    s_nop 0
    s_cmp_ge_u32 s94, 1
    s_cbranch_scc1 L_spun17
    s_sleep 1
    s_sub_u32 s95, s95, 1
    s_cbranch_scc0 L_spin17
L_spun17:
L_g2:
    buffer_load_dwordx4 v[96:99], v9, s[52:55], s77 offen offset:0 sc1
    buffer_load_dwordx4 v[100:103], v9, s[52:55], s77 offen offset:1024 sc1
    buffer_load_dwordx4 v[104:107], v9, s[52:55], s77 offen offset:2048 sc1
    buffer_load_dwordx4 v[108:111], v9, s[52:55], s77 offen offset:3072 sc1
    buffer_load_dwordx4 v[112:115], v10, s[52:55], s77 offen offset:0 sc1
    s_add_u32 s77, s77, 163840
    buffer_load_dwordx4 v[116:119], v9, s[52:55], s77 offen offset:0 sc1
    buffer_load_dwordx4 v[120:123], v9, s[52:55], s77 offen offset:1024 sc1
    buffer_load_dwordx4 v[124:127], v9, s[52:55], s77 offen offset:2048 sc1
    buffer_load_dwordx4 v[128:131], v9, s[52:55], s77 offen offset:3072 sc1
    buffer_load_dwordx4 v[132:135], v10, s[52:55], s77 offen offset:0 sc1
    s_add_u32 s77, s77, 163840
    buffer_load_dwordx4 v[136:139], v9, s[52:55], s77 offen offset:0 sc1
    buffer_load_dwordx4 v[140:143], v9, s[52:55], s77 offen offset:1024 sc1
    buffer_load_dwordx4 v[144:147], v9, s[52:55], s77 offen offset:2048 sc1
    buffer_load_dwordx4 v[148:151], v9, s[52:55], s77 offen offset:3072 sc1
    buffer_load_dwordx4 v[152:155], v10, s[52:55], s77 offen offset:0 sc1
    buffer_load_dword v253, v252, s[72:75], s78 offen sc1
    s_mul_i32 s36, s33, 81920
    s_add_u32 s36, s36, 2818048
    s_add_u32 s60, s30, s36
    s_addc_u32 s61, s31, 0
    s_mov_b32 s62, 81920
    s_mov_b32 s63, 0x20000
    s_mul_i32 s71, s37, 20480
    v_mov_b32 v11, 161844
    s_mov_b32 s39, 0
    s_xor_b32 s36, s88, 0
    s_lshl_b32 s36, s36, 10
    s_add_u32 s84, s36, s71
    s_xor_b32 s36, s88, 1
    s_lshl_b32 s36, s36, 10
    s_add_u32 s85, s36, s71
    s_xor_b32 s36, s88, 2
    s_lshl_b32 s36, s36, 10
    s_add_u32 s86, s36, s71
    s_xor_b32 s36, s88, 3
    s_lshl_b32 s36, s36, 10
    s_add_u32 s87, s36, s71
    ds_read_b64_tr_b16 v[156:157], v5 offset:0
    ds_read_b64_tr_b16 v[158:159], v5 offset:2048
    ds_read_b64_tr_b16 v[160:161], v6 offset:0
    ds_read_b64_tr_b16 v[162:163], v6 offset:2048
    ds_read_b64_tr_b16 v[164:165], v7 offset:0
    ds_read_b64_tr_b16 v[166:167], v7 offset:2048
    ds_read_b64_tr_b16 v[168:169], v8 offset:0
    ds_read_b64_tr_b16 v[170:171], v8 offset:2048
    s_waitcnt vmcnt(11) lgkmcnt(0)
    s_setprio 0
    s_add_u32 m0, s38, 0
    s_add_u32 s76, s76, 524288
    buffer_load_dwordx4 v1, s[56:59], s76 offen offset:0 lds
    v_mfma_f32_16x16x32_bf16 v[16:19], v[96:99], v[156:159], 0
    v_mfma_f32_16x16x32_bf16 v[20:23], v[96:99], v[160:163], 0
    buffer_load_dwordx4 v2, s[56:59], s76 offen offset:1024 lds
    v_mfma_f32_16x16x32_bf16 v[24:27], v[96:99], v[164:167], 0
    v_mfma_f32_16x16x32_bf16 v[28:31], v[96:99], v[168:171], 0
    buffer_load_dwordx4 v3, s[56:59], s76 offen offset:2048 lds
    v_mfma_f32_16x16x32_bf16 v[44:47], v[100:103], v[168:171], 0
    v_mfma_f32_16x16x32_bf16 v[40:43], v[100:103], v[164:167], 0
    buffer_load_dwordx4 v4, s[56:59], s76 offen offset:3072 lds
    v_mfma_f32_16x16x32_bf16 v[36:39], v[100:103], v[160:163], 0
    v_mfma_f32_16x16x32_bf16 v[32:35], v[100:103], v[156:159], 0
    s_add_u32 s77, s77, 163840
    buffer_load_dwordx4 v[96:99], v9, s[52:55], s77 offen offset:0 sc1
    v_mfma_f32_16x16x32_bf16 v[48:51], v[104:107], v[156:159], 0
    v_mfma_f32_16x16x32_bf16 v[52:55], v[104:107], v[160:163], 0
    buffer_load_dwordx4 v[100:103], v9, s[52:55], s77 offen offset:1024 sc1
    v_mfma_f32_16x16x32_bf16 v[56:59], v[104:107], v[164:167], 0
    v_mfma_f32_16x16x32_bf16 v[60:63], v[104:107], v[168:171], 0
    ds_read_b64_tr_b16 v[172:173], v5 offset:4096
    ds_read_b64_tr_b16 v[174:175], v5 offset:6144
    buffer_load_dwordx4 v[104:107], v9, s[52:55], s77 offen offset:2048 sc1
    v_mfma_f32_16x16x32_bf16 v[76:79], v[108:111], v[168:171], 0
    v_mfma_f32_16x16x32_bf16 v[72:75], v[108:111], v[164:167], 0
    ds_read_b64_tr_b16 v[176:177], v6 offset:4096
    ds_read_b64_tr_b16 v[178:179], v6 offset:6144
    v_mfma_f32_16x16x32_bf16 v[68:71], v[108:111], v[160:163], 0
    v_mfma_f32_16x16x32_bf16 v[64:67], v[108:111], v[156:159], 0
    ds_read_b64_tr_b16 v[180:181], v7 offset:4096
    ds_read_b64_tr_b16 v[182:183], v7 offset:6144
    buffer_load_dwordx4 v[108:111], v9, s[52:55], s77 offen offset:3072 sc1
    v_mfma_f32_16x16x32_bf16 v[80:83], v[112:115], v[156:159], 0
    v_mfma_f32_16x16x32_bf16 v[84:87], v[112:115], v[160:163], 0
    ds_read_b64_tr_b16 v[184:185], v8 offset:4096
    ds_read_b64_tr_b16 v[186:187], v8 offset:6144
    v_mfma_f32_16x16x32_bf16 v[88:91], v[112:115], v[164:167], 0
    v_mfma_f32_16x16x32_bf16 v[92:95], v[112:115], v[168:171], 0
    buffer_load_dwordx4 v[112:115], v10, s[52:55], s77 offen offset:0 sc1
    s_waitcnt vmcnt(15) lgkmcnt(0)
    s_setprio 2
    s_waitcnt vmcnt(9)
    v_cmp_ne_u32 vcc, s3, v253
    s_nop 0
    s_cmp_eq_u64 vcc, 0
    s_cbranch_scc1 L_ok18
    s_mov_b32 s95, 0x20000
L_poll19:
    buffer_load_dword v253, v252, s[72:75], s78 offen sc1
L_pollw19:
    s_waitcnt vmcnt(0)
    v_cmp_ne_u32 vcc, s3, v253
    s_nop 0
    s_cmp_eq_u64 vcc, 0
    s_cbranch_scc1 L_polled19
    s_sleep 2
    s_sub_u32 s95, s95, 1
    s_cbranch_scc0 L_poll19
L_polled19:
L_ok18:
    s_setprio 0
    s_add_u32 m0, s38, 4096
    s_add_u32 s76, s76, 524288
    buffer_load_dwordx4 v1, s[56:59], s76 offen offset:0 lds
    v_mfma_f32_16x16x32_bf16 v[16:19], v[116:119], v[172:175], v[16:19]
    v_mfma_f32_16x16x32_bf16 v[20:23], v[116:119], v[176:179], v[20:23]
    buffer_load_dwordx4 v2, s[56:59], s76 offen offset:1024 lds
    v_mfma_f32_16x16x32_bf16 v[24:27], v[116:119], v[180:183], v[24:27]
    v_mfma_f32_16x16x32_bf16 v[28:31], v[116:119], v[184:187], v[28:31]
    buffer_load_dwordx4 v3, s[56:59], s76 offen offset:2048 lds
    v_mfma_f32_16x16x32_bf16 v[44:47], v[120:123], v[184:187], v[44:47]
    v_mfma_f32_16x16x32_bf16 v[40:43], v[120:123], v[180:183], v[40:43]
    buffer_load_dwordx4 v4, s[56:59], s76 offen offset:3072 lds
    v_mfma_f32_16x16x32_bf16 v[36:39], v[120:123], v[176:179], v[36:39]
    v_mfma_f32_16x16x32_bf16 v[32:35], v[120:123], v[172:175], v[32:35]
    s_add_u32 s77, s77, 163840
    buffer_load_dwordx4 v[116:119], v9, s[52:55], s77 offen offset:0 sc1
    v_mfma_f32_16x16x32_bf16 v[48:51], v[124:127], v[172:175], v[48:51]
    v_mfma_f32_16x16x32_bf16 v[52:55], v[124:127], v[176:179], v[52:55]
    buffer_load_dwordx4 v[120:123], v9, s[52:55], s77 offen offset:1024 sc1
    v_mfma_f32_16x16x32_bf16 v[56:59], v[124:127], v[180:183], v[56:59]
    v_mfma_f32_16x16x32_bf16 v[60:63], v[124:127], v[184:187], v[60:63]
    s_waitcnt vmcnt(11)
    ds_read_b64_tr_b16 v[156:157], v5 offset:0
    ds_read_b64_tr_b16 v[158:159], v5 offset:2048
    buffer_load_dwordx4 v[124:127], v9, s[52:55], s77 offen offset:2048 sc1
    v_mfma_f32_16x16x32_bf16 v[76:79], v[128:131], v[184:187], v[76:79]
    v_mfma_f32_16x16x32_bf16 v[72:75], v[128:131], v[180:183], v[72:75]
    ds_read_b64_tr_b16 v[160:161], v6 offset:0
    ds_read_b64_tr_b16 v[162:163], v6 offset:2048
    v_mfma_f32_16x16x32_bf16 v[68:71], v[128:131], v[176:179], v[68:71]
    v_mfma_f32_16x16x32_bf16 v[64:67], v[128:131], v[172:175], v[64:67]
    ds_read_b64_tr_b16 v[164:165], v7 offset:0
    ds_read_b64_tr_b16 v[166:167], v7 offset:2048
    buffer_load_dwordx4 v[128:131], v9, s[52:55], s77 offen offset:3072 sc1
    v_mfma_f32_16x16x32_bf16 v[80:83], v[132:135], v[172:175], v[80:83]
    v_mfma_f32_16x16x32_bf16 v[84:87], v[132:135], v[176:179], v[84:87]
    ds_read_b64_tr_b16 v[168:169], v8 offset:0
    ds_read_b64_tr_b16 v[170:171], v8 offset:2048
    v_mfma_f32_16x16x32_bf16 v[88:91], v[132:135], v[180:183], v[88:91]
    v_mfma_f32_16x16x32_bf16 v[92:95], v[132:135], v[184:187], v[92:95]
    buffer_load_dwordx4 v[132:135], v10, s[52:55], s77 offen offset:0 sc1
    s_waitcnt lgkmcnt(0)
    s_add_u32 m0, s38, 0
    s_add_u32 s76, s76, 524288
    buffer_load_dwordx4 v1, s[56:59], s76 offen offset:0 lds
    v_mfma_f32_16x16x32_bf16 v[16:19], v[136:139], v[156:159], v[16:19]
    v_mfma_f32_16x16x32_bf16 v[20:23], v[136:139], v[160:163], v[20:23]
    buffer_load_dwordx4 v2, s[56:59], s76 offen offset:1024 lds
    v_mfma_f32_16x16x32_bf16 v[24:27], v[136:139], v[164:167], v[24:27]
    v_mfma_f32_16x16x32_bf16 v[28:31], v[136:139], v[168:171], v[28:31]
    buffer_load_dwordx4 v3, s[56:59], s76 offen offset:2048 lds
    v_mfma_f32_16x16x32_bf16 v[44:47], v[140:143], v[168:171], v[44:47]
    v_mfma_f32_16x16x32_bf16 v[40:43], v[140:143], v[164:167], v[40:43]
    buffer_load_dwordx4 v4, s[56:59], s76 offen offset:3072 lds
    v_mfma_f32_16x16x32_bf16 v[36:39], v[140:143], v[160:163], v[36:39]
    v_mfma_f32_16x16x32_bf16 v[32:35], v[140:143], v[156:159], v[32:35]
    s_add_u32 s77, s77, 163840
    buffer_load_dwordx4 v[136:139], v9, s[52:55], s77 offen offset:0 sc1
    v_mfma_f32_16x16x32_bf16 v[48:51], v[144:147], v[156:159], v[48:51]
    v_mfma_f32_16x16x32_bf16 v[52:55], v[144:147], v[160:163], v[52:55]
    buffer_load_dwordx4 v[140:143], v9, s[52:55], s77 offen offset:1024 sc1
    v_mfma_f32_16x16x32_bf16 v[56:59], v[144:147], v[164:167], v[56:59]
    v_mfma_f32_16x16x32_bf16 v[60:63], v[144:147], v[168:171], v[60:63]
    s_waitcnt vmcnt(11)
    ds_read_b64_tr_b16 v[172:173], v5 offset:4096
    ds_read_b64_tr_b16 v[174:175], v5 offset:6144
    buffer_load_dwordx4 v[144:147], v9, s[52:55], s77 offen offset:2048 sc1
    v_mfma_f32_16x16x32_bf16 v[76:79], v[148:151], v[168:171], v[76:79]
    v_mfma_f32_16x16x32_bf16 v[72:75], v[148:151], v[164:167], v[72:75]
    ds_read_b64_tr_b16 v[176:177], v6 offset:4096
    ds_read_b64_tr_b16 v[178:179], v6 offset:6144
    v_mfma_f32_16x16x32_bf16 v[68:71], v[148:151], v[160:163], v[68:71]
    v_mfma_f32_16x16x32_bf16 v[64:67], v[148:151], v[156:159], v[64:67]
    ds_read_b64_tr_b16 v[180:181], v7 offset:4096
    ds_read_b64_tr_b16 v[182:183], v7 offset:6144
    buffer_load_dwordx4 v[148:151], v9, s[52:55], s77 offen offset:3072 sc1
    v_mfma_f32_16x16x32_bf16 v[80:83], v[152:155], v[156:159], v[80:83]
    v_mfma_f32_16x16x32_bf16 v[84:87], v[152:155], v[160:163], v[84:87]
    ds_read_b64_tr_b16 v[184:185], v8 offset:4096
    ds_read_b64_tr_b16 v[186:187], v8 offset:6144
    v_mfma_f32_16x16x32_bf16 v[88:91], v[152:155], v[164:167], v[88:91]
    v_mfma_f32_16x16x32_bf16 v[92:95], v[152:155], v[168:171], v[92:95]
    buffer_load_dwordx4 v[152:155], v10, s[52:55], s77 offen offset:0 sc1
    s_waitcnt lgkmcnt(0)
    s_add_u32 m0, s38, 4096
    s_add_u32 s76, s76, 524288
    buffer_load_dwordx4 v1, s[56:59], s76 offen offset:0 lds
    v_mfma_f32_16x16x32_bf16 v[16:19], v[96:99], v[172:175], v[16:19]
    v_mfma_f32_16x16x32_bf16 v[20:23], v[96:99], v[176:179], v[20:23]
    buffer_load_dwordx4 v2, s[56:59], s76 offen offset:1024 lds
    v_mfma_f32_16x16x32_bf16 v[24:27], v[96:99], v[180:183], v[24:27]
    v_mfma_f32_16x16x32_bf16 v[28:31], v[96:99], v[184:187], v[28:31]
    buffer_load_dwordx4 v3, s[56:59], s76 offen offset:2048 lds
    v_mfma_f32_16x16x32_bf16 v[44:47], v[100:103], v[184:187], v[44:47]
    v_mfma_f32_16x16x32_bf16 v[40:43], v[100:103], v[180:183], v[40:43]
    buffer_load_dwordx4 v4, s[56:59], s76 offen offset:3072 lds
    v_mfma_f32_16x16x32_bf16 v[36:39], v[100:103], v[176:179], v[36:39]
    v_mfma_f32_16x16x32_bf16 v[32:35], v[100:103], v[172:175], v[32:35]
    s_add_u32 s77, s77, 163840
    buffer_load_dwordx4 v[96:99], v9, s[52:55], s77 offen offset:0 sc1
    v_mfma_f32_16x16x32_bf16 v[48:51], v[104:107], v[172:175], v[48:51]
    v_mfma_f32_16x16x32_bf16 v[52:55], v[104:107], v[176:179], v[52:55]
    buffer_load_dwordx4 v[100:103], v9, s[52:55], s77 offen offset:1024 sc1
    v_mfma_f32_16x16x32_bf16 v[56:59], v[104:107], v[180:183], v[56:59]
    v_mfma_f32_16x16x32_bf16 v[60:63], v[104:107], v[184:187], v[60:63]
    s_waitcnt vmcnt(11)
    ds_read_b64_tr_b16 v[156:157], v5 offset:0
    ds_read_b64_tr_b16 v[158:159], v5 offset:2048
    buffer_load_dwordx4 v[104:107], v9, s[52:55], s77 offen offset:2048 sc1
    v_mfma_f32_16x16x32_bf16 v[76:79], v[108:111], v[184:187], v[76:79]
    v_mfma_f32_16x16x32_bf16 v[72:75], v[108:111], v[180:183], v[72:75]
    ds_read_b64_tr_b16 v[160:161], v6 offset:0
    ds_read_b64_tr_b16 v[162:163], v6 offset:2048
    v_mfma_f32_16x16x32_bf16 v[68:71], v[108:111], v[176:179], v[68:71]
    v_mfma_f32_16x16x32_bf16 v[64:67], v[108:111], v[172:175], v[64:67]
    ds_read_b64_tr_b16 v[164:165], v7 offset:0
    ds_read_b64_tr_b16 v[166:167], v7 offset:2048
    buffer_load_dwordx4 v[108:111], v9, s[52:55], s77 offen offset:3072 sc1
    v_mfma_f32_16x16x32_bf16 v[80:83], v[112:115], v[172:175], v[80:83]
    v_mfma_f32_16x16x32_bf16 v[84:87], v[112:115], v[176:179], v[84:87]
    ds_read_b64_tr_b16 v[168:169], v8 offset:0
    ds_read_b64_tr_b16 v[170:171], v8 offset:2048
    v_mfma_f32_16x16x32_bf16 v[88:91], v[112:115], v[180:183], v[88:91]
    v_mfma_f32_16x16x32_bf16 v[92:95], v[112:115], v[184:187], v[92:95]
    buffer_load_dwordx4 v[112:115], v10, s[52:55], s77 offen offset:0 sc1
    s_waitcnt lgkmcnt(0)
    s_add_u32 m0, s38, 0
    s_add_u32 s76, s76, 524288
    buffer_load_dwordx4 v1, s[56:59], s76 offen offset:0 lds
    v_mfma_f32_16x16x32_bf16 v[16:19], v[116:119], v[156:159], v[16:19]
    v_mfma_f32_16x16x32_bf16 v[20:23], v[116:119], v[160:163], v[20:23]
    buffer_load_dwordx4 v2, s[56:59], s76 offen offset:1024 lds
    v_mfma_f32_16x16x32_bf16 v[24:27], v[116:119], v[164:167], v[24:27]
    v_mfma_f32_16x16x32_bf16 v[28:31], v[116:119], v[168:171], v[28:31]
    buffer_load_dwordx4 v3, s[56:59], s76 offen offset:2048 lds
    v_mfma_f32_16x16x32_bf16 v[44:47], v[120:123], v[168:171], v[44:47]
    v_mfma_f32_16x16x32_bf16 v[40:43], v[120:123], v[164:167], v[40:43]
    buffer_load_dwordx4 v4, s[56:59], s76 offen offset:3072 lds
    v_mfma_f32_16x16x32_bf16 v[36:39], v[120:123], v[160:163], v[36:39]
    v_mfma_f32_16x16x32_bf16 v[32:35], v[120:123], v[156:159], v[32:35]
    s_add_u32 s77, s77, 163840
    buffer_load_dwordx4 v[116:119], v9, s[52:55], s77 offen offset:0 sc1
    v_mfma_f32_16x16x32_bf16 v[48:51], v[124:127], v[156:159], v[48:51]
    v_mfma_f32_16x16x32_bf16 v[52:55], v[124:127], v[160:163], v[52:55]
    buffer_load_dwordx4 v[120:123], v9, s[52:55], s77 offen offset:1024 sc1
    v_mfma_f32_16x16x32_bf16 v[56:59], v[124:127], v[164:167], v[56:59]
    v_mfma_f32_16x16x32_bf16 v[60:63], v[124:127], v[168:171], v[60:63]
    s_waitcnt vmcnt(11)
    ds_read_b64_tr_b16 v[172:173], v5 offset:4096
    ds_read_b64_tr_b16 v[174:175], v5 offset:6144
    buffer_load_dwordx4 v[124:127], v9, s[52:55], s77 offen offset:2048 sc1
    v_mfma_f32_16x16x32_bf16 v[76:79], v[128:131], v[168:171], v[76:79]
    v_mfma_f32_16x16x32_bf16 v[72:75], v[128:131], v[164:167], v[72:75]
    ds_read_b64_tr_b16 v[176:177], v6 offset:4096
    ds_read_b64_tr_b16 v[178:179], v6 offset:6144
    v_mfma_f32_16x16x32_bf16 v[68:71], v[128:131], v[160:163], v[68:71]
    v_mfma_f32_16x16x32_bf16 v[64:67], v[128:131], v[156:159], v[64:67]
    ds_read_b64_tr_b16 v[180:181], v7 offset:4096
    ds_read_b64_tr_b16 v[182:183], v7 offset:6144
    buffer_load_dwordx4 v[128:131], v9, s[52:55], s77 offen offset:3072 sc1
    v_mfma_f32_16x16x32_bf16 v[80:83], v[132:135], v[156:159], v[80:83]
    v_mfma_f32_16x16x32_bf16 v[84:87], v[132:135], v[160:163], v[84:87]
    ds_read_b64_tr_b16 v[184:185], v8 offset:4096
    ds_read_b64_tr_b16 v[186:187], v8 offset:6144
    v_mfma_f32_16x16x32_bf16 v[88:91], v[132:135], v[164:167], v[88:91]
    v_mfma_f32_16x16x32_bf16 v[92:95], v[132:135], v[168:171], v[92:95]
    buffer_load_dwordx4 v[132:135], v10, s[52:55], s77 offen offset:0 sc1
    s_waitcnt lgkmcnt(0)
    s_add_u32 m0, s38, 4096
    s_add_u32 s76, s76, 524288
    buffer_load_dwordx4 v1, s[56:59], s76 offen offset:0 lds
    v_mfma_f32_16x16x32_bf16 v[16:19], v[136:139], v[172:175], v[16:19]
    v_mfma_f32_16x16x32_bf16 v[20:23], v[136:139], v[176:179], v[20:23]
    buffer_load_dwordx4 v2, s[56:59], s76 offen offset:1024 lds
    v_mfma_f32_16x16x32_bf16 v[24:27], v[136:139], v[180:183], v[24:27]
    v_mfma_f32_16x16x32_bf16 v[28:31], v[136:139], v[184:187], v[28:31]
    buffer_load_dwordx4 v3, s[56:59], s76 offen offset:2048 lds
    v_mfma_f32_16x16x32_bf16 v[44:47], v[140:143], v[184:187], v[44:47]
    v_mfma_f32_16x16x32_bf16 v[40:43], v[140:143], v[180:183], v[40:43]
    buffer_load_dwordx4 v4, s[56:59], s76 offen offset:3072 lds
    v_mfma_f32_16x16x32_bf16 v[36:39], v[140:143], v[176:179], v[36:39]
    v_mfma_f32_16x16x32_bf16 v[32:35], v[140:143], v[172:175], v[32:35]
    s_add_u32 s77, s77, 163840
    buffer_load_dwordx4 v[136:139], v9, s[52:55], s77 offen offset:0 sc1
    v_mfma_f32_16x16x32_bf16 v[48:51], v[144:147], v[172:175], v[48:51]
    v_mfma_f32_16x16x32_bf16 v[52:55], v[144:147], v[176:179], v[52:55]
    buffer_load_dwordx4 v[140:143], v9, s[52:55], s77 offen offset:1024 sc1
    v_mfma_f32_16x16x32_bf16 v[56:59], v[144:147], v[180:183], v[56:59]
    v_mfma_f32_16x16x32_bf16 v[60:63], v[144:147], v[184:187], v[60:63]
    s_waitcnt vmcnt(11)
    ds_read_b64_tr_b16 v[156:157], v5 offset:0
    ds_read_b64_tr_b16 v[158:159], v5 offset:2048
    buffer_load_dwordx4 v[144:147], v9, s[52:55], s77 offen offset:2048 sc1
    v_mfma_f32_16x16x32_bf16 v[76:79], v[148:151], v[184:187], v[76:79]
    v_mfma_f32_16x16x32_bf16 v[72:75], v[148:151], v[180:183], v[72:75]
    ds_read_b64_tr_b16 v[160:161], v6 offset:0
    ds_read_b64_tr_b16 v[162:163], v6 offset:2048
    v_mfma_f32_16x16x32_bf16 v[68:71], v[148:151], v[176:179], v[68:71]
    v_mfma_f32_16x16x32_bf16 v[64:67], v[148:151], v[172:175], v[64:67]
    ds_read_b64_tr_b16 v[164:165], v7 offset:0
    ds_read_b64_tr_b16 v[166:167], v7 offset:2048
    buffer_load_dwordx4 v[148:151], v9, s[52:55], s77 offen offset:3072 sc1
    v_mfma_f32_16x16x32_bf16 v[80:83], v[152:155], v[172:175], v[80:83]
    v_mfma_f32_16x16x32_bf16 v[84:87], v[152:155], v[176:179], v[84:87]
    ds_read_b64_tr_b16 v[168:169], v8 offset:0
    ds_read_b64_tr_b16 v[170:171], v8 offset:2048
    v_mfma_f32_16x16x32_bf16 v[88:91], v[152:155], v[180:183], v[88:91]
    v_mfma_f32_16x16x32_bf16 v[92:95], v[152:155], v[184:187], v[92:95]
    buffer_load_dwordx4 v[152:155], v10, s[52:55], s77 offen offset:0 sc1
    s_waitcnt lgkmcnt(0)
    s_add_u32 m0, s38, 0
    s_add_u32 s76, s76, 524288
    buffer_load_dwordx4 v1, s[56:59], s76 offen offset:0 lds
    v_mfma_f32_16x16x32_bf16 v[16:19], v[96:99], v[156:159], v[16:19]
    v_mfma_f32_16x16x32_bf16 v[20:23], v[96:99], v[160:163], v[20:23]
    buffer_load_dwordx4 v2, s[56:59], s76 offen offset:1024 lds
    v_mfma_f32_16x16x32_bf16 v[24:27], v[96:99], v[164:167], v[24:27]
    v_mfma_f32_16x16x32_bf16 v[28:31], v[96:99], v[168:171], v[28:31]
    buffer_load_dwordx4 v3, s[56:59], s76 offen offset:2048 lds
    v_mfma_f32_16x16x32_bf16 v[44:47], v[100:103], v[168:171], v[44:47]
    v_mfma_f32_16x16x32_bf16 v[40:43], v[100:103], v[164:167], v[40:43]
    buffer_load_dwordx4 v4, s[56:59], s76 offen offset:3072 lds
    v_mfma_f32_16x16x32_bf16 v[36:39], v[100:103], v[160:163], v[36:39]
    v_mfma_f32_16x16x32_bf16 v[32:35], v[100:103], v[156:159], v[32:35]
    s_add_u32 s77, s77, 163840
    buffer_load_dwordx4 v[96:99], v9, s[52:55], s77 offen offset:0 sc1
    v_mfma_f32_16x16x32_bf16 v[48:51], v[104:107], v[156:159], v[48:51]
    v_mfma_f32_16x16x32_bf16 v[52:55], v[104:107], v[160:163], v[52:55]
    buffer_load_dwordx4 v[100:103], v9, s[52:55], s77 offen offset:1024 sc1
    v_mfma_f32_16x16x32_bf16 v[56:59], v[104:107], v[164:167], v[56:59]
    v_mfma_f32_16x16x32_bf16 v[60:63], v[104:107], v[168:171], v[60:63]
    s_waitcnt vmcnt(11)
    ds_read_b64_tr_b16 v[172:173], v5 offset:4096
    ds_read_b64_tr_b16 v[174:175], v5 offset:6144
    buffer_load_dwordx4 v[104:107], v9, s[52:55], s77 offen offset:2048 sc1
    v_mfma_f32_16x16x32_bf16 v[76:79], v[108:111], v[168:171], v[76:79]
    v_mfma_f32_16x16x32_bf16 v[72:75], v[108:111], v[164:167], v[72:75]
    ds_read_b64_tr_b16 v[176:177], v6 offset:4096
    ds_read_b64_tr_b16 v[178:179], v6 offset:6144
    v_mfma_f32_16x16x32_bf16 v[68:71], v[108:111], v[160:163], v[68:71]
    v_mfma_f32_16x16x32_bf16 v[64:67], v[108:111], v[156:159], v[64:67]
    ds_read_b64_tr_b16 v[180:181], v7 offset:4096
    ds_read_b64_tr_b16 v[182:183], v7 offset:6144
    buffer_load_dwordx4 v[108:111], v9, s[52:55], s77 offen offset:3072 sc1
    v_mfma_f32_16x16x32_bf16 v[80:83], v[112:115], v[156:159], v[80:83]
    v_mfma_f32_16x16x32_bf16 v[84:87], v[112:115], v[160:163], v[84:87]
    ds_read_b64_tr_b16 v[184:185], v8 offset:4096
    ds_read_b64_tr_b16 v[186:187], v8 offset:6144
    v_mfma_f32_16x16x32_bf16 v[88:91], v[112:115], v[164:167], v[88:91]
    v_mfma_f32_16x16x32_bf16 v[92:95], v[112:115], v[168:171], v[92:95]
    buffer_load_dwordx4 v[112:115], v10, s[52:55], s77 offen offset:0 sc1
    s_waitcnt lgkmcnt(0)
    s_add_u32 m0, s38, 4096
    s_add_u32 s76, s76, 524288
    buffer_load_dwordx4 v1, s[56:59], s76 offen offset:0 lds
    v_mfma_f32_16x16x32_bf16 v[16:19], v[116:119], v[172:175], v[16:19]
    v_mfma_f32_16x16x32_bf16 v[20:23], v[116:119], v[176:179], v[20:23]
    buffer_load_dwordx4 v2, s[56:59], s76 offen offset:1024 lds
    v_mfma_f32_16x16x32_bf16 v[24:27], v[116:119], v[180:183], v[24:27]
    v_mfma_f32_16x16x32_bf16 v[28:31], v[116:119], v[184:187], v[28:31]
    buffer_load_dwordx4 v3, s[56:59], s76 offen offset:2048 lds
    v_mfma_f32_16x16x32_bf16 v[44:47], v[120:123], v[184:187], v[44:47]
    v_mfma_f32_16x16x32_bf16 v[40:43], v[120:123], v[180:183], v[40:43]
    buffer_load_dwordx4 v4, s[56:59], s76 offen offset:3072 lds
    v_mfma_f32_16x16x32_bf16 v[36:39], v[120:123], v[176:179], v[36:39]
    v_mfma_f32_16x16x32_bf16 v[32:35], v[120:123], v[172:175], v[32:35]
    s_add_u32 s77, s77, 163840
    buffer_load_dwordx4 v[116:119], v9, s[52:55], s77 offen offset:0 sc1
    v_mfma_f32_16x16x32_bf16 v[48:51], v[124:127], v[172:175], v[48:51]
    v_mfma_f32_16x16x32_bf16 v[52:55], v[124:127], v[176:179], v[52:55]
    buffer_load_dwordx4 v[120:123], v9, s[52:55], s77 offen offset:1024 sc1
    v_mfma_f32_16x16x32_bf16 v[56:59], v[124:127], v[180:183], v[56:59]
    v_mfma_f32_16x16x32_bf16 v[60:63], v[124:127], v[184:187], v[60:63]
    s_waitcnt vmcnt(11)
    ds_read_b64_tr_b16 v[156:157], v5 offset:0
    ds_read_b64_tr_b16 v[158:159], v5 offset:2048
    buffer_load_dwordx4 v[124:127], v9, s[52:55], s77 offen offset:2048 sc1
    v_mfma_f32_16x16x32_bf16 v[76:79], v[128:131], v[184:187], v[76:79]
    v_mfma_f32_16x16x32_bf16 v[72:75], v[128:131], v[180:183], v[72:75]
    ds_read_b64_tr_b16 v[160:161], v6 offset:0
    ds_read_b64_tr_b16 v[162:163], v6 offset:2048
    v_mfma_f32_16x16x32_bf16 v[68:71], v[128:131], v[176:179], v[68:71]
    v_mfma_f32_16x16x32_bf16 v[64:67], v[128:131], v[172:175], v[64:67]
    ds_read_b64_tr_b16 v[164:165], v7 offset:0
    ds_read_b64_tr_b16 v[166:167], v7 offset:2048
    buffer_load_dwordx4 v[128:131], v9, s[52:55], s77 offen offset:3072 sc1
    v_mfma_f32_16x16x32_bf16 v[80:83], v[132:135], v[172:175], v[80:83]
    v_mfma_f32_16x16x32_bf16 v[84:87], v[132:135], v[176:179], v[84:87]
    ds_read_b64_tr_b16 v[168:169], v8 offset:0
    ds_read_b64_tr_b16 v[170:171], v8 offset:2048
    v_mfma_f32_16x16x32_bf16 v[88:91], v[132:135], v[180:183], v[88:91]
    v_mfma_f32_16x16x32_bf16 v[92:95], v[132:135], v[184:187], v[92:95]
    buffer_load_dwordx4 v[132:135], v10, s[52:55], s77 offen offset:0 sc1
    s_waitcnt lgkmcnt(0)
    s_setprio 2
    s_mov_b32 s48, s22
    s_mov_b32 s49, s23
    s_mov_b32 s50, 4096
    s_mov_b32 s51, 0x20000
    v_bfe_u32 v12, v0, 1, 2
    v_lshlrev_b32 v12, 14, v12
    v_bfe_u32 v13, v0, 3, 1
    v_lshl_add_u32 v12, v13, 6, v12
    v_and_b32 v13, 1, v0
    v_lshl_add_u32 v252, v13, 3, v12
    v_and_b32 v12, 15, v0
    v_lshlrev_b32 v12, 1, v12
    s_lshl_b32 s36, s33, 2
    s_add_u32 s36, s36, s37
    s_lshl_b32 s68, s36, 7
    s_lshl_b32 s67, s36, 5
    s_mul_i32 s64, s36, 20480
    buffer_load_ushort v15, v12, s[48:51], s67 offen
    buffer_load_dwordx2 v[248:249], v252, s[72:75], s68 offen offset:0 sc1
    s_setprio 0
    s_add_u32 m0, s38, 0
    s_add_u32 s76, s76, 524288
    buffer_load_dwordx4 v1, s[56:59], s76 offen offset:0 lds
    v_mfma_f32_16x16x32_bf16 v[16:19], v[136:139], v[156:159], v[16:19]
    v_mfma_f32_16x16x32_bf16 v[20:23], v[136:139], v[160:163], v[20:23]
    buffer_load_dwordx4 v2, s[56:59], s76 offen offset:1024 lds
    v_mfma_f32_16x16x32_bf16 v[24:27], v[136:139], v[164:167], v[24:27]
    v_mfma_f32_16x16x32_bf16 v[28:31], v[136:139], v[168:171], v[28:31]
    buffer_load_dwordx4 v3, s[56:59], s76 offen offset:2048 lds
    v_mfma_f32_16x16x32_bf16 v[44:47], v[140:143], v[168:171], v[44:47]
    v_mfma_f32_16x16x32_bf16 v[40:43], v[140:143], v[164:167], v[40:43]
    buffer_load_dwordx4 v4, s[56:59], s76 offen offset:3072 lds
    v_mfma_f32_16x16x32_bf16 v[36:39], v[140:143], v[160:163], v[36:39]
    v_mfma_f32_16x16x32_bf16 v[32:35], v[140:143], v[156:159], v[32:35]
    s_add_u32 s77, s77, 163840
    buffer_load_dwordx4 v[136:139], v9, s[52:55], s77 offen offset:0 sc1
    v_mfma_f32_16x16x32_bf16 v[48:51], v[144:147], v[156:159], v[48:51]
    v_mfma_f32_16x16x32_bf16 v[52:55], v[144:147], v[160:163], v[52:55]
    buffer_load_dwordx4 v[140:143], v9, s[52:55], s77 offen offset:1024 sc1
    v_mfma_f32_16x16x32_bf16 v[56:59], v[144:147], v[164:167], v[56:59]
    v_mfma_f32_16x16x32_bf16 v[60:63], v[144:147], v[168:171], v[60:63]
    s_waitcnt vmcnt(13)
    ds_read_b64_tr_b16 v[172:173], v5 offset:4096
    ds_read_b64_tr_b16 v[174:175], v5 offset:6144
    buffer_load_dwordx4 v[144:147], v9, s[52:55], s77 offen offset:2048 sc1
    v_mfma_f32_16x16x32_bf16 v[76:79], v[148:151], v[168:171], v[76:79]
    v_mfma_f32_16x16x32_bf16 v[72:75], v[148:151], v[164:167], v[72:75]
    ds_read_b64_tr_b16 v[176:177], v6 offset:4096
    ds_read_b64_tr_b16 v[178:179], v6 offset:6144
    v_mfma_f32_16x16x32_bf16 v[68:71], v[148:151], v[160:163], v[68:71]
    v_mfma_f32_16x16x32_bf16 v[64:67], v[148:151], v[156:159], v[64:67]
    ds_read_b64_tr_b16 v[180:181], v7 offset:4096
    ds_read_b64_tr_b16 v[182:183], v7 offset:6144
    buffer_load_dwordx4 v[148:151], v9, s[52:55], s77 offen offset:3072 sc1
    v_mfma_f32_16x16x32_bf16 v[80:83], v[152:155], v[156:159], v[80:83]
    v_mfma_f32_16x16x32_bf16 v[84:87], v[152:155], v[160:163], v[84:87]
    ds_read_b64_tr_b16 v[184:185], v8 offset:4096
    ds_read_b64_tr_b16 v[186:187], v8 offset:6144
    v_mfma_f32_16x16x32_bf16 v[88:91], v[152:155], v[164:167], v[88:91]
    v_mfma_f32_16x16x32_bf16 v[92:95], v[152:155], v[168:171], v[92:95]
    buffer_load_dwordx4 v[152:155], v10, s[52:55], s77 offen offset:0 sc1
    s_waitcnt lgkmcnt(0)
    s_add_u32 m0, s38, 4096
    s_add_u32 s76, s76, 524288
    buffer_load_dwordx4 v1, s[56:59], s76 offen offset:0 lds
    v_mfma_f32_16x16x32_bf16 v[16:19], v[96:99], v[172:175], v[16:19]
    v_mfma_f32_16x16x32_bf16 v[20:23], v[96:99], v[176:179], v[20:23]
    buffer_load_dwordx4 v2, s[56:59], s76 offen offset:1024 lds
    v_mfma_f32_16x16x32_bf16 v[24:27], v[96:99], v[180:183], v[24:27]
    v_mfma_f32_16x16x32_bf16 v[28:31], v[96:99], v[184:187], v[28:31]
    buffer_load_dwordx4 v3, s[56:59], s76 offen offset:2048 lds
    v_mfma_f32_16x16x32_bf16 v[44:47], v[100:103], v[184:187], v[44:47]
    v_mfma_f32_16x16x32_bf16 v[40:43], v[100:103], v[180:183], v[40:43]
    buffer_load_dwordx4 v4, s[56:59], s76 offen offset:3072 lds
    v_mfma_f32_16x16x32_bf16 v[36:39], v[100:103], v[176:179], v[36:39]
    v_mfma_f32_16x16x32_bf16 v[32:35], v[100:103], v[172:175], v[32:35]
    s_add_u32 s77, s77, 163840
    buffer_load_dwordx4 v[96:99], v9, s[52:55], s77 offen offset:0 sc1
    v_mfma_f32_16x16x32_bf16 v[48:51], v[104:107], v[172:175], v[48:51]
    v_mfma_f32_16x16x32_bf16 v[52:55], v[104:107], v[176:179], v[52:55]
    buffer_load_dwordx4 v[100:103], v9, s[52:55], s77 offen offset:1024 sc1
    v_mfma_f32_16x16x32_bf16 v[56:59], v[104:107], v[180:183], v[56:59]
    v_mfma_f32_16x16x32_bf16 v[60:63], v[104:107], v[184:187], v[60:63]
    s_waitcnt vmcnt(11)
    ds_read_b64_tr_b16 v[156:157], v5 offset:0
    ds_read_b64_tr_b16 v[158:159], v5 offset:2048
    buffer_load_dwordx4 v[104:107], v9, s[52:55], s77 offen offset:2048 sc1
    v_mfma_f32_16x16x32_bf16 v[76:79], v[108:111], v[184:187], v[76:79]
    v_mfma_f32_16x16x32_bf16 v[72:75], v[108:111], v[180:183], v[72:75]
    ds_read_b64_tr_b16 v[160:161], v6 offset:0
    ds_read_b64_tr_b16 v[162:163], v6 offset:2048
    v_mfma_f32_16x16x32_bf16 v[68:71], v[108:111], v[176:179], v[68:71]
    v_mfma_f32_16x16x32_bf16 v[64:67], v[108:111], v[172:175], v[64:67]
    ds_read_b64_tr_b16 v[164:165], v7 offset:0
    ds_read_b64_tr_b16 v[166:167], v7 offset:2048
    buffer_load_dwordx4 v[108:111], v9, s[52:55], s77 offen offset:3072 sc1
    v_mfma_f32_16x16x32_bf16 v[80:83], v[112:115], v[172:175], v[80:83]
    v_mfma_f32_16x16x32_bf16 v[84:87], v[112:115], v[176:179], v[84:87]
    ds_read_b64_tr_b16 v[168:169], v8 offset:0
    ds_read_b64_tr_b16 v[170:171], v8 offset:2048
    v_mfma_f32_16x16x32_bf16 v[88:91], v[112:115], v[180:183], v[88:91]
    v_mfma_f32_16x16x32_bf16 v[92:95], v[112:115], v[184:187], v[92:95]
    buffer_load_dwordx4 v[112:115], v10, s[52:55], s77 offen offset:0 sc1
    s_waitcnt lgkmcnt(0)
    s_add_u32 m0, s38, 0
    s_add_u32 s76, s76, 524288
    buffer_load_dwordx4 v1, s[56:59], s76 offen offset:0 lds
    v_mfma_f32_16x16x32_bf16 v[16:19], v[116:119], v[156:159], v[16:19]
    v_mfma_f32_16x16x32_bf16 v[20:23], v[116:119], v[160:163], v[20:23]
    buffer_load_dwordx4 v2, s[56:59], s76 offen offset:1024 lds
    v_mfma_f32_16x16x32_bf16 v[24:27], v[116:119], v[164:167], v[24:27]
    v_mfma_f32_16x16x32_bf16 v[28:31], v[116:119], v[168:171], v[28:31]
    buffer_load_dwordx4 v3, s[56:59], s76 offen offset:2048 lds
    v_mfma_f32_16x16x32_bf16 v[44:47], v[120:123], v[168:171], v[44:47]
    v_mfma_f32_16x16x32_bf16 v[40:43], v[120:123], v[164:167], v[40:43]
    buffer_load_dwordx4 v4, s[56:59], s76 offen offset:3072 lds
    v_mfma_f32_16x16x32_bf16 v[36:39], v[120:123], v[160:163], v[36:39]
    v_mfma_f32_16x16x32_bf16 v[32:35], v[120:123], v[156:159], v[32:35]
    s_add_u32 s77, s77, 163840
    buffer_load_dwordx4 v[116:119], v9, s[52:55], s77 offen offset:0 sc1
    v_mfma_f32_16x16x32_bf16 v[48:51], v[124:127], v[156:159], v[48:51]
    v_mfma_f32_16x16x32_bf16 v[52:55], v[124:127], v[160:163], v[52:55]
    buffer_load_dwordx4 v[120:123], v9, s[52:55], s77 offen offset:1024 sc1
    v_mfma_f32_16x16x32_bf16 v[56:59], v[124:127], v[164:167], v[56:59]
    v_mfma_f32_16x16x32_bf16 v[60:63], v[124:127], v[168:171], v[60:63]
    s_waitcnt vmcnt(11)
    ds_read_b64_tr_b16 v[172:173], v5 offset:4096
    ds_read_b64_tr_b16 v[174:175], v5 offset:6144
    buffer_load_dwordx4 v[124:127], v9, s[52:55], s77 offen offset:2048 sc1
    v_mfma_f32_16x16x32_bf16 v[76:79], v[128:131], v[168:171], v[76:79]
    v_mfma_f32_16x16x32_bf16 v[72:75], v[128:131], v[164:167], v[72:75]
    ds_read_b64_tr_b16 v[176:177], v6 offset:4096
    ds_read_b64_tr_b16 v[178:179], v6 offset:6144
    v_mfma_f32_16x16x32_bf16 v[68:71], v[128:131], v[160:163], v[68:71]
    v_mfma_f32_16x16x32_bf16 v[64:67], v[128:131], v[156:159], v[64:67]
    ds_read_b64_tr_b16 v[180:181], v7 offset:4096
    ds_read_b64_tr_b16 v[182:183], v7 offset:6144
    buffer_load_dwordx4 v[128:131], v9, s[52:55], s77 offen offset:3072 sc1
    v_mfma_f32_16x16x32_bf16 v[80:83], v[132:135], v[156:159], v[80:83]
    v_mfma_f32_16x16x32_bf16 v[84:87], v[132:135], v[160:163], v[84:87]
    ds_read_b64_tr_b16 v[184:185], v8 offset:4096
    ds_read_b64_tr_b16 v[186:187], v8 offset:6144
    v_mfma_f32_16x16x32_bf16 v[88:91], v[132:135], v[164:167], v[88:91]
    v_mfma_f32_16x16x32_bf16 v[92:95], v[132:135], v[168:171], v[92:95]
    buffer_load_dwordx4 v[132:135], v10, s[52:55], s77 offen offset:0 sc1
    s_waitcnt lgkmcnt(0)
    s_add_u32 m0, s38, 4096
    s_add_u32 s76, s76, 524288
    buffer_load_dwordx4 v1, s[56:59], s76 offen offset:0 lds
    v_mfma_f32_16x16x32_bf16 v[16:19], v[136:139], v[172:175], v[16:19]
    v_mfma_f32_16x16x32_bf16 v[20:23], v[136:139], v[176:179], v[20:23]
    buffer_load_dwordx4 v2, s[56:59], s76 offen offset:1024 lds
    v_mfma_f32_16x16x32_bf16 v[24:27], v[136:139], v[180:183], v[24:27]
    v_mfma_f32_16x16x32_bf16 v[28:31], v[136:139], v[184:187], v[28:31]
    buffer_load_dwordx4 v3, s[56:59], s76 offen offset:2048 lds
    v_mfma_f32_16x16x32_bf16 v[44:47], v[140:143], v[184:187], v[44:47]
    v_mfma_f32_16x16x32_bf16 v[40:43], v[140:143], v[180:183], v[40:43]
    buffer_load_dwordx4 v4, s[56:59], s76 offen offset:3072 lds
    v_mfma_f32_16x16x32_bf16 v[36:39], v[140:143], v[176:179], v[36:39]
    v_mfma_f32_16x16x32_bf16 v[32:35], v[140:143], v[172:175], v[32:35]
    v_mfma_f32_16x16x32_bf16 v[48:51], v[144:147], v[172:175], v[48:51]
    v_mfma_f32_16x16x32_bf16 v[52:55], v[144:147], v[176:179], v[52:55]
    v_mfma_f32_16x16x32_bf16 v[56:59], v[144:147], v[180:183], v[56:59]
    v_mfma_f32_16x16x32_bf16 v[60:63], v[144:147], v[184:187], v[60:63]
    s_waitcnt vmcnt(9)
    ds_read_b64_tr_b16 v[156:157], v5 offset:0
    ds_read_b64_tr_b16 v[158:159], v5 offset:2048
    v_mfma_f32_16x16x32_bf16 v[76:79], v[148:151], v[184:187], v[76:79]
    v_mfma_f32_16x16x32_bf16 v[72:75], v[148:151], v[180:183], v[72:75]
    ds_read_b64_tr_b16 v[160:161], v6 offset:0
    ds_read_b64_tr_b16 v[162:163], v6 offset:2048
    v_mfma_f32_16x16x32_bf16 v[68:71], v[148:151], v[176:179], v[68:71]
    v_mfma_f32_16x16x32_bf16 v[64:67], v[148:151], v[172:175], v[64:67]
    ds_read_b64_tr_b16 v[164:165], v7 offset:0
    ds_read_b64_tr_b16 v[166:167], v7 offset:2048
    v_mfma_f32_16x16x32_bf16 v[80:83], v[152:155], v[172:175], v[80:83]
    v_mfma_f32_16x16x32_bf16 v[84:87], v[152:155], v[176:179], v[84:87]
    ds_read_b64_tr_b16 v[168:169], v8 offset:0
    ds_read_b64_tr_b16 v[170:171], v8 offset:2048
    v_mfma_f32_16x16x32_bf16 v[88:91], v[152:155], v[180:183], v[88:91]
    v_mfma_f32_16x16x32_bf16 v[92:95], v[152:155], v[184:187], v[92:95]
    s_waitcnt lgkmcnt(0)
    v_mfma_f32_16x16x32_bf16 v[16:19], v[96:99], v[156:159], v[16:19]
    v_mfma_f32_16x16x32_bf16 v[20:23], v[96:99], v[160:163], v[20:23]
    v_mfma_f32_16x16x32_bf16 v[24:27], v[96:99], v[164:167], v[24:27]
    v_mfma_f32_16x16x32_bf16 v[28:31], v[96:99], v[168:171], v[28:31]
    v_mfma_f32_16x16x32_bf16 v[44:47], v[100:103], v[168:171], v[44:47]
    v_mfma_f32_16x16x32_bf16 v[40:43], v[100:103], v[164:167], v[40:43]
    v_mfma_f32_16x16x32_bf16 v[36:39], v[100:103], v[160:163], v[36:39]
    v_mfma_f32_16x16x32_bf16 v[32:35], v[100:103], v[156:159], v[32:35]
    ds_read_b32 v253, v11
    v_mfma_f32_16x16x32_bf16 v[48:51], v[104:107], v[156:159], v[48:51]
    v_mfma_f32_16x16x32_bf16 v[52:55], v[104:107], v[160:163], v[52:55]
    v_mfma_f32_16x16x32_bf16 v[56:59], v[104:107], v[164:167], v[56:59]
    v_mfma_f32_16x16x32_bf16 v[60:63], v[104:107], v[168:171], v[60:63]
    s_waitcnt vmcnt(0)
    ds_read_b64_tr_b16 v[172:173], v5 offset:4096
    ds_read_b64_tr_b16 v[174:175], v5 offset:6144
    v_mfma_f32_16x16x32_bf16 v[76:79], v[108:111], v[168:171], v[76:79]
    v_mfma_f32_16x16x32_bf16 v[72:75], v[108:111], v[164:167], v[72:75]
    ds_read_b64_tr_b16 v[176:177], v6 offset:4096
    ds_read_b64_tr_b16 v[178:179], v6 offset:6144
    s_waitcnt vmcnt(0)
    v_cmp_ne_u32 vcc, s3, v249
    s_nop 0
    s_cmp_eq_u64 vcc, 0
    s_cbranch_scc1 L_ok21
    s_mov_b32 s95, 0x20000
L_poll22:
    buffer_load_dwordx2 v[248:249], v252, s[72:75], s68 offen offset:0 sc1
L_pollw22:
    s_waitcnt vmcnt(0)
    v_cmp_ne_u32 vcc, s3, v249
    s_nop 0
    s_cmp_eq_u64 vcc, 0
    s_cbranch_scc1 L_polled22
    s_sleep 2
    s_sub_u32 s95, s95, 1
    s_cbranch_scc0 L_poll22
L_polled22:
L_ok21:
    v_and_b32 v248, 0xffff0000, v248
    v_max_f32 v248, 0x2b800000, v248
    v_lshlrev_b32 v15, 16, v15
    v_mul_f32 v249, v15, v248
    s_waitcnt lgkmcnt(4)
    v_readfirstlane_b32 s39, v253
    s_nop 0
    s_cmp_eq_u32 s39, 0
    s_cbranch_scc1 L_oe23
    s_add_u32 s36, s84, 0
    buffer_load_dwordx4 v[136:139], v9, s[60:63], s36 offen sc1
    s_add_u32 s36, s85, 0
    buffer_load_dwordx4 v[140:143], v9, s[60:63], s36 offen sc1
    s_add_u32 s36, s86, 0
    buffer_load_dwordx4 v[144:147], v9, s[60:63], s36 offen sc1
    s_add_u32 s36, s87, 0
    buffer_load_dwordx4 v[148:151], v9, s[60:63], s36 offen sc1
L_oe23:
L_gl20:
    v_mfma_f32_16x16x32_bf16 v[68:71], v[108:111], v[160:163], v[68:71]
    v_mfma_f32_16x16x32_bf16 v[64:67], v[108:111], v[156:159], v[64:67]
    ds_read_b64_tr_b16 v[180:181], v7 offset:4096
    ds_read_b64_tr_b16 v[182:183], v7 offset:6144
    ds_read_b32 v253, v11
    v_mfma_f32_16x16x32_bf16 v[80:83], v[112:115], v[156:159], v[80:83]
    v_mfma_f32_16x16x32_bf16 v[84:87], v[112:115], v[160:163], v[84:87]
    ds_read_b64_tr_b16 v[184:185], v8 offset:4096
    ds_read_b64_tr_b16 v[186:187], v8 offset:6144
    v_mfma_f32_16x16x32_bf16 v[88:91], v[112:115], v[164:167], v[88:91]
    v_mfma_f32_16x16x32_bf16 v[92:95], v[112:115], v[168:171], v[92:95]
    s_waitcnt lgkmcnt(0)
    v_mfma_f32_16x16x32_bf16 v[16:19], v[116:119], v[172:175], v[16:19]
    v_mfma_f32_16x16x32_bf16 v[20:23], v[116:119], v[176:179], v[20:23]
    s_cmp_lg_u32 s39, 0
    s_cbranch_scc1 L_gl24
    v_readfirstlane_b32 s39, v253
    s_nop 0
    s_cmp_eq_u32 s39, 0
    s_cbranch_scc1 L_oe25
    s_add_u32 s36, s84, 0
    buffer_load_dwordx4 v[136:139], v9, s[60:63], s36 offen sc1
    s_add_u32 s36, s85, 0
    buffer_load_dwordx4 v[140:143], v9, s[60:63], s36 offen sc1
    s_add_u32 s36, s86, 0
    buffer_load_dwordx4 v[144:147], v9, s[60:63], s36 offen sc1
    s_add_u32 s36, s87, 0
    buffer_load_dwordx4 v[148:151], v9, s[60:63], s36 offen sc1
L_oe25:
L_gl24:
    s_cmp_eq_u32 s39, 0
    s_cbranch_scc1 L_oe26
    s_add_u32 s36, s84, 4096
    buffer_load_dwordx4 v[96:99], v9, s[60:63], s36 offen sc1
    s_add_u32 s36, s85, 4096
    buffer_load_dwordx4 v[100:103], v9, s[60:63], s36 offen sc1
    s_add_u32 s36, s86, 4096
    buffer_load_dwordx4 v[104:107], v9, s[60:63], s36 offen sc1
    s_add_u32 s36, s87, 4096
    buffer_load_dwordx4 v[108:111], v9, s[60:63], s36 offen sc1
L_oe26:
    v_mfma_f32_16x16x32_bf16 v[24:27], v[116:119], v[180:183], v[24:27]
    v_mfma_f32_16x16x32_bf16 v[28:31], v[116:119], v[184:187], v[28:31]
    v_mfma_f32_16x16x32_bf16 v[44:47], v[120:123], v[184:187], v[44:47]
    v_mfma_f32_16x16x32_bf16 v[40:43], v[120:123], v[180:183], v[40:43]
    v_mfma_f32_16x16x32_bf16 v[36:39], v[120:123], v[176:179], v[36:39]
    v_mfma_f32_16x16x32_bf16 v[32:35], v[120:123], v[172:175], v[32:35]
    v_mfma_f32_16x16x32_bf16 v[48:51], v[124:127], v[172:175], v[48:51]
    v_mfma_f32_16x16x32_bf16 v[52:55], v[124:127], v[176:179], v[52:55]
    s_cmp_eq_u32 s39, 0
    s_cbranch_scc1 L_oe27
    s_add_u32 s36, s84, 8192
    buffer_load_dwordx4 v[156:159], v9, s[60:63], s36 offen sc1
    s_add_u32 s36, s85, 8192
    buffer_load_dwordx4 v[160:163], v9, s[60:63], s36 offen sc1
    s_add_u32 s36, s86, 8192
    buffer_load_dwordx4 v[164:167], v9, s[60:63], s36 offen sc1
    s_add_u32 s36, s87, 8192
    buffer_load_dwordx4 v[168:171], v9, s[60:63], s36 offen sc1
L_oe27:
    v_mfma_f32_16x16x32_bf16 v[56:59], v[124:127], v[180:183], v[56:59]
    v_mfma_f32_16x16x32_bf16 v[60:63], v[124:127], v[184:187], v[60:63]
    v_mfma_f32_16x16x32_bf16 v[76:79], v[128:131], v[184:187], v[76:79]
    v_mfma_f32_16x16x32_bf16 v[72:75], v[128:131], v[180:183], v[72:75]
    v_mfma_f32_16x16x32_bf16 v[68:71], v[128:131], v[176:179], v[68:71]
    v_mfma_f32_16x16x32_bf16 v[64:67], v[128:131], v[172:175], v[64:67]
    v_mfma_f32_16x16x32_bf16 v[80:83], v[132:135], v[172:175], v[80:83]
    v_mfma_f32_16x16x32_bf16 v[84:87], v[132:135], v[176:179], v[84:87]
    v_mfma_f32_16x16x32_bf16 v[88:91], v[132:135], v[180:183], v[88:91]
    v_mfma_f32_16x16x32_bf16 v[92:95], v[132:135], v[184:187], v[92:95]
    s_setprio 2
    s_cmp_lg_u32 s39, 0
    s_cbranch_scc1 L_o2
    v_mov_b32 v12, 161844
    s_mov_b32 s95, 0x400000
L_spin28:
    ds_read_b32 v13, v12
    s_waitcnt lgkmcnt(0)
    v_readfirstlane_b32 s94, v13
    s_nop 0
    s_cmp_ge_u32 s94, 1
    s_cbranch_scc1 L_spun28
    s_sub_u32 s95, s95, 1
    s_cbranch_scc0 L_spin28
L_spun28:
    s_add_u32 s36, s84, 0
    buffer_load_dwordx4 v[136:139], v9, s[60:63], s36 offen sc1
    s_add_u32 s36, s85, 0
    buffer_load_dwordx4 v[140:143], v9, s[60:63], s36 offen sc1
    s_add_u32 s36, s86, 0
    buffer_load_dwordx4 v[144:147], v9, s[60:63], s36 offen sc1
    s_add_u32 s36, s87, 0
    buffer_load_dwordx4 v[148:151], v9, s[60:63], s36 offen sc1
    s_add_u32 s36, s84, 4096
    buffer_load_dwordx4 v[96:99], v9, s[60:63], s36 offen sc1
    s_add_u32 s36, s85, 4096
    buffer_load_dwordx4 v[100:103], v9, s[60:63], s36 offen sc1
    s_add_u32 s36, s86, 4096
    buffer_load_dwordx4 v[104:107], v9, s[60:63], s36 offen sc1
    s_add_u32 s36, s87, 4096
    buffer_load_dwordx4 v[108:111], v9, s[60:63], s36 offen sc1
    s_add_u32 s36, s84, 8192
    buffer_load_dwordx4 v[156:159], v9, s[60:63], s36 offen sc1
    s_add_u32 s36, s85, 8192
    buffer_load_dwordx4 v[160:163], v9, s[60:63], s36 offen sc1
    s_add_u32 s36, s86, 8192
    buffer_load_dwordx4 v[164:167], v9, s[60:63], s36 offen sc1
    s_add_u32 s36, s87, 8192
    buffer_load_dwordx4 v[168:171], v9, s[60:63], s36 offen sc1
L_o2:
    s_add_u32 s36, s84, 12288
    buffer_load_dwordx4 v[116:119], v9, s[60:63], s36 offen sc1
    s_add_u32 s36, s84, 16384
    buffer_load_dwordx4 v[172:175], v9, s[60:63], s36 offen sc1
    s_add_u32 s36, s70, 20480
    v_add_u32 v6, s36, v9
    s_waitcnt vmcnt(10)
    v_mfma_f32_16x16x32_bf16 v[16:19], v[188:191], v[136:139], v[16:19]
    v_mfma_f32_16x16x32_bf16 v[20:23], v[188:191], v[140:143], v[20:23]
    s_add_u32 s36, s85, 12288
    buffer_load_dwordx4 v[120:123], v9, s[60:63], s36 offen sc1
    v_mfma_f32_16x16x32_bf16 v[24:27], v[188:191], v[144:147], v[24:27]
    v_mfma_f32_16x16x32_bf16 v[28:31], v[188:191], v[148:151], v[28:31]
    s_add_u32 s36, s85, 16384
    buffer_load_dwordx4 v[176:179], v9, s[60:63], s36 offen sc1
    ds_read_b128 v[188:191], v6 offset:0
    v_mfma_f32_16x16x32_bf16 v[32:35], v[192:195], v[136:139], v[32:35]
    v_mfma_f32_16x16x32_bf16 v[36:39], v[192:195], v[140:143], v[36:39]
    s_add_u32 s36, s86, 12288
    buffer_load_dwordx4 v[124:127], v9, s[60:63], s36 offen sc1
    v_mfma_f32_16x16x32_bf16 v[40:43], v[192:195], v[144:147], v[40:43]
    v_mfma_f32_16x16x32_bf16 v[44:47], v[192:195], v[148:151], v[44:47]
    s_add_u32 s36, s86, 16384
    buffer_load_dwordx4 v[180:183], v9, s[60:63], s36 offen sc1
    ds_read_b128 v[192:195], v6 offset:1024
    v_mfma_f32_16x16x32_bf16 v[48:51], v[196:199], v[136:139], v[48:51]
    v_mfma_f32_16x16x32_bf16 v[52:55], v[196:199], v[140:143], v[52:55]
    s_add_u32 s36, s87, 12288
    buffer_load_dwordx4 v[128:131], v9, s[60:63], s36 offen sc1
    v_mfma_f32_16x16x32_bf16 v[56:59], v[196:199], v[144:147], v[56:59]
    v_mfma_f32_16x16x32_bf16 v[60:63], v[196:199], v[148:151], v[60:63]
    s_add_u32 s36, s87, 16384
    buffer_load_dwordx4 v[184:187], v9, s[60:63], s36 offen sc1
    ds_read_b128 v[196:199], v6 offset:2048
    v_mfma_f32_16x16x32_bf16 v[64:67], v[200:203], v[136:139], v[64:67]
    s_add_u32 s36, s71, 61440
    v_add_u32 v1, s36, v9
    s_xor_b32 s36, s37, 1
    v_mfma_f32_16x16x32_bf16 v[68:71], v[200:203], v[140:143], v[68:71]
    s_mul_i32 s36, s36, 20480
    s_add_u32 s36, s36, 71680
    v_add_u32 v2, s36, v9
    v_mfma_f32_16x16x32_bf16 v[72:75], v[200:203], v[144:147], v[72:75]
    s_xor_b32 s36, s37, 2
    s_mul_i32 s36, s36, 20480
    s_add_u32 s36, s36, 66560
    v_mfma_f32_16x16x32_bf16 v[76:79], v[200:203], v[148:151], v[76:79]
    v_add_u32 v3, s36, v9
    s_xor_b32 s36, s37, 3
    s_mul_i32 s36, s36, 20480
    ds_read_b128 v[200:203], v6 offset:3072
    v_mfma_f32_16x16x32_bf16 v[80:83], v[204:207], v[136:139], v[80:83]
    s_add_u32 s36, s36, 61440
    v_add_u32 v4, s36, v9
    s_add_u32 s69, s71, 76800
    v_mfma_f32_16x16x32_bf16 v[84:87], v[204:207], v[140:143], v[84:87]
    v_and_b32 v5, 15, v0
    v_mul_u32_u24 v5, 176, v5
    v_lshrrev_b32 v7, 4, v0
    v_mfma_f32_16x16x32_bf16 v[88:91], v[204:207], v[144:147], v[88:91]
    v_lshl_add_u32 v5, v7, 3, v5
    v_add_u32 v5, s69, v5
    v_add_u32 v7, 0, v0
    v_mfma_f32_16x16x32_bf16 v[92:95], v[204:207], v[148:151], v[92:95]
    v_min_u32 v7, 159, v7
    v_mul_u32_u24 v8, 205, v7
    v_lshrrev_b32 v8, 11, v8
    ds_read_b128 v[204:207], v6 offset:4096
    s_waitcnt vmcnt(12)
    v_mfma_f32_16x16x32_bf16 v[16:19], v[208:211], v[96:99], v[16:19]
    v_lshlrev_b32 v7, 4, v7
    v_lshl_add_u32 v11, v8, 4, v7
    v_add_u32 v11, s69, v11
    v_mfma_f32_16x16x32_bf16 v[20:23], v[208:211], v[100:103], v[20:23]
    v_mul_u32_u24 v8, 1120, v8
    v_add_u32 v14, v8, v7
    v_add_u32 v7, 64, v0
    v_mfma_f32_16x16x32_bf16 v[24:27], v[208:211], v[104:107], v[24:27]
    v_min_u32 v7, 159, v7
    v_mul_u32_u24 v8, 205, v7
    v_lshrrev_b32 v8, 11, v8
    v_mfma_f32_16x16x32_bf16 v[28:31], v[208:211], v[108:111], v[28:31]
    v_lshlrev_b32 v7, 4, v7
    v_lshl_add_u32 v12, v8, 4, v7
    v_add_u32 v12, s69, v12
    ds_read_b128 v[208:211], v6 offset:5120
    v_mfma_f32_16x16x32_bf16 v[32:35], v[212:215], v[96:99], v[32:35]
    v_mul_u32_u24 v8, 1120, v8
    v_add_u32 v250, v8, v7
    v_add_u32 v7, 128, v0
    v_mfma_f32_16x16x32_bf16 v[36:39], v[212:215], v[100:103], v[36:39]
    v_min_u32 v7, 159, v7
    v_mul_u32_u24 v8, 205, v7
    v_lshrrev_b32 v8, 11, v8
    v_mfma_f32_16x16x32_bf16 v[40:43], v[212:215], v[104:107], v[40:43]
    v_lshlrev_b32 v7, 4, v7
    v_lshl_add_u32 v13, v8, 4, v7
    v_add_u32 v13, s69, v13
    v_mfma_f32_16x16x32_bf16 v[44:47], v[212:215], v[108:111], v[44:47]
    v_mul_u32_u24 v8, 1120, v8
    v_add_u32 v251, v8, v7
    s_mov_b32 s44, s26
    ds_read_b128 v[212:215], v6 offset:6144
    v_mfma_f32_16x16x32_bf16 v[48:51], v[216:219], v[96:99], v[48:51]
    s_mov_b32 s45, s27
    s_mov_b32 s46, 2621440
    s_mov_b32 s47, 0x20000
    v_mfma_f32_16x16x32_bf16 v[52:55], v[216:219], v[100:103], v[52:55]
    s_mul_i32 s36, s34, 160
    s_add_u32 s64, s64, s36
    v_mfma_f32_16x16x32_bf16 v[56:59], v[216:219], v[104:107], v[56:59]
    v_mfma_f32_16x16x32_bf16 v[60:63], v[216:219], v[108:111], v[60:63]
    ds_read_b128 v[216:219], v6 offset:7168
    v_mfma_f32_16x16x32_bf16 v[64:67], v[220:223], v[96:99], v[64:67]
    v_mfma_f32_16x16x32_bf16 v[68:71], v[220:223], v[100:103], v[68:71]
    v_mfma_f32_16x16x32_bf16 v[72:75], v[220:223], v[104:107], v[72:75]
    v_mfma_f32_16x16x32_bf16 v[76:79], v[220:223], v[108:111], v[76:79]
    ds_read_b128 v[220:223], v6 offset:8192
    v_mfma_f32_16x16x32_bf16 v[80:83], v[224:227], v[96:99], v[80:83]
    v_mfma_f32_16x16x32_bf16 v[84:87], v[224:227], v[100:103], v[84:87]
    v_mfma_f32_16x16x32_bf16 v[88:91], v[224:227], v[104:107], v[88:91]
    v_mfma_f32_16x16x32_bf16 v[92:95], v[224:227], v[108:111], v[92:95]
    ds_read_b128 v[224:227], v6 offset:9216
    s_waitcnt vmcnt(8)
    v_mfma_f32_16x16x32_bf16 v[16:19], v[228:231], v[156:159], v[16:19]
    s_waitcnt vmcnt(6) lgkmcnt(0)
    v_mfma_f32_16x16x32_bf16 v[16:19], v[188:191], v[116:119], v[16:19]
    v_mfma_f32_16x16x32_bf16 v[16:19], v[208:211], v[172:175], v[16:19]
    v_mfma_f32_16x16x32_bf16 v[32:35], v[232:235], v[156:159], v[32:35]
    v_mfma_f32_16x16x32_bf16 v[32:35], v[192:195], v[116:119], v[32:35]
    v_mfma_f32_16x16x32_bf16 v[32:35], v[212:215], v[172:175], v[32:35]
    v_mfma_f32_16x16x32_bf16 v[48:51], v[236:239], v[156:159], v[48:51]
    v_mfma_f32_16x16x32_bf16 v[48:51], v[196:199], v[116:119], v[48:51]
    v_mfma_f32_16x16x32_bf16 v[48:51], v[216:219], v[172:175], v[48:51]
    v_mfma_f32_16x16x32_bf16 v[64:67], v[240:243], v[156:159], v[64:67]
    v_mfma_f32_16x16x32_bf16 v[64:67], v[200:203], v[116:119], v[64:67]
    ds_write_b128 v1, v[16:19] offset:0
    v_mfma_f32_16x16x32_bf16 v[64:67], v[220:223], v[172:175], v[64:67]
    v_mfma_f32_16x16x32_bf16 v[80:83], v[244:247], v[156:159], v[80:83]
    v_mfma_f32_16x16x32_bf16 v[80:83], v[204:207], v[116:119], v[80:83]
    ds_write_b128 v1, v[32:35] offset:1024
    v_mfma_f32_16x16x32_bf16 v[80:83], v[224:227], v[172:175], v[80:83]
    v_mfma_f32_16x16x32_bf16 v[20:23], v[228:231], v[160:163], v[20:23]
    s_waitcnt vmcnt(4)
    v_mfma_f32_16x16x32_bf16 v[20:23], v[188:191], v[120:123], v[20:23]
    ds_write_b128 v1, v[48:51] offset:2048
    v_mfma_f32_16x16x32_bf16 v[20:23], v[208:211], v[176:179], v[20:23]
    v_mfma_f32_16x16x32_bf16 v[36:39], v[232:235], v[160:163], v[36:39]
    v_mfma_f32_16x16x32_bf16 v[36:39], v[192:195], v[120:123], v[36:39]
    ds_write_b128 v1, v[64:67] offset:3072
    v_mfma_f32_16x16x32_bf16 v[36:39], v[212:215], v[176:179], v[36:39]
    v_mfma_f32_16x16x32_bf16 v[52:55], v[236:239], v[160:163], v[52:55]
    v_mfma_f32_16x16x32_bf16 v[52:55], v[196:199], v[120:123], v[52:55]
    ds_write_b128 v1, v[80:83] offset:4096
    v_mfma_f32_16x16x32_bf16 v[52:55], v[216:219], v[176:179], v[52:55]
    v_mfma_f32_16x16x32_bf16 v[68:71], v[240:243], v[160:163], v[68:71]
    v_mfma_f32_16x16x32_bf16 v[68:71], v[200:203], v[120:123], v[68:71]
    ds_write_b128 v1, v[20:23] offset:5120
    v_mfma_f32_16x16x32_bf16 v[68:71], v[220:223], v[176:179], v[68:71]
    v_mfma_f32_16x16x32_bf16 v[84:87], v[244:247], v[160:163], v[84:87]
    v_mfma_f32_16x16x32_bf16 v[84:87], v[204:207], v[120:123], v[84:87]
    ds_write_b128 v1, v[36:39] offset:6144
    v_mfma_f32_16x16x32_bf16 v[84:87], v[224:227], v[176:179], v[84:87]
    v_mfma_f32_16x16x32_bf16 v[24:27], v[228:231], v[164:167], v[24:27]
    s_waitcnt vmcnt(2)
    v_mfma_f32_16x16x32_bf16 v[24:27], v[188:191], v[124:127], v[24:27]
    ds_write_b128 v1, v[52:55] offset:7168
    v_mfma_f32_16x16x32_bf16 v[24:27], v[208:211], v[180:183], v[24:27]
    v_mfma_f32_16x16x32_bf16 v[40:43], v[232:235], v[164:167], v[40:43]
    v_mfma_f32_16x16x32_bf16 v[40:43], v[192:195], v[124:127], v[40:43]
    ds_write_b128 v1, v[68:71] offset:8192
    v_mfma_f32_16x16x32_bf16 v[40:43], v[212:215], v[180:183], v[40:43]
    v_mfma_f32_16x16x32_bf16 v[56:59], v[236:239], v[164:167], v[56:59]
    v_mfma_f32_16x16x32_bf16 v[56:59], v[196:199], v[124:127], v[56:59]
    ds_write_b128 v1, v[84:87] offset:9216
    v_mfma_f32_16x16x32_bf16 v[56:59], v[216:219], v[180:183], v[56:59]
    v_mfma_f32_16x16x32_bf16 v[72:75], v[240:243], v[164:167], v[72:75]
    v_mfma_f32_16x16x32_bf16 v[72:75], v[200:203], v[124:127], v[72:75]
    ds_write_b128 v1, v[24:27] offset:10240
    v_mfma_f32_16x16x32_bf16 v[72:75], v[220:223], v[180:183], v[72:75]
    v_mfma_f32_16x16x32_bf16 v[88:91], v[244:247], v[164:167], v[88:91]
    v_mfma_f32_16x16x32_bf16 v[88:91], v[204:207], v[124:127], v[88:91]
    ds_write_b128 v1, v[40:43] offset:11264
    v_mfma_f32_16x16x32_bf16 v[88:91], v[224:227], v[180:183], v[88:91]
    v_mfma_f32_16x16x32_bf16 v[28:31], v[228:231], v[168:171], v[28:31]
    s_waitcnt vmcnt(0)
    v_mfma_f32_16x16x32_bf16 v[28:31], v[188:191], v[128:131], v[28:31]
    ds_write_b128 v1, v[56:59] offset:12288
    v_mfma_f32_16x16x32_bf16 v[28:31], v[208:211], v[184:187], v[28:31]
    s_waitcnt lgkmcnt(3)
    s_barrier
    v_mfma_f32_16x16x32_bf16 v[44:47], v[232:235], v[168:171], v[44:47]
    v_mfma_f32_16x16x32_bf16 v[44:47], v[192:195], v[128:131], v[44:47]
    ds_write_b128 v1, v[72:75] offset:13312
    v_mfma_f32_16x16x32_bf16 v[44:47], v[212:215], v[184:187], v[44:47]
    v_mfma_f32_16x16x32_bf16 v[60:63], v[236:239], v[168:171], v[60:63]
    v_mfma_f32_16x16x32_bf16 v[60:63], v[196:199], v[128:131], v[60:63]
    ds_write_b128 v1, v[88:91] offset:14336
    v_mfma_f32_16x16x32_bf16 v[60:63], v[216:219], v[184:187], v[60:63]
    v_mfma_f32_16x16x32_bf16 v[76:79], v[240:243], v[168:171], v[76:79]
    ds_read_b128 v[136:139], v4 offset:0
    ds_read_b128 v[96:99], v3 offset:0
    v_mfma_f32_16x16x32_bf16 v[76:79], v[200:203], v[128:131], v[76:79]
    ds_read_b128 v[140:143], v4 offset:1024
    ds_read_b128 v[100:103], v3 offset:1024
    v_mfma_f32_16x16x32_bf16 v[76:79], v[220:223], v[184:187], v[76:79]
    ds_read_b128 v[144:147], v4 offset:2048
    ds_read_b128 v[104:107], v3 offset:2048
    v_mfma_f32_16x16x32_bf16 v[92:95], v[244:247], v[168:171], v[92:95]
    ds_read_b128 v[148:151], v4 offset:3072
    ds_read_b128 v[108:111], v3 offset:3072
    v_mfma_f32_16x16x32_bf16 v[92:95], v[204:207], v[128:131], v[92:95]
    ds_read_b128 v[152:155], v4 offset:4096
    ds_read_b128 v[112:115], v3 offset:4096
    v_mfma_f32_16x16x32_bf16 v[92:95], v[224:227], v[184:187], v[92:95]
    s_waitcnt lgkmcnt(10)
    s_barrier
    ds_read_b128 v[188:191], v2 offset:0
    ds_read_b128 v[192:195], v2 offset:1024
    ds_read_b128 v[196:199], v2 offset:2048
    ds_read_b128 v[200:203], v2 offset:3072
    ds_read_b128 v[204:207], v2 offset:4096
    s_waitcnt lgkmcnt(13)
    v_pk_add_f32 v[96:97], v[96:97], v[136:137]
    v_pk_add_f32 v[98:99], v[98:99], v[138:139]
    s_waitcnt lgkmcnt(11)
    v_pk_add_f32 v[100:101], v[100:101], v[140:141]
    v_pk_add_f32 v[102:103], v[102:103], v[142:143]
    s_waitcnt lgkmcnt(9)
    v_pk_add_f32 v[104:105], v[104:105], v[144:145]
    v_pk_add_f32 v[106:107], v[106:107], v[146:147]
    s_waitcnt lgkmcnt(7)
    v_pk_add_f32 v[108:109], v[108:109], v[148:149]
    v_pk_add_f32 v[110:111], v[110:111], v[150:151]
    s_waitcnt lgkmcnt(5)
    v_pk_add_f32 v[112:113], v[112:113], v[152:153]
    v_pk_add_f32 v[114:115], v[114:115], v[154:155]
    v_pk_add_f32 v[28:29], v[28:29], v[96:97]
    v_pk_add_f32 v[30:31], v[30:31], v[98:99]
    v_pk_add_f32 v[44:45], v[44:45], v[100:101]
    v_pk_add_f32 v[46:47], v[46:47], v[102:103]
    v_pk_add_f32 v[60:61], v[60:61], v[104:105]
    v_pk_add_f32 v[62:63], v[62:63], v[106:107]
    v_pk_add_f32 v[76:77], v[76:77], v[108:109]
    v_pk_add_f32 v[78:79], v[78:79], v[110:111]
    v_pk_add_f32 v[92:93], v[92:93], v[112:113]
    v_pk_add_f32 v[94:95], v[94:95], v[114:115]
    s_waitcnt lgkmcnt(4)
    v_pk_add_f32 v[28:29], v[28:29], v[188:189]
    v_pk_add_f32 v[30:31], v[30:31], v[190:191]
    v_pk_fma_f32 v[28:29], v[28:29], v[248:249], v[248:249] op_sel:[0,0,1] op_sel_hi:[1,0,1]
    v_pk_fma_f32 v[30:31], v[30:31], v[248:249], v[248:249] op_sel:[0,0,1] op_sel_hi:[1,0,1]
    v_cvt_pk_bf16_f32 v28, v28, v29
    v_cvt_pk_bf16_f32 v29, v30, v31
    ds_write_b64 v5, v[28:29] offset:0
    s_waitcnt lgkmcnt(4)
    v_pk_add_f32 v[44:45], v[44:45], v[192:193]
    v_pk_add_f32 v[46:47], v[46:47], v[194:195]
    v_pk_fma_f32 v[44:45], v[44:45], v[248:249], v[248:249] op_sel:[0,0,1] op_sel_hi:[1,0,1]
    v_pk_fma_f32 v[46:47], v[46:47], v[248:249], v[248:249] op_sel:[0,0,1] op_sel_hi:[1,0,1]
    v_cvt_pk_bf16_f32 v44, v44, v45
    v_cvt_pk_bf16_f32 v45, v46, v47
    ds_write_b64 v5, v[44:45] offset:32
    s_waitcnt lgkmcnt(4)
    v_pk_add_f32 v[60:61], v[60:61], v[196:197]
    v_pk_add_f32 v[62:63], v[62:63], v[198:199]
    v_pk_fma_f32 v[60:61], v[60:61], v[248:249], v[248:249] op_sel:[0,0,1] op_sel_hi:[1,0,1]
    v_pk_fma_f32 v[62:63], v[62:63], v[248:249], v[248:249] op_sel:[0,0,1] op_sel_hi:[1,0,1]
    v_cvt_pk_bf16_f32 v60, v60, v61
    v_cvt_pk_bf16_f32 v61, v62, v63
    ds_write_b64 v5, v[60:61] offset:64
    s_waitcnt lgkmcnt(4)
    v_pk_add_f32 v[76:77], v[76:77], v[200:201]
    v_pk_add_f32 v[78:79], v[78:79], v[202:203]
    v_pk_fma_f32 v[76:77], v[76:77], v[248:249], v[248:249] op_sel:[0,0,1] op_sel_hi:[1,0,1]
    v_pk_fma_f32 v[78:79], v[78:79], v[248:249], v[248:249] op_sel:[0,0,1] op_sel_hi:[1,0,1]
    v_cvt_pk_bf16_f32 v76, v76, v77
    v_cvt_pk_bf16_f32 v77, v78, v79
    ds_write_b64 v5, v[76:77] offset:96
    s_waitcnt lgkmcnt(4)
    v_pk_add_f32 v[92:93], v[92:93], v[204:205]
    v_pk_add_f32 v[94:95], v[94:95], v[206:207]
    v_pk_fma_f32 v[92:93], v[92:93], v[248:249], v[248:249] op_sel:[0,0,1] op_sel_hi:[1,0,1]
    v_pk_fma_f32 v[94:95], v[94:95], v[248:249], v[248:249] op_sel:[0,0,1] op_sel_hi:[1,0,1]
    v_cvt_pk_bf16_f32 v92, v92, v93
    v_cvt_pk_bf16_f32 v93, v94, v95
    ds_write_b64 v5, v[92:93] offset:128
    ds_read_b128 v[156:159], v11
    ds_read_b128 v[160:163], v12
    ds_read_b128 v[164:167], v13
    s_waitcnt lgkmcnt(2)
    buffer_store_dwordx4 v[156:159], v14, s[44:47], s64 offen
    s_waitcnt lgkmcnt(1)
    buffer_store_dwordx4 v[160:163], v250, s[44:47], s64 offen
    s_waitcnt lgkmcnt(0)
    s_mov_b32 exec_hi, 0
    buffer_store_dwordx4 v[164:167], v251, s[44:47], s64 offen
    s_mov_b64 exec, -1
    s_branch L_fin
L_q:
    s_lshr_b32 s35, s34, 1
    s_xor_b32 s35, s35, 3
    s_xor_b32 s37, s35, s32
    s_xor_b32 s36, s35, 0
    s_lshl_b32 s38, s33, 2
    s_add_u32 s36, s36, s38
    s_mul_i32 s80, s36, 20480
    s_xor_b32 s36, s35, 1
    s_lshl_b32 s38, s33, 2
    s_add_u32 s36, s36, s38
    s_mul_i32 s81, s36, 20480
    s_xor_b32 s36, s35, 2
    s_lshl_b32 s38, s33, 2
    s_add_u32 s36, s36, s38
    s_mul_i32 s82, s36, 20480
    s_lshl_b32 s36, s32, 1
    v_lshrrev_b32 v38, 5, v0
    v_lshl_add_u32 v38, v38, 3, s36
    v_bfe_u32 v30, v0, 4, 1
    v_add_u32 v38, v38, v30
    v_and_b32 v30, 15, v0
    v_xor_b32 v30, v30, v38
    v_mul_u32_u24 v38, 1280, v38
    v_lshl_add_u32 v38, v30, 4, v38
    s_lshl_b32 s68, s32, 10
    s_mul_i32 s66, s32, 40960
    s_mul_i32 s67, s32, 5120
    s_mul_i32 s65, s34, 160
    v_add_u32 v30, 0, v0
    v_mul_u32_u24 v31, 205, v30
    v_lshrrev_b32 v31, 11, v31
    v_mul_u32_u24 v32, 10, v31
    v_sub_u32 v32, v30, v32
    v_lshlrev_b32 v32, 4, v32
    v_lshrrev_b32 v33, 1, v31
    v_xor_b32 v33, v33, v31
    v_and_b32 v33, 4, v33
    v_mul_u32_u24 v33, 3, v33
    v_xor_b32 v33, v33, v31
    v_mul_u32_u24 v33, 1280, v33
    v_add3_u32 v25, v33, v32, s65
    v_add_u32 v30, 64, v0
    v_mul_u32_u24 v31, 205, v30
    v_lshrrev_b32 v31, 11, v31
    v_mul_u32_u24 v32, 10, v31
    v_sub_u32 v32, v30, v32
    v_lshlrev_b32 v32, 4, v32
    v_lshrrev_b32 v33, 1, v31
    v_xor_b32 v33, v33, v31
    v_and_b32 v33, 4, v33
    v_mul_u32_u24 v33, 3, v33
    v_xor_b32 v33, v33, v31
    v_mul_u32_u24 v33, 1280, v33
    v_add3_u32 v26, v33, v32, s65
    v_add_u32 v30, 128, v0
    v_mul_u32_u24 v31, 205, v30
    v_lshrrev_b32 v31, 11, v31
    v_mul_u32_u24 v32, 10, v31
    v_sub_u32 v32, v30, v32
    v_lshlrev_b32 v32, 4, v32
    v_lshrrev_b32 v33, 1, v31
    v_xor_b32 v33, v33, v31
    v_and_b32 v33, 4, v33
    v_mul_u32_u24 v33, 3, v33
    v_xor_b32 v33, v33, v31
    v_mul_u32_u24 v33, 1280, v33
    v_add3_u32 v27, v33, v32, s65
    v_add_u32 v30, 192, v0
    v_mul_u32_u24 v31, 205, v30
    v_lshrrev_b32 v31, 11, v31
    v_mul_u32_u24 v32, 10, v31
    v_sub_u32 v32, v30, v32
    v_lshlrev_b32 v32, 4, v32
    v_lshrrev_b32 v33, 1, v31
    v_xor_b32 v33, v33, v31
    v_and_b32 v33, 4, v33
    v_mul_u32_u24 v33, 3, v33
    v_xor_b32 v33, v33, v31
    v_mul_u32_u24 v33, 1280, v33
    v_add3_u32 v28, v33, v32, s65
    v_add_u32 v30, 256, v0
    v_mul_u32_u24 v31, 205, v30
    v_lshrrev_b32 v31, 11, v31
    v_mul_u32_u24 v32, 10, v31
    v_sub_u32 v32, v30, v32
    v_lshlrev_b32 v32, 4, v32
    v_lshrrev_b32 v33, 1, v31
    v_xor_b32 v33, v33, v31
    v_and_b32 v33, 4, v33
    v_mul_u32_u24 v33, 3, v33
    v_xor_b32 v33, v33, v31
    v_mul_u32_u24 v33, 1280, v33
    v_add3_u32 v29, v33, v32, s65
    s_waitcnt lgkmcnt(0)
    s_mov_b32 s44, s4
    s_mov_b32 s45, s5
    s_mov_b32 s46, 2621440
    s_mov_b32 s47, 0x20000
    s_mov_b32 s48, s6
    s_mov_b32 s49, s7
    s_mov_b32 s50, 819200
    s_mov_b32 s51, 0x20000
    s_add_u32 s72, s30, 8519680
    s_addc_u32 s73, s31, 0
    s_mov_b32 s74, 196864
    s_mov_b32 s75, 0x20000
    s_mul_i32 s38, s37, 12288
    s_add_u32 s38, s38, 61440
    s_cmp_eq_u32 s37, 3
    s_cselect_b32 s38, 102400, s38
    s_cselect_b32 s83, 12288, 0
    v_and_b32 v30, 15, v0
    v_lshrrev_b32 v31, 4, v0
    v_xor_b32 v31, v31, v30
    v_bfe_u32 v32, v0, 1, 2
    v_bfe_u32 v30, v0, 3, 1
    v_lshl_add_u32 v32, v32, 1, v30
    v_and_b32 v30, 1, v0
    v_lshl_add_u32 v32, v32, 1, v30
    v_lshlrev_b32 v32, 8, v32
    v_add_u32 v32, s38, v32
    v_xor_b32 v30, 0, v31
    v_lshl_add_u32 v34, v30, 4, v32
    v_xor_b32 v30, 4, v31
    v_lshl_add_u32 v35, v30, 4, v32
    v_xor_b32 v30, 8, v31
    v_lshl_add_u32 v36, v30, 4, v32
    v_xor_b32 v30, 12, v31
    v_lshl_add_u32 v37, v30, 4, v32
    v_lshrrev_b32 v9, 5, v0
    v_lshlrev_b32 v9, 4, v9
    v_bfe_u32 v8, v0, 2, 3
    v_add_u32 v9, v9, v8
    v_mul_u32_u24 v9, 160, v9
    v_and_b32 v8, 3, v0
    v_lshl_add_u32 v8, v8, 3, v9
    v_add_u32 v9, 122880, v8
    s_lshr_b32 s36, s32, 1
    s_mul_i32 s64, s36, 5120
    s_add_u32 s64, s64, 40960
    s_and_b32 s36, s32, 1
    s_lshl_b32 s36, s36, 4
    v_and_b32 v4, 15, v0
    v_add_u32 v4, s36, v4
    v_lshrrev_b32 v5, 4, v0
    v_add_u32 v6, 0, v5
    v_mul_u32_u24 v7, 52, v6
    v_lshrrev_b32 v7, 8, v7
    v_mul_u32_u24 v30, 5, v7
    v_sub_u32 v30, v6, v30
    v_mul_u32_u24 v7, 1280, v7
    v_lshrrev_b32 v31, 1, v30
    v_lshl_add_u32 v7, v31, 9, v7
    v_and_b32 v31, 1, v30
    v_lshl_add_u32 v7, v31, 3, v7
    v_lshrrev_b32 v31, 2, v30
    v_sub_u32 v31, 4, v31
    v_lshl_add_u32 v10, v4, v31, v7
    v_add_u32 v10, s64, v10
    v_add_u32 v6, 4, v5
    v_mul_u32_u24 v7, 52, v6
    v_lshrrev_b32 v7, 8, v7
    v_mul_u32_u24 v30, 5, v7
    v_sub_u32 v30, v6, v30
    v_mul_u32_u24 v7, 1280, v7
    v_lshrrev_b32 v31, 1, v30
    v_lshl_add_u32 v7, v31, 9, v7
    v_and_b32 v31, 1, v30
    v_lshl_add_u32 v7, v31, 3, v7
    v_lshrrev_b32 v31, 2, v30
    v_sub_u32 v31, 4, v31
    v_lshl_add_u32 v11, v4, v31, v7
    v_add_u32 v11, s64, v11
    v_add_u32 v6, 8, v5
    v_mul_u32_u24 v7, 52, v6
    v_lshrrev_b32 v7, 8, v7
    v_mul_u32_u24 v30, 5, v7
    v_sub_u32 v30, v6, v30
    v_mul_u32_u24 v7, 1280, v7
    v_lshrrev_b32 v31, 1, v30
    v_lshl_add_u32 v7, v31, 9, v7
    v_and_b32 v31, 1, v30
    v_lshl_add_u32 v7, v31, 3, v7
    v_lshrrev_b32 v31, 2, v30
    v_sub_u32 v31, 4, v31
    v_lshl_add_u32 v12, v4, v31, v7
    v_add_u32 v12, s64, v12
    v_add_u32 v6, 12, v5
    v_mul_u32_u24 v7, 52, v6
    v_lshrrev_b32 v7, 8, v7
    v_mul_u32_u24 v30, 5, v7
    v_sub_u32 v30, v6, v30
    v_mul_u32_u24 v7, 1280, v7
    v_lshrrev_b32 v31, 1, v30
    v_lshl_add_u32 v7, v31, 9, v7
    v_and_b32 v31, 1, v30
    v_lshl_add_u32 v7, v31, 3, v7
    v_lshrrev_b32 v31, 2, v30
    v_sub_u32 v31, 4, v31
    v_lshl_add_u32 v13, v4, v31, v7
    v_add_u32 v13, s64, v13
    v_add_u32 v6, 16, v5
    v_mul_u32_u24 v7, 52, v6
    v_lshrrev_b32 v7, 8, v7
    v_mul_u32_u24 v30, 5, v7
    v_sub_u32 v30, v6, v30
    v_mul_u32_u24 v7, 1280, v7
    v_lshrrev_b32 v31, 1, v30
    v_lshl_add_u32 v7, v31, 9, v7
    v_and_b32 v31, 1, v30
    v_lshl_add_u32 v7, v31, 3, v7
    v_lshrrev_b32 v31, 2, v30
    v_sub_u32 v31, 4, v31
    v_lshl_add_u32 v14, v4, v31, v7
    v_add_u32 v14, s64, v14
    v_bfe_u32 v251, v0, 1, 2
    v_lshlrev_b32 v251, 14, v251
    v_bfe_u32 v5, v0, 3, 2
    v_lshl_add_u32 v251, v5, 6, v251
    v_and_b32 v5, 1, v0
    v_lshl_add_u32 v251, v5, 3, v251
    s_lshl_b32 s76, s33, 9
    s_lshr_b32 s36, s32, 1
    s_lshl_b32 s36, s36, 8
    s_add_u32 s76, s76, s36
    s_mul_i32 s36, s33, 81920
    s_add_u32 s36, s36, 2818048
    s_add_u32 s52, s30, s36
    s_addc_u32 s53, s31, 0
    s_mov_b32 s54, 81920
    s_mov_b32 s55, 0x20000
    v_and_b32 v252, 15, v0
    v_lshlrev_b32 v252, 4, v252
    v_bfe_u32 v253, v0, 4, 1
    v_lshl_add_u32 v252, v253, 10, v252
    v_lshrrev_b32 v253, 5, v0
    v_lshl_add_u32 v253, v253, 8, v252
    s_lshr_b32 s71, s34, 1
    s_mul_i32 s71, s71, 20480
    s_lshr_b32 s36, s32, 1
    s_lshl_b32 s36, s36, 11
    s_add_u32 s71, s71, s36
    s_and_b32 s36, s34, 1
    s_lshl_b32 s36, s36, 1
    s_and_b32 s69, s32, 1
    s_add_u32 s36, s36, s69
    s_lshl_b32 s69, s36, 12
    s_add_u32 s69, s69, s71
    s_lshl_b32 s36, s36, 8
    s_add_u32 s71, s71, s36
    s_add_u32 s71, s71, 16384
    s_lshl_b32 s77, s33, 3
    s_add_u32 s77, s77, s34
    s_lshl_b32 s77, s77, 7
    s_add_u32 s77, s77, 131072
    s_xor_b32 s36, s32, 0
    s_mul_i32 s36, s36, 5120
    s_add_u32 s84, s36, 61440
    s_xor_b32 s36, s32, 1
    s_mul_i32 s36, s36, 5120
    s_add_u32 s85, s36, 61440
    s_xor_b32 s36, s32, 2
    s_mul_i32 s36, s36, 5120
    s_add_u32 s86, s36, 61440
    s_xor_b32 s36, s32, 3
    s_mul_i32 s36, s36, 5120
    s_add_u32 s87, s36, 61440
    s_mul_i32 s36, s32, 40960
    s_add_u32 s36, s36, 2621440
    s_add_u32 s40, s30, s36
    s_addc_u32 s41, s31, 0
    s_mov_b32 s42, 40960
    s_mov_b32 s43, 0x20000
    s_mov_b32 s90, 0x0033ffff
    s_mov_b32 s91, 0x0033ffff
    s_add_u32 m0, s68, 61440
    s_nop 0
    buffer_load_dwordx4 v38, s[44:47], s80 offen offset:0 lds
    s_add_u32 m0, s68, 73728
    s_nop 0
    buffer_load_dwordx4 v38, s[44:47], s81 offen offset:0 lds
    s_add_u32 m0, s68, 86016
    s_nop 0
    buffer_load_dwordx4 v38, s[44:47], s82 offen offset:0 lds
    s_add_u32 m0, s67, 0
    s_nop 0
    buffer_load_dwordx4 v25, s[48:51], s66 offen lds
    s_add_u32 m0, s67, 1024
    s_nop 0
    buffer_load_dwordx4 v26, s[48:51], s66 offen lds
    s_add_u32 m0, s67, 2048
    s_nop 0
    buffer_load_dwordx4 v27, s[48:51], s66 offen lds
    s_add_u32 m0, s67, 3072
    s_nop 0
    buffer_load_dwordx4 v28, s[48:51], s66 offen lds
    s_add_u32 m0, s67, 4096
    s_nop 0
    buffer_load_dwordx4 v29, s[48:51], s66 offen lds
    v_lshlrev_b32 v2, 4, v0
    v_and_b32 v6, 31, v0
    v_lshrrev_b32 v7, 5, v0
    v_and_b32 v3, 15, v0
    v_lshlrev_b32 v3, 2, v3
    v_lshl_add_u32 v3, v7, 6, v3
    v_bfe_u32 v4, v0, 4, 1
    v_lshl_add_u32 v3, v4, 7, v3
    v_lshlrev_b32 v4, 8, v7
    v_lshlrev_b32 v7, 6, v7
    v_add_u32 v7, 256, v7
    v_cmp_lt_u32 vcc, 15, v6
    s_nop 1
    v_cndmask_b32 v4, v4, v7, vcc
    v_lshl_add_u32 v4, v6, 4, v4
    v_subrev_u32 v7, 32, v4
    v_cmp_lt_u32 vcc, 19, v6
    s_nop 1
    v_cndmask_b32 v4, v4, v7, vcc
    s_lshl_b32 s88, s32, 1
    s_xor_b32 s88, s88, 6
    v_lshlrev_b32 v6, 3, v6
    v_lshrrev_b32 v7, 5, v0
    v_lshl_add_u32 v6, v7, 2, v6
    s_xor_b32 s36, s88, 0
    s_mul_i32 s36, s36, 1280
    s_add_u32 s36, s36, 40960
    v_add_u32 v84, s36, v2
    v_add_u32 v244, s36, v6
    s_xor_b32 s36, s88, 2
    s_mul_i32 s36, s36, 1280
    s_add_u32 s36, s36, 40960
    v_add_u32 v85, s36, v2
    v_add_u32 v245, s36, v6
    s_xor_b32 s36, s88, 4
    s_mul_i32 s36, s36, 1280
    s_add_u32 s36, s36, 40960
    v_add_u32 v86, s36, v2
    v_add_u32 v246, s36, v6
    s_xor_b32 s36, s88, 6
    s_mul_i32 s36, s36, 1280
    s_add_u32 s36, s36, 40960
    v_add_u32 v87, s36, v2
    v_add_u32 v247, s36, v6
    s_mul_i32 s36, s32, 5120
    v_add_u32 v2, s36, v2
    v_add_u32 v3, s36, v3
    v_add_u32 v4, s36, v4
    v_and_b32 v6, 27, v0
    v_cmp_eq_u32 vcc, 18, v6
    v_mov_b32 v6, 0
    v_mov_b32 v7, 0x3f803f80
    v_cndmask_b32 v6, v6, v7, vcc
    v_mov_b32 v7, v6
    v_mov_b32 v93, 0x3f80
    v_mov_b64 v[94:95], v[6:7]
    v_mov_b64 v[96:97], v[6:7]
    v_mov_b64 v[98:99], v[6:7]
    v_mov_b64 v[100:101], v[6:7]
    v_mov_b32 v107, 0x3f80
    v_mov_b64 v[108:109], v[6:7]
    v_mov_b64 v[110:111], v[6:7]
    v_mov_b64 v[112:113], v[6:7]
    v_mov_b64 v[114:115], v[6:7]
    v_mov_b32 v250, 49580
    v_mov_b32 v1, 0xdddddddd
    s_mov_b32 s39, 0
    s_mov_b32 s65, 3
    s_lshl_b32 s36, s32, 2
    s_add_u32 s89, s36, 161872
    s_add_u32 s36, s36, 161856
    v_mov_b32 v5, s36
    v_mov_b64 v[116:117], 0
    v_mov_b64 v[118:119], 0
    v_mov_b64 v[120:121], 0
    v_mov_b64 v[122:123], 0
    v_mov_b64 v[124:125], 0
    v_mov_b64 v[126:127], 0
    v_mov_b64 v[128:129], 0
    v_mov_b64 v[130:131], 0
    v_mov_b64 v[132:133], 0
    v_mov_b64 v[134:135], 0
    v_mov_b64 v[136:137], 0
    v_mov_b64 v[138:139], 0
    v_mov_b64 v[140:141], 0
    v_mov_b64 v[142:143], 0
    v_mov_b64 v[144:145], 0
    v_mov_b64 v[146:147], 0
    v_mov_b64 v[148:149], 0
    v_mov_b64 v[150:151], 0
    v_mov_b64 v[152:153], 0
    v_mov_b64 v[154:155], 0
    v_mov_b64 v[156:157], 0
    v_mov_b64 v[158:159], 0
    v_mov_b64 v[160:161], 0
    v_mov_b64 v[162:163], 0
    v_mov_b64 v[164:165], 0
    v_mov_b64 v[166:167], 0
    v_mov_b64 v[168:169], 0
    v_mov_b64 v[170:171], 0
    v_mov_b64 v[172:173], 0
    v_mov_b64 v[174:175], 0
    v_mov_b64 v[176:177], 0
    v_mov_b64 v[178:179], 0
    v_mov_b64 v[180:181], 0
    v_mov_b64 v[182:183], 0
    v_mov_b64 v[184:185], 0
    v_mov_b64 v[186:187], 0
    v_mov_b64 v[188:189], 0
    v_mov_b64 v[190:191], 0
    s_add_u32 m0, s68, 65280
    s_nop 0
    buffer_load_dwordx4 v38, s[44:47], s80 offen offset:256 lds
    s_add_u32 m0, s68, 77568
    s_nop 0
    buffer_load_dwordx4 v38, s[44:47], s81 offen offset:256 lds
    s_add_u32 m0, s68, 89856
    s_nop 0
    buffer_load_dwordx4 v38, s[44:47], s82 offen offset:256 lds
    s_add_u32 m0, s67, 20480
    s_add_u32 s66, s66, 163840
    buffer_load_dwordx4 v25, s[48:51], s66 offen lds
    s_add_u32 m0, s67, 21504
    s_nop 0
    buffer_load_dwordx4 v26, s[48:51], s66 offen lds
    s_add_u32 m0, s67, 22528
    s_nop 0
    buffer_load_dwordx4 v27, s[48:51], s66 offen lds
    s_add_u32 m0, s67, 23552
    s_nop 0
    buffer_load_dwordx4 v28, s[48:51], s66 offen lds
    s_add_u32 m0, s67, 24576
    s_nop 0
    buffer_load_dwordx4 v29, s[48:51], s66 offen lds
    s_cmp_lg_u32 s37, 3
    s_cbranch_scc1 L_qown
    v_mov_b32 v30, 161792
    s_mov_b32 s95, 0x400000
L_spin29:
    ds_read_b32 v31, v30
    s_waitcnt lgkmcnt(0)
    v_readfirstlane_b32 s94, v31
    s_nop 0
    s_cmp_ge_u32 s94, 4
    s_cbranch_scc1 L_spun29
    s_sub_u32 s95, s95, 1
    s_cbranch_scc0 L_spin29
L_spun29:
L_qown:
    s_waitcnt vmcnt(8)
    v_mov_b32 v30, 161888
    v_mov_b32 v31, 1
    s_waitcnt lgkmcnt(0)
    s_mov_b64 exec, 1
    ds_add_u32 v30, v31
    s_mov_b64 exec, -1
    s_add_u32 m0, s68, 69120
    s_nop 0
    buffer_load_dwordx4 v38, s[44:47], s80 offen offset:512 lds
    s_add_u32 m0, s68, 81408
    s_nop 0
    buffer_load_dwordx4 v38, s[44:47], s81 offen offset:512 lds
    v_mov_b32 v30, 161888
    s_mov_b32 s95, 0x400000
L_spin30:
    ds_read_b32 v32, v30
    s_waitcnt lgkmcnt(0)
    v_readfirstlane_b32 s94, v32
    s_nop 0
    s_cmp_ge_u32 s94, 4
    s_cbranch_scc1 L_spun30
    s_sub_u32 s95, s95, 1
    s_cbranch_scc0 L_spin30
L_spun30:
    v_mov_b32 v33, 161812
    ds_read_b32 v33, v33
    ds_read_b128 v[192:195], v34 offset:0
    ds_read_b64_tr_b16 v[44:45], v8 offset:0
    ds_read_b64_tr_b16 v[46:47], v8 offset:1280
    ds_read_b128 v[196:199], v35 offset:0
    ds_read_b64_tr_b16 v[48:49], v8 offset:32
    ds_read_b64_tr_b16 v[50:51], v8 offset:1312
    ds_read_b128 v[200:203], v36 offset:0
    ds_read_b64_tr_b16 v[52:53], v8 offset:64
    ds_read_b64_tr_b16 v[54:55], v8 offset:1344
    ds_read_b128 v[204:207], v37 offset:0
    ds_read_b64_tr_b16 v[56:57], v8 offset:96
    ds_read_b64_tr_b16 v[58:59], v8 offset:1376
    ds_read_b64_tr_b16 v[60:61], v8 offset:128
    ds_read_b64_tr_b16 v[62:63], v8 offset:1408
    s_waitcnt lgkmcnt(8)
    v_mfma_f32_16x16x32_bf16 v[224:227], v[44:47], v[192:195], 0
    ds_read_b64_tr_b16 v[64:65], v8 offset:5120
    ds_read_b64_tr_b16 v[66:67], v8 offset:6400
    s_add_u32 m0, s68, 93696
    s_nop 0
    buffer_load_dwordx4 v38, s[44:47], s82 offen offset:512 lds
    v_mfma_f32_16x16x32_bf16 v[228:231], v[48:51], v[192:195], 0
    ds_read_b64_tr_b16 v[68:69], v8 offset:5152
    ds_read_b64_tr_b16 v[70:71], v8 offset:6432
    s_add_u32 m0, s67, 40960
    s_add_u32 s66, s66, 163840
    buffer_load_dwordx4 v25, s[48:51], s66 offen lds
    s_waitcnt lgkmcnt(6)
    v_mfma_f32_16x16x32_bf16 v[232:235], v[52:55], v[192:195], 0
    ds_read_b64_tr_b16 v[72:73], v8 offset:5184
    ds_read_b64_tr_b16 v[74:75], v8 offset:6464
    s_add_u32 m0, s67, 41984
    s_nop 0
    buffer_load_dwordx4 v26, s[48:51], s66 offen lds
    v_mfma_f32_16x16x32_bf16 v[236:239], v[56:59], v[192:195], 0
    ds_read_b64_tr_b16 v[76:77], v8 offset:5216
    ds_read_b64_tr_b16 v[78:79], v8 offset:6496
    s_add_u32 m0, s67, 43008
    s_nop 0
    buffer_load_dwordx4 v27, s[48:51], s66 offen lds
    s_waitcnt lgkmcnt(6)
    v_mfma_f32_16x16x32_bf16 v[240:243], v[60:63], v[192:195], 0
    ds_read_b64_tr_b16 v[80:81], v8 offset:5248
    ds_read_b64_tr_b16 v[82:83], v8 offset:6528
    s_add_u32 m0, s67, 44032
    s_nop 0
    buffer_load_dwordx4 v28, s[48:51], s66 offen lds
    v_mfma_f32_16x16x32_bf16 v[224:227], v[64:67], v[196:199], v[224:227]
    ds_read_b64_tr_b16 v[44:45], v8 offset:10240
    ds_read_b64_tr_b16 v[46:47], v8 offset:11520
    s_add_u32 m0, s67, 45056
    s_nop 0
    buffer_load_dwordx4 v29, s[48:51], s66 offen lds
    s_waitcnt lgkmcnt(6)
    v_mfma_f32_16x16x32_bf16 v[228:231], v[68:71], v[196:199], v[228:231]
    ds_read_b64_tr_b16 v[48:49], v8 offset:10272
    ds_read_b64_tr_b16 v[50:51], v8 offset:11552
    v_mfma_f32_16x16x32_bf16 v[232:235], v[72:75], v[196:199], v[232:235]
    ds_read_b64_tr_b16 v[52:53], v8 offset:10304
    ds_read_b64_tr_b16 v[54:55], v8 offset:11584
    s_waitcnt lgkmcnt(6)
    v_mfma_f32_16x16x32_bf16 v[236:239], v[76:79], v[196:199], v[236:239]
    ds_read_b64_tr_b16 v[56:57], v8 offset:10336
    ds_read_b64_tr_b16 v[58:59], v8 offset:11616
    v_mfma_f32_16x16x32_bf16 v[240:243], v[80:83], v[196:199], v[240:243]
    ds_read_b64_tr_b16 v[60:61], v8 offset:10368
    ds_read_b64_tr_b16 v[62:63], v8 offset:11648
    s_waitcnt lgkmcnt(6)
    v_mfma_f32_16x16x32_bf16 v[224:227], v[44:47], v[200:203], v[224:227]
    s_waitcnt vmcnt(8)
    s_mov_b64 exec, 1
    ds_add_u32 v30, v31 offset:4
    s_mov_b64 exec, -1
    ds_read_b64_tr_b16 v[64:65], v8 offset:15360
    ds_read_b64_tr_b16 v[66:67], v8 offset:16640
    v_mfma_f32_16x16x32_bf16 v[228:231], v[48:51], v[200:203], v[228:231]
    ds_read_b64_tr_b16 v[68:69], v8 offset:15392
    ds_read_b64_tr_b16 v[70:71], v8 offset:16672
    s_waitcnt lgkmcnt(7)
    v_mfma_f32_16x16x32_bf16 v[232:235], v[52:55], v[200:203], v[232:235]
    ds_read_b64_tr_b16 v[72:73], v8 offset:15424
    ds_read_b64_tr_b16 v[74:75], v8 offset:16704
    v_mfma_f32_16x16x32_bf16 v[236:239], v[56:59], v[200:203], v[236:239]
    ds_read_b32 v32, v30 offset:4
    ds_read_b64_tr_b16 v[76:77], v8 offset:15456
    ds_read_b64_tr_b16 v[78:79], v8 offset:16736
    s_waitcnt lgkmcnt(7)
    v_mfma_f32_16x16x32_bf16 v[240:243], v[60:63], v[200:203], v[240:243]
    ds_read_b64_tr_b16 v[80:81], v8 offset:15488
    ds_read_b64_tr_b16 v[82:83], v8 offset:16768
    v_mfma_f32_16x16x32_bf16 v[224:227], v[64:67], v[204:207], v[224:227]
    s_waitcnt lgkmcnt(4)
    v_readfirstlane_b32 s94, v32
    s_nop 0
    s_cmp_ge_u32 s94, 6
    s_cbranch_scc1 L_qv31
    v_mov_b32 v6, 161892
    s_mov_b32 s95, 0x400000
L_spin32:
    ds_read_b32 v7, v6
    s_waitcnt lgkmcnt(0)
    v_readfirstlane_b32 s94, v7
    s_nop 0
    s_cmp_ge_u32 s94, 6
    s_cbranch_scc1 L_spun32
    s_sub_u32 s95, s95, 1
    s_cbranch_scc0 L_spin32
L_spun32:
L_qv31:
    ds_read_b128 v[208:211], v34 offset:4096
    ds_read_b64_tr_b16 v[44:45], v8 offset:20480
    ds_read_b64_tr_b16 v[46:47], v8 offset:21760
    s_add_u32 m0, s68, 60672
    s_nop 0
    buffer_load_dwordx4 v38, s[44:47], s80 offen offset:768 lds
    v_mfma_f32_16x16x32_bf16 v[228:231], v[68:71], v[204:207], v[228:231]
    ds_read_b128 v[212:215], v35 offset:4096
    ds_read_b64_tr_b16 v[48:49], v8 offset:20512
    ds_read_b64_tr_b16 v[50:51], v8 offset:21792
    s_add_u32 m0, s68, 72960
    s_nop 0
    buffer_load_dwordx4 v38, s[44:47], s81 offen offset:768 lds
    v_mfma_f32_16x16x32_bf16 v[232:235], v[72:75], v[204:207], v[232:235]
    ds_read_b128 v[216:219], v36 offset:4096
    ds_read_b64_tr_b16 v[52:53], v8 offset:20544
    ds_read_b64_tr_b16 v[54:55], v8 offset:21824
    s_add_u32 m0, s68, 85248
    s_nop 0
    buffer_load_dwordx4 v38, s[44:47], s82 offen offset:768 lds
    s_waitcnt lgkmcnt(9)
    v_mfma_f32_16x16x32_bf16 v[236:239], v[76:79], v[204:207], v[236:239]
    ds_read_b128 v[220:223], v37 offset:4096
    ds_read_b64_tr_b16 v[56:57], v8 offset:20576
    ds_read_b64_tr_b16 v[58:59], v8 offset:21856
    s_add_u32 m0, s67, 122880
    s_add_u32 s66, s66, 163840
    buffer_load_dwordx4 v25, s[48:51], s66 offen lds
    v_mfma_f32_16x16x32_bf16 v[240:243], v[80:83], v[204:207], v[240:243]
    ds_read_b64_tr_b16 v[60:61], v8 offset:20608
    ds_read_b64_tr_b16 v[62:63], v8 offset:21888
    s_add_u32 m0, s67, 123904
    s_nop 0
    buffer_load_dwordx4 v26, s[48:51], s66 offen lds
    s_waitcnt lgkmcnt(8)
    v_mfma_f32_16x16x32_bf16 v[224:227], v[44:47], v[208:211], v[224:227]
    ds_read_b64_tr_b16 v[64:65], v8 offset:25600
    ds_read_b64_tr_b16 v[66:67], v8 offset:26880
    s_add_u32 m0, s67, 124928
    s_nop 0
    buffer_load_dwordx4 v27, s[48:51], s66 offen lds
    v_mfma_f32_16x16x32_bf16 v[228:231], v[48:51], v[208:211], v[228:231]
    ds_read_b64_tr_b16 v[68:69], v8 offset:25632
    ds_read_b64_tr_b16 v[70:71], v8 offset:26912
    s_add_u32 m0, s67, 125952
    s_nop 0
    buffer_load_dwordx4 v28, s[48:51], s66 offen lds
    s_waitcnt lgkmcnt(6)
    v_mfma_f32_16x16x32_bf16 v[232:235], v[52:55], v[208:211], v[232:235]
    ds_read_b64_tr_b16 v[72:73], v8 offset:25664
    ds_read_b64_tr_b16 v[74:75], v8 offset:26944
    s_add_u32 m0, s67, 126976
    s_nop 0
    buffer_load_dwordx4 v29, s[48:51], s66 offen lds
    v_mfma_f32_16x16x32_bf16 v[236:239], v[56:59], v[208:211], v[236:239]
    ds_read_b64_tr_b16 v[76:77], v8 offset:25696
    ds_read_b64_tr_b16 v[78:79], v8 offset:26976
    s_waitcnt lgkmcnt(6)
    v_mfma_f32_16x16x32_bf16 v[240:243], v[60:63], v[208:211], v[240:243]
    ds_read_b64_tr_b16 v[80:81], v8 offset:25728
    ds_read_b64_tr_b16 v[82:83], v8 offset:27008
    v_mfma_f32_16x16x32_bf16 v[224:227], v[64:67], v[212:215], v[224:227]
    v_readfirstlane_b32 s3, v33
    ds_read_b64_tr_b16 v[44:45], v8 offset:30720
    ds_read_b64_tr_b16 v[46:47], v8 offset:32000
    s_waitcnt lgkmcnt(6)
    v_mfma_f32_16x16x32_bf16 v[228:231], v[68:71], v[212:215], v[228:231]
    ds_read_b64_tr_b16 v[48:49], v8 offset:30752
    ds_read_b64_tr_b16 v[50:51], v8 offset:32032
    v_mfma_f32_16x16x32_bf16 v[232:235], v[72:75], v[212:215], v[232:235]
    ds_read_b64_tr_b16 v[52:53], v8 offset:30784
    ds_read_b64_tr_b16 v[54:55], v8 offset:32064
    s_waitcnt lgkmcnt(6)
    v_mfma_f32_16x16x32_bf16 v[236:239], v[76:79], v[212:215], v[236:239]
    ds_read_b64_tr_b16 v[56:57], v8 offset:30816
    ds_read_b64_tr_b16 v[58:59], v8 offset:32096
    v_mfma_f32_16x16x32_bf16 v[240:243], v[80:83], v[212:215], v[240:243]
    ds_read_b64_tr_b16 v[60:61], v8 offset:30848
    ds_read_b64_tr_b16 v[62:63], v8 offset:32128
    s_waitcnt lgkmcnt(6)
    v_mfma_f32_16x16x32_bf16 v[224:227], v[44:47], v[216:219], v[224:227]
    s_waitcnt vmcnt(8)
    s_mov_b64 exec, 1
    ds_add_u32 v30, v31 offset:8
    s_mov_b64 exec, -1
    ds_read_b64_tr_b16 v[64:65], v8 offset:35840
    ds_read_b64_tr_b16 v[66:67], v8 offset:37120
    v_mfma_f32_16x16x32_bf16 v[228:231], v[48:51], v[216:219], v[228:231]
    ds_read_b64_tr_b16 v[68:69], v8 offset:35872
    ds_read_b64_tr_b16 v[70:71], v8 offset:37152
    s_waitcnt lgkmcnt(7)
    v_mfma_f32_16x16x32_bf16 v[232:235], v[52:55], v[216:219], v[232:235]
    ds_read_b64_tr_b16 v[72:73], v8 offset:35904
    ds_read_b64_tr_b16 v[74:75], v8 offset:37184
    v_mfma_f32_16x16x32_bf16 v[236:239], v[56:59], v[216:219], v[236:239]
    ds_read_b32 v32, v30 offset:8
    ds_read_b64_tr_b16 v[76:77], v8 offset:35936
    ds_read_b64_tr_b16 v[78:79], v8 offset:37216
    s_waitcnt lgkmcnt(7)
    v_mfma_f32_16x16x32_bf16 v[240:243], v[60:63], v[216:219], v[240:243]
    ds_read_b64_tr_b16 v[80:81], v8 offset:35968
    ds_read_b64_tr_b16 v[82:83], v8 offset:37248
    v_mfma_f32_16x16x32_bf16 v[224:227], v[64:67], v[220:223], v[224:227]
    s_waitcnt lgkmcnt(4)
    v_readfirstlane_b32 s94, v32
    s_nop 0
    s_cmp_ge_u32 s94, 4
    s_cbranch_scc1 L_qv33
    v_mov_b32 v6, 161896
    s_mov_b32 s95, 0x400000
L_spin34:
    ds_read_b32 v7, v6
    s_waitcnt lgkmcnt(0)
    v_readfirstlane_b32 s94, v7
    s_nop 0
    s_cmp_ge_u32 s94, 4
    s_cbranch_scc1 L_spun34
    s_sub_u32 s95, s95, 1
    s_cbranch_scc0 L_spin34
L_spun34:
L_qv33:
    ds_read_b128 v[192:195], v34 offset:8192
    ds_read_b64_tr_b16 v[44:45], v8 offset:40960
    ds_read_b64_tr_b16 v[46:47], v8 offset:42240
    s_add_u32 m0, s68, 64512
    s_nop 0
    buffer_load_dwordx4 v38, s[44:47], s80 offen offset:1024 lds
    v_mfma_f32_16x16x32_bf16 v[228:231], v[68:71], v[220:223], v[228:231]
    ds_read_b128 v[196:199], v35 offset:8192
    ds_read_b64_tr_b16 v[48:49], v8 offset:40992
    ds_read_b64_tr_b16 v[50:51], v8 offset:42272
    s_add_u32 m0, s68, 76800
    s_nop 0
    buffer_load_dwordx4 v38, s[44:47], s81 offen offset:1024 lds
    v_mfma_f32_16x16x32_bf16 v[232:235], v[72:75], v[220:223], v[232:235]
    ds_read_b128 v[200:203], v36 offset:8192
    ds_read_b64_tr_b16 v[52:53], v8 offset:41024
    ds_read_b64_tr_b16 v[54:55], v8 offset:42304
    s_add_u32 m0, s68, 89088
    s_nop 0
    buffer_load_dwordx4 v38, s[44:47], s82 offen offset:1024 lds
    s_waitcnt lgkmcnt(9)
    v_mfma_f32_16x16x32_bf16 v[236:239], v[76:79], v[220:223], v[236:239]
    ds_read_b128 v[204:207], v37 offset:8192
    ds_read_b64_tr_b16 v[56:57], v8 offset:41056
    ds_read_b64_tr_b16 v[58:59], v8 offset:42336
    s_add_u32 m0, s67, 0
    s_add_u32 s66, s66, 163840
    buffer_load_dwordx4 v25, s[48:51], s66 offen lds
    v_mfma_f32_16x16x32_bf16 v[240:243], v[80:83], v[220:223], v[240:243]
    ds_read_b64_tr_b16 v[60:61], v8 offset:41088
    ds_read_b64_tr_b16 v[62:63], v8 offset:42368
    s_add_u32 m0, s67, 1024
    s_nop 0
    buffer_load_dwordx4 v26, s[48:51], s66 offen lds
    s_waitcnt lgkmcnt(8)
    v_mfma_f32_16x16x32_bf16 v[224:227], v[44:47], v[192:195], v[224:227]
    ds_read_b64_tr_b16 v[64:65], v8 offset:46080
    ds_read_b64_tr_b16 v[66:67], v8 offset:47360
    s_add_u32 m0, s67, 2048
    s_nop 0
    buffer_load_dwordx4 v27, s[48:51], s66 offen lds
    v_mfma_f32_16x16x32_bf16 v[228:231], v[48:51], v[192:195], v[228:231]
    ds_read_b64_tr_b16 v[68:69], v8 offset:46112
    ds_read_b64_tr_b16 v[70:71], v8 offset:47392
    s_add_u32 m0, s67, 3072
    s_nop 0
    buffer_load_dwordx4 v28, s[48:51], s66 offen lds
    s_waitcnt lgkmcnt(6)
    v_mfma_f32_16x16x32_bf16 v[232:235], v[52:55], v[192:195], v[232:235]
    ds_read_b64_tr_b16 v[72:73], v8 offset:46144
    ds_read_b64_tr_b16 v[74:75], v8 offset:47424
    s_add_u32 m0, s67, 4096
    s_nop 0
    buffer_load_dwordx4 v29, s[48:51], s66 offen lds
    v_mfma_f32_16x16x32_bf16 v[236:239], v[56:59], v[192:195], v[236:239]
    ds_read_b64_tr_b16 v[76:77], v8 offset:46176
    ds_read_b64_tr_b16 v[78:79], v8 offset:47456
    s_waitcnt lgkmcnt(6)
    v_mfma_f32_16x16x32_bf16 v[240:243], v[60:63], v[192:195], v[240:243]
    ds_read_b64_tr_b16 v[80:81], v8 offset:46208
    ds_read_b64_tr_b16 v[82:83], v8 offset:47488
    v_mfma_f32_16x16x32_bf16 v[224:227], v[64:67], v[196:199], v[224:227]
    ds_read_b64_tr_b16 v[44:45], v8 offset:51200
    ds_read_b64_tr_b16 v[46:47], v8 offset:52480
    s_waitcnt lgkmcnt(6)
    v_mfma_f32_16x16x32_bf16 v[228:231], v[68:71], v[196:199], v[228:231]
    ds_read_b64_tr_b16 v[48:49], v8 offset:51232
    ds_read_b64_tr_b16 v[50:51], v8 offset:52512
    v_mfma_f32_16x16x32_bf16 v[232:235], v[72:75], v[196:199], v[232:235]
    ds_read_b64_tr_b16 v[52:53], v8 offset:51264
    ds_read_b64_tr_b16 v[54:55], v8 offset:52544
    s_waitcnt lgkmcnt(6)
    v_mfma_f32_16x16x32_bf16 v[236:239], v[76:79], v[196:199], v[236:239]
    ds_read_b64_tr_b16 v[56:57], v8 offset:51296
    ds_read_b64_tr_b16 v[58:59], v8 offset:52576
    v_mfma_f32_16x16x32_bf16 v[240:243], v[80:83], v[196:199], v[240:243]
    ds_read_b64_tr_b16 v[60:61], v8 offset:51328
    ds_read_b64_tr_b16 v[62:63], v8 offset:52608
    s_waitcnt lgkmcnt(6)
    v_mfma_f32_16x16x32_bf16 v[224:227], v[44:47], v[200:203], v[224:227]
    s_waitcnt vmcnt(8)
    s_mov_b64 exec, 1
    ds_add_u32 v30, v31 offset:12
    s_mov_b64 exec, -1
    ds_read_b64_tr_b16 v[64:65], v8 offset:56320
    ds_read_b64_tr_b16 v[66:67], v8 offset:57600
    v_mfma_f32_16x16x32_bf16 v[228:231], v[48:51], v[200:203], v[228:231]
    ds_read_b64_tr_b16 v[68:69], v8 offset:56352
    ds_read_b64_tr_b16 v[70:71], v8 offset:57632
    s_waitcnt lgkmcnt(7)
    v_mfma_f32_16x16x32_bf16 v[232:235], v[52:55], v[200:203], v[232:235]
    ds_read_b64_tr_b16 v[72:73], v8 offset:56384
    ds_read_b64_tr_b16 v[74:75], v8 offset:57664
    v_mfma_f32_16x16x32_bf16 v[236:239], v[56:59], v[200:203], v[236:239]
    ds_read_b32 v32, v30 offset:12
    ds_read_b64_tr_b16 v[76:77], v8 offset:56416
    ds_read_b64_tr_b16 v[78:79], v8 offset:57696
    s_waitcnt lgkmcnt(7)
    v_mfma_f32_16x16x32_bf16 v[240:243], v[60:63], v[200:203], v[240:243]
    ds_read_b64_tr_b16 v[80:81], v8 offset:56448
    ds_read_b64_tr_b16 v[82:83], v8 offset:57728
    v_mfma_f32_16x16x32_bf16 v[224:227], v[64:67], v[204:207], v[224:227]
    s_waitcnt lgkmcnt(4)
    v_readfirstlane_b32 s94, v32
    s_nop 0
    s_cmp_ge_u32 s94, 4
    s_cbranch_scc1 L_qv35
    v_mov_b32 v6, 161900
    s_mov_b32 s95, 0x400000
L_spin36:
    ds_read_b32 v7, v6
    s_waitcnt lgkmcnt(0)
    v_readfirstlane_b32 s94, v7
    s_nop 0
    s_cmp_ge_u32 s94, 4
    s_cbranch_scc1 L_spun36
    s_sub_u32 s95, s95, 1
    s_cbranch_scc0 L_spin36
L_spun36:
L_qv35:
    v_add_u32 v34, s83, v34
    v_add_u32 v35, s83, v35
    v_add_u32 v36, s83, v36
    v_add_u32 v37, s83, v37
    ds_read_b128 v[208:211], v34 offset:0
    ds_read_b64_tr_b16 v[44:45], v9 offset:0
    ds_read_b64_tr_b16 v[46:47], v9 offset:1280
    v_mfma_f32_16x16x32_bf16 v[228:231], v[68:71], v[204:207], v[228:231]
    ds_read_b128 v[212:215], v35 offset:0
    ds_read_b64_tr_b16 v[48:49], v9 offset:32
    ds_read_b64_tr_b16 v[50:51], v9 offset:1312
    v_mfma_f32_16x16x32_bf16 v[232:235], v[72:75], v[204:207], v[232:235]
    ds_read_b128 v[216:219], v36 offset:0
    ds_read_b64_tr_b16 v[52:53], v9 offset:64
    ds_read_b64_tr_b16 v[54:55], v9 offset:1344
    s_waitcnt lgkmcnt(9)
    v_mfma_f32_16x16x32_bf16 v[236:239], v[76:79], v[204:207], v[236:239]
    ds_read_b128 v[220:223], v37 offset:0
    ds_read_b64_tr_b16 v[56:57], v9 offset:96
    ds_read_b64_tr_b16 v[58:59], v9 offset:1376
    v_mfma_f32_16x16x32_bf16 v[240:243], v[80:83], v[204:207], v[240:243]
    ds_read_b64_tr_b16 v[60:61], v9 offset:128
    ds_read_b64_tr_b16 v[62:63], v9 offset:1408
    s_waitcnt lgkmcnt(8)
    v_mfma_f32_16x16x32_bf16 v[224:227], v[44:47], v[208:211], v[224:227]
    ds_read_b64_tr_b16 v[64:65], v9 offset:5120
    ds_read_b64_tr_b16 v[66:67], v9 offset:6400
    v_mfma_f32_16x16x32_bf16 v[228:231], v[48:51], v[208:211], v[228:231]
    ds_read_b64_tr_b16 v[68:69], v9 offset:5152
    ds_read_b64_tr_b16 v[70:71], v9 offset:6432
    s_waitcnt lgkmcnt(6)
    v_mfma_f32_16x16x32_bf16 v[232:235], v[52:55], v[208:211], v[232:235]
    ds_read_b64_tr_b16 v[72:73], v9 offset:5184
    ds_read_b64_tr_b16 v[74:75], v9 offset:6464
    v_mfma_f32_16x16x32_bf16 v[236:239], v[56:59], v[208:211], v[236:239]
    ds_read_b64_tr_b16 v[76:77], v9 offset:5216
    ds_read_b64_tr_b16 v[78:79], v9 offset:6496
    s_waitcnt lgkmcnt(6)
    v_mfma_f32_16x16x32_bf16 v[240:243], v[60:63], v[208:211], v[240:243]
    ds_read_b64_tr_b16 v[80:81], v9 offset:5248
    ds_read_b64_tr_b16 v[82:83], v9 offset:6528
    v_mfma_f32_16x16x32_bf16 v[224:227], v[64:67], v[212:215], v[224:227]
    ds_read_b64_tr_b16 v[44:45], v9 offset:10240
    ds_read_b64_tr_b16 v[46:47], v9 offset:11520
    s_waitcnt lgkmcnt(6)
    v_mfma_f32_16x16x32_bf16 v[228:231], v[68:71], v[212:215], v[228:231]
    ds_read_b64_tr_b16 v[48:49], v9 offset:10272
    ds_read_b64_tr_b16 v[50:51], v9 offset:11552
    v_mov_b64 v[208:209], 0
    v_mfma_f32_16x16x32_bf16 v[232:235], v[72:75], v[212:215], v[232:235]
    ds_read_b64_tr_b16 v[52:53], v9 offset:10304
    ds_read_b64_tr_b16 v[54:55], v9 offset:11584
    s_waitcnt lgkmcnt(6)
    v_mfma_f32_16x16x32_bf16 v[236:239], v[76:79], v[212:215], v[236:239]
    ds_read_b64_tr_b16 v[56:57], v9 offset:10336
    ds_read_b64_tr_b16 v[58:59], v9 offset:11616
    v_mov_b64 v[210:211], 0
    v_mfma_f32_16x16x32_bf16 v[240:243], v[80:83], v[212:215], v[240:243]
    ds_read_b64_tr_b16 v[60:61], v9 offset:10368
    ds_read_b64_tr_b16 v[62:63], v9 offset:11648
    s_waitcnt lgkmcnt(6)
    v_mfma_f32_16x16x32_bf16 v[224:227], v[44:47], v[216:219], v[224:227]
    s_waitcnt vmcnt(0)
    s_mov_b64 exec, 1
    ds_add_u32 v30, v31 offset:16
    s_mov_b64 exec, -1
    ds_read_b64_tr_b16 v[64:65], v9 offset:15360
    ds_read_b64_tr_b16 v[66:67], v9 offset:16640
    v_mfma_f32_16x16x32_bf16 v[228:231], v[48:51], v[216:219], v[228:231]
    ds_read_b64_tr_b16 v[68:69], v9 offset:15392
    ds_read_b64_tr_b16 v[70:71], v9 offset:16672
    v_mov_b64 v[212:213], 0
    s_waitcnt lgkmcnt(7)
    v_mfma_f32_16x16x32_bf16 v[232:235], v[52:55], v[216:219], v[232:235]
    ds_read_b64_tr_b16 v[72:73], v9 offset:15424
    ds_read_b64_tr_b16 v[74:75], v9 offset:16704
    v_mfma_f32_16x16x32_bf16 v[236:239], v[56:59], v[216:219], v[236:239]
    ds_read_b32 v32, v30 offset:16
    ds_read_b64_tr_b16 v[76:77], v9 offset:15456
    ds_read_b64_tr_b16 v[78:79], v9 offset:16736
    v_mov_b64 v[214:215], 0
    s_waitcnt lgkmcnt(7)
    v_mfma_f32_16x16x32_bf16 v[240:243], v[60:63], v[216:219], v[240:243]
    ds_read_b64_tr_b16 v[80:81], v9 offset:15488
    ds_read_b64_tr_b16 v[82:83], v9 offset:16768
    v_mfma_f32_16x16x32_bf16 v[224:227], v[64:67], v[220:223], v[224:227]
    s_waitcnt lgkmcnt(4)
    v_readfirstlane_b32 s94, v32
    s_nop 0
    s_cmp_ge_u32 s94, 4
    s_cbranch_scc1 L_qv37
    v_mov_b32 v6, 161904
    s_mov_b32 s95, 0x400000
L_spin38:
    ds_read_b32 v7, v6
    s_waitcnt lgkmcnt(0)
    v_readfirstlane_b32 s94, v7
    s_nop 0
    s_cmp_ge_u32 s94, 4
    s_cbranch_scc1 L_spun38
    s_sub_u32 s95, s95, 1
    s_cbranch_scc0 L_spin38
L_spun38:
L_qv37:
    ds_read_b128 v[192:195], v34 offset:4096
    ds_read_b64_tr_b16 v[44:45], v8 offset:0
    ds_read_b64_tr_b16 v[46:47], v8 offset:1280
    v_mfma_f32_16x16x32_bf16 v[228:231], v[68:71], v[220:223], v[228:231]
    ds_read_b128 v[196:199], v35 offset:4096
    ds_read_b64_tr_b16 v[48:49], v8 offset:32
    ds_read_b64_tr_b16 v[50:51], v8 offset:1312
    v_mov_b64 v[216:217], 0
    v_mfma_f32_16x16x32_bf16 v[232:235], v[72:75], v[220:223], v[232:235]
    ds_read_b128 v[200:203], v36 offset:4096
    ds_read_b64_tr_b16 v[52:53], v8 offset:64
    ds_read_b64_tr_b16 v[54:55], v8 offset:1344
    s_waitcnt lgkmcnt(9)
    v_mfma_f32_16x16x32_bf16 v[236:239], v[76:79], v[220:223], v[236:239]
    ds_read_b128 v[204:207], v37 offset:4096
    ds_read_b64_tr_b16 v[56:57], v8 offset:96
    ds_read_b64_tr_b16 v[58:59], v8 offset:1376
    v_mov_b64 v[218:219], 0
    v_mfma_f32_16x16x32_bf16 v[240:243], v[80:83], v[220:223], v[240:243]
    ds_read_b64_tr_b16 v[60:61], v8 offset:128
    ds_read_b64_tr_b16 v[62:63], v8 offset:1408
    s_waitcnt lgkmcnt(8)
    v_mfma_f32_16x16x32_bf16 v[224:227], v[44:47], v[192:195], v[224:227]
    ds_read_b64_tr_b16 v[64:65], v8 offset:5120
    ds_read_b64_tr_b16 v[66:67], v8 offset:6400
    v_mfma_f32_16x16x32_bf16 v[228:231], v[48:51], v[192:195], v[228:231]
    ds_read_b64_tr_b16 v[68:69], v8 offset:5152
    ds_read_b64_tr_b16 v[70:71], v8 offset:6432
    v_mov_b64 v[220:221], 0
    s_waitcnt lgkmcnt(6)
    v_mfma_f32_16x16x32_bf16 v[232:235], v[52:55], v[192:195], v[232:235]
    ds_read_b64_tr_b16 v[72:73], v8 offset:5184
    ds_read_b64_tr_b16 v[74:75], v8 offset:6464
    v_mfma_f32_16x16x32_bf16 v[236:239], v[56:59], v[192:195], v[236:239]
    ds_read_b64_tr_b16 v[76:77], v8 offset:5216
    ds_read_b64_tr_b16 v[78:79], v8 offset:6496
    v_mov_b64 v[222:223], 0
    s_waitcnt lgkmcnt(6)
    v_mfma_f32_16x16x32_bf16 v[240:243], v[60:63], v[192:195], v[240:243]
    ds_read_b64_tr_b16 v[80:81], v8 offset:5248
    ds_read_b64_tr_b16 v[82:83], v8 offset:6528
    v_mfma_f32_16x16x32_bf16 v[224:227], v[64:67], v[196:199], v[224:227]
    ds_read_b64_tr_b16 v[44:45], v8 offset:10240
    ds_read_b64_tr_b16 v[46:47], v8 offset:11520
    s_waitcnt lgkmcnt(6)
    v_mfma_f32_16x16x32_bf16 v[228:231], v[68:71], v[196:199], v[228:231]
    ds_read_b64_tr_b16 v[48:49], v8 offset:10272
    ds_read_b64_tr_b16 v[50:51], v8 offset:11552
    v_mov_b64 v[192:193], 0
    v_mfma_f32_16x16x32_bf16 v[232:235], v[72:75], v[196:199], v[232:235]
    ds_read_b64_tr_b16 v[52:53], v8 offset:10304
    ds_read_b64_tr_b16 v[54:55], v8 offset:11584
    s_waitcnt lgkmcnt(6)
    v_mfma_f32_16x16x32_bf16 v[236:239], v[76:79], v[196:199], v[236:239]
    ds_read_b64_tr_b16 v[56:57], v8 offset:10336
    ds_read_b64_tr_b16 v[58:59], v8 offset:11616
    v_mov_b64 v[194:195], 0
    v_mfma_f32_16x16x32_bf16 v[240:243], v[80:83], v[196:199], v[240:243]
    ds_read_b64_tr_b16 v[60:61], v8 offset:10368
    ds_read_b64_tr_b16 v[62:63], v8 offset:11648
    s_waitcnt lgkmcnt(6)
    v_mfma_f32_16x16x32_bf16 v[224:227], v[44:47], v[200:203], v[224:227]
    ds_read_b64_tr_b16 v[64:65], v8 offset:15360
    ds_read_b64_tr_b16 v[66:67], v8 offset:16640
    v_mfma_f32_16x16x32_bf16 v[228:231], v[48:51], v[200:203], v[228:231]
    ds_read_b64_tr_b16 v[68:69], v8 offset:15392
    ds_read_b64_tr_b16 v[70:71], v8 offset:16672
    v_mov_b64 v[196:197], 0
    buffer_load_dwordx2 v[248:249], v251, s[72:75], s76 offen offset:0 sc1
    s_waitcnt lgkmcnt(6)
    v_mfma_f32_16x16x32_bf16 v[232:235], v[52:55], v[200:203], v[232:235]
    ds_read_b64_tr_b16 v[72:73], v8 offset:15424
    ds_read_b64_tr_b16 v[74:75], v8 offset:16704
    v_mfma_f32_16x16x32_bf16 v[236:239], v[56:59], v[200:203], v[236:239]
    ds_read_b64_tr_b16 v[76:77], v8 offset:15456
    ds_read_b64_tr_b16 v[78:79], v8 offset:16736
    v_mov_b64 v[198:199], 0
    s_waitcnt lgkmcnt(6)
    v_mfma_f32_16x16x32_bf16 v[240:243], v[60:63], v[200:203], v[240:243]
    ds_read_b64_tr_b16 v[80:81], v8 offset:15488
    ds_read_b64_tr_b16 v[82:83], v8 offset:16768
    v_mfma_f32_16x16x32_bf16 v[224:227], v[64:67], v[204:207], v[224:227]
    s_waitcnt lgkmcnt(4)
    v_mfma_f32_16x16x32_bf16 v[228:231], v[68:71], v[204:207], v[228:231]
    v_mov_b64 v[200:201], 0
    v_mfma_f32_16x16x32_bf16 v[232:235], v[72:75], v[204:207], v[232:235]
    s_waitcnt lgkmcnt(0)
    v_mfma_f32_16x16x32_bf16 v[236:239], v[76:79], v[204:207], v[236:239]
    v_mov_b64 v[202:203], 0
    v_mfma_f32_16x16x32_bf16 v[240:243], v[80:83], v[204:207], v[240:243]
    s_mov_b32 s66, 0x3ea52b5c
    s_mov_b32 s67, s66
    s_nop 1
    v_pk_mul_f32 v[224:225], v[224:225], s[66:67]
    v_pk_mul_f32 v[226:227], v[226:227], s[66:67]
    v_cvt_pk_bf16_f32 v16, v224, v225
    v_cvt_pk_bf16_f32 v17, v226, v227
    ds_write_b64 v10, v[16:17]
    v_pk_mul_f32 v[228:229], v[228:229], s[66:67]
    v_pk_mul_f32 v[230:231], v[230:231], s[66:67]
    v_cvt_pk_bf16_f32 v18, v228, v229
    v_cvt_pk_bf16_f32 v19, v230, v231
    ds_write_b64 v11, v[18:19]
    v_pk_mul_f32 v[232:233], v[232:233], s[66:67]
    v_pk_mul_f32 v[234:235], v[234:235], s[66:67]
    v_cvt_pk_bf16_f32 v20, v232, v233
    v_cvt_pk_bf16_f32 v21, v234, v235
    ds_write_b64 v12, v[20:21]
    v_pk_mul_f32 v[236:237], v[236:237], s[66:67]
    v_pk_mul_f32 v[238:239], v[238:239], s[66:67]
    v_cvt_pk_bf16_f32 v22, v236, v237
    v_cvt_pk_bf16_f32 v23, v238, v239
    ds_write_b64 v13, v[22:23]
    v_pk_mul_f32 v[240:241], v[240:241], s[66:67]
    v_pk_mul_f32 v[242:243], v[242:243], s[66:67]
    v_cvt_pk_bf16_f32 v24, v240, v241
    v_cvt_pk_bf16_f32 v25, v242, v243
    ds_write_b64 v14, v[24:25]
    v_mov_b64 v[204:205], 0
    v_mov_b64 v[206:207], 0
    v_mov_b64 v[224:225], 0
    v_mov_b64 v[226:227], 0
    v_mov_b64 v[228:229], 0
    v_mov_b64 v[230:231], 0
    v_mov_b64 v[232:233], 0
    v_mov_b64 v[234:235], 0
    v_mov_b64 v[236:237], 0
    v_mov_b64 v[238:239], 0
    v_mov_b64 v[240:241], 0
    v_mov_b64 v[242:243], 0
    s_waitcnt lgkmcnt(0)
    s_barrier
    s_setprio 1
    ds_read_b128 v[88:91], v2 offset:20480
    ds_read_b32 v92, v3 offset:21504
    ds_read_b128 v[8:11], v84 offset:0
    ds_read_b32 v12, v244 offset:1024
    ds_read_b128 v[14:17], v84 offset:1280
    ds_read_b32 v18, v244 offset:2304
    s_mov_b64 exec, s[90:91]
    ds_read_b128 v[94:97], v4 offset:21760
    ds_read_b128 v[98:101], v4 offset:22400
    s_mov_b64 exec, -1
    ds_read_b128 v[20:23], v85 offset:0
    ds_read_b32 v24, v245 offset:1024
    ds_read_b128 v[26:29], v85 offset:1280
    ds_read_b32 v30, v245 offset:2304
    ds_read_b128 v[32:35], v86 offset:0
    ds_read_b32 v36, v246 offset:1024
    v_mov_b32 v13, v250
    s_waitcnt lgkmcnt(10)
    s_mov_b32 s37, s88
    v_mfma_f32_32x32x8_bf16 v[56:71], v[92:93], v[12:13], 0
    ds_read_b128 v[38:41], v86 offset:1280
    ds_read_b32 v42, v246 offset:2304
    ds_read_b128 v[44:47], v87 offset:0
    ds_read_b32 v48, v247 offset:1024
    ds_read_b128 v[50:53], v87 offset:1280
    ds_read_b32 v54, v247 offset:2304
    v_mov_b32 v19, v13
    v_mov_b32 v25, v13
    v_mov_b32 v31, v13
    v_mov_b32 v37, v13
    v_mov_b32 v43, v13
    v_mov_b32 v49, v13
    v_mov_b32 v55, v13
    v_mfma_f32_32x32x16_bf16 v[56:71], v[88:91], v[8:11], v[56:71]
    ds_read_b128 v[102:105], v2 offset:23040
    ds_read_b32 v106, v3 offset:24064
    s_mov_b64 exec, s[90:91]
    ds_read_b128 v[108:111], v4 offset:24320
    ds_read_b128 v[112:115], v4 offset:24960
    s_mov_b64 exec, -1
    v_mov_b32 v80, 0
    v_mov_b32 v81, 0
    v_mov_b32 v82, 0
    v_mov_b32 v83, 0
    v_mov_b32 v84, 0
    v_mov_b32 v85, 0
    v_mov_b32 v86, 0
    v_mov_b32 v87, 0
    v_lshl_add_u32 v244, v0, 4, s84
    v_lshl_add_u32 v245, v0, 4, s85
    v_lshl_add_u32 v246, v0, 4, s86
    v_lshl_add_u32 v247, v0, 4, s87
    v_add_u32 v2, 102400, v2
    v_add_u32 v3, 102400, v3
    v_add_u32 v4, 102400, v4
    s_mov_b32 s64, 0
    s_mov_b32 s70, -81920
    v_mov_b32 v6, 161820
    v_mov_b32 v7, 1
    s_waitcnt lgkmcnt(0)
    s_mov_b64 exec, 1
    ds_add_u32 v6, v7
    s_mov_b64 exec, -1
.p2align 3
L_att_loop:
    v_exp_f32 v56, v56
    v_exp_f32 v57, v57
    v_smfmac_f32_32x32x32_bf16 v[228:243], v[112:115], v[80:87], v1
    v_exp_f32 v58, v58
    v_exp_f32 v59, v59
    v_exp_f32 v60, v60
    v_mfma_f32_32x32x8_bf16 v[72:87], v[92:93], v[18:19], 0
    v_exp_f32 v61, v61
    v_exp_f32 v62, v62
    v_exp_f32 v63, v63
    v_exp_f32 v64, v64
    v_exp_f32 v65, v65
    v_mfma_f32_32x32x16_bf16 v[72:87], v[88:91], v[14:17], v[72:87]
    v_exp_f32 v66, v66
    v_exp_f32 v67, v67
    v_exp_f32 v68, v68
    v_exp_f32 v69, v69
    v_smfmac_f32_32x32x32_bf16 v[116:131], v[94:97], v[56:63], v1
    v_exp_f32 v70, v70
    v_exp_f32 v71, v71
    v_exp_f32 v72, v72
    v_exp_f32 v73, v73
    v_smfmac_f32_32x32x32_bf16 v[116:131], v[98:101], v[64:71], v1
    v_exp_f32 v74, v74
    v_exp_f32 v75, v75
    v_exp_f32 v76, v76
    v_mfma_f32_32x32x8_bf16 v[56:71], v[92:93], v[24:25], 0
    v_exp_f32 v77, v77
    v_exp_f32 v78, v78
    v_exp_f32 v79, v79
    v_exp_f32 v80, v80
    v_exp_f32 v81, v81
    v_mfma_f32_32x32x16_bf16 v[56:71], v[88:91], v[20:23], v[56:71]
    v_exp_f32 v82, v82
    v_exp_f32 v83, v83
    v_exp_f32 v84, v84
    v_exp_f32 v85, v85
    v_smfmac_f32_32x32x32_bf16 v[132:147], v[94:97], v[72:79], v1
    s_cmp_eq_u32 s65, 3
    s_cbranch_scc1 L_att_skip
    ds_read_b128 v[102:105], v2 offset:2560
    ds_read_b32 v106, v3 offset:3584
    s_mov_b64 exec, s[90:91]
    ds_read_b128 v[108:111], v4 offset:3840
    ds_read_b128 v[112:115], v4 offset:4480
    s_mov_b64 exec, -1
L_att_skip:
    v_exp_f32 v86, v86
    v_exp_f32 v87, v87
    v_exp_f32 v56, v56
    v_exp_f32 v57, v57
    v_smfmac_f32_32x32x32_bf16 v[132:147], v[98:101], v[80:87], v1
    v_exp_f32 v58, v58
    v_exp_f32 v59, v59
    v_exp_f32 v60, v60
    v_mfma_f32_32x32x8_bf16 v[72:87], v[92:93], v[30:31], 0
    v_exp_f32 v61, v61
    v_exp_f32 v62, v62
    v_exp_f32 v63, v63
    v_exp_f32 v64, v64
    v_exp_f32 v65, v65
    v_mfma_f32_32x32x16_bf16 v[72:87], v[88:91], v[26:29], v[72:87]
    v_exp_f32 v66, v66
    v_exp_f32 v67, v67
    v_exp_f32 v68, v68
    v_exp_f32 v69, v69
    v_smfmac_f32_32x32x32_bf16 v[148:163], v[94:97], v[56:63], v1
    v_exp_f32 v70, v70
    v_exp_f32 v71, v71
    v_exp_f32 v72, v72
    v_exp_f32 v73, v73
    v_smfmac_f32_32x32x32_bf16 v[148:163], v[98:101], v[64:71], v1
    v_exp_f32 v74, v74
    v_exp_f32 v75, v75
    v_exp_f32 v76, v76
    v_mfma_f32_32x32x8_bf16 v[56:71], v[92:93], v[36:37], 0
    v_exp_f32 v77, v77
    v_exp_f32 v78, v78
    v_exp_f32 v79, v79
    v_exp_f32 v80, v80
    v_exp_f32 v81, v81
    v_mfma_f32_32x32x16_bf16 v[56:71], v[88:91], v[32:35], v[56:71]
    v_exp_f32 v82, v82
    v_exp_f32 v83, v83
    v_exp_f32 v84, v84
    v_exp_f32 v85, v85
    v_smfmac_f32_32x32x32_bf16 v[164:179], v[94:97], v[72:79], v1
    v_exp_f32 v86, v86
    v_exp_f32 v87, v87
    v_exp_f32 v56, v56
    v_exp_f32 v57, v57
    v_smfmac_f32_32x32x32_bf16 v[164:179], v[98:101], v[80:87], v1
    v_exp_f32 v58, v58
    v_exp_f32 v59, v59
    v_exp_f32 v60, v60
    v_mfma_f32_32x32x8_bf16 v[72:87], v[92:93], v[42:43], 0
    v_exp_f32 v61, v61
    v_exp_f32 v62, v62
    v_exp_f32 v63, v63
    v_exp_f32 v64, v64
    v_exp_f32 v65, v65
    v_mfma_f32_32x32x16_bf16 v[72:87], v[88:91], v[38:41], v[72:87]
    v_exp_f32 v66, v66
    v_exp_f32 v67, v67
    v_exp_f32 v68, v68
    ds_read_b32 v7, v5 offset:16
    v_exp_f32 v69, v69
    v_smfmac_f32_32x32x32_bf16 v[180:195], v[94:97], v[56:63], v1
    v_exp_f32 v70, v70
    v_exp_f32 v71, v71
    v_exp_f32 v72, v72
    v_exp_f32 v73, v73
    v_smfmac_f32_32x32x32_bf16 v[180:195], v[98:101], v[64:71], v1
    v_exp_f32 v74, v74
    v_exp_f32 v75, v75
    v_exp_f32 v76, v76
    v_mfma_f32_32x32x8_bf16 v[56:71], v[92:93], v[48:49], 0
    v_exp_f32 v77, v77
    v_exp_f32 v78, v78
    v_exp_f32 v79, v79
    v_exp_f32 v80, v80
    s_waitcnt vmcnt(0) lgkmcnt(0)
    v_exp_f32 v81, v81
    v_mfma_f32_32x32x16_bf16 v[56:71], v[88:91], v[44:47], v[56:71]
    v_exp_f32 v82, v82
    v_readfirstlane_b32 s94, v7
    s_add_u32 s64, s64, 1
    v_exp_f32 v83, v83
    s_cmp_lt_u32 s94, s64
    s_cbranch_scc1 L_att_land0
L_att_landed0:
    v_exp_f32 v84, v84
    v_exp_f32 v85, v85
    v_smfmac_f32_32x32x32_bf16 v[196:211], v[94:97], v[72:79], v1
    v_exp_f32 v86, v86
    v_exp_f32 v87, v87
    v_exp_f32 v56, v56
    v_exp_f32 v57, v57
    v_smfmac_f32_32x32x32_bf16 v[196:211], v[98:101], v[80:87], v1
    v_exp_f32 v58, v58
    v_exp_f32 v59, v59
    v_exp_f32 v60, v60
    v_mfma_f32_32x32x8_bf16 v[72:87], v[92:93], v[54:55], 0
    v_exp_f32 v61, v61
    v_exp_f32 v62, v62
    v_exp_f32 v63, v63
    v_exp_f32 v64, v64
    v_exp_f32 v65, v65
    v_mfma_f32_32x32x16_bf16 v[72:87], v[88:91], v[50:53], v[72:87]
    v_exp_f32 v66, v66
    v_exp_f32 v67, v67
    v_exp_f32 v68, v68
    v_exp_f32 v69, v69
    v_smfmac_f32_32x32x32_bf16 v[212:227], v[94:97], v[56:63], v1
    v_exp_f32 v70, v70
    v_exp_f32 v71, v71
    v_exp_f32 v72, v72
    v_exp_f32 v73, v73
    v_smfmac_f32_32x32x32_bf16 v[212:227], v[98:101], v[64:71], v1
    v_exp_f32 v74, v74
    v_exp_f32 v75, v75
    v_exp_f32 v76, v76
    v_mfma_f32_32x32x8_bf16 v[56:71], v[106:107], v[12:13], 0
    v_exp_f32 v77, v77
    v_exp_f32 v78, v78
    v_exp_f32 v79, v79
    v_exp_f32 v80, v80
    v_exp_f32 v81, v81
    v_mfma_f32_32x32x16_bf16 v[56:71], v[102:105], v[8:11], v[56:71]
    v_exp_f32 v82, v82
    v_exp_f32 v83, v83
    v_exp_f32 v84, v84
    v_exp_f32 v85, v85
    v_smfmac_f32_32x32x32_bf16 v[228:243], v[94:97], v[72:79], v1
    v_exp_f32 v86, v86
    v_exp_f32 v87, v87
    v_exp_f32 v56, v56
    v_exp_f32 v57, v57
    v_smfmac_f32_32x32x32_bf16 v[228:243], v[98:101], v[80:87], v1
    v_exp_f32 v58, v58
    v_exp_f32 v59, v59
    v_exp_f32 v60, v60
    v_mfma_f32_32x32x8_bf16 v[72:87], v[106:107], v[18:19], 0
    v_exp_f32 v61, v61
    v_exp_f32 v62, v62
    v_exp_f32 v63, v63
    v_exp_f32 v64, v64
    v_exp_f32 v65, v65
    v_mfma_f32_32x32x16_bf16 v[72:87], v[102:105], v[14:17], v[72:87]
    v_exp_f32 v66, v66
    v_exp_f32 v67, v67
    v_exp_f32 v68, v68
    v_exp_f32 v69, v69
    v_smfmac_f32_32x32x32_bf16 v[116:131], v[108:111], v[56:63], v1
    v_exp_f32 v70, v70
    v_exp_f32 v71, v71
    v_exp_f32 v72, v72
    v_exp_f32 v73, v73
    v_smfmac_f32_32x32x32_bf16 v[116:131], v[112:115], v[64:71], v1
    v_exp_f32 v74, v74
    v_exp_f32 v75, v75
    v_exp_f32 v76, v76
    v_mfma_f32_32x32x8_bf16 v[56:71], v[106:107], v[24:25], 0
    v_exp_f32 v77, v77
    v_exp_f32 v78, v78
    v_exp_f32 v79, v79
    v_exp_f32 v80, v80
    v_exp_f32 v81, v81
    v_mfma_f32_32x32x16_bf16 v[56:71], v[102:105], v[20:23], v[56:71]
    v_exp_f32 v82, v82
    v_exp_f32 v83, v83
    v_exp_f32 v84, v84
    v_exp_f32 v85, v85
    v_smfmac_f32_32x32x32_bf16 v[132:147], v[108:111], v[72:79], v1
    ds_read_b128 v[88:91], v2 offset:20480
    ds_read_b32 v92, v3 offset:21504
    s_mov_b64 exec, s[90:91]
    ds_read_b128 v[94:97], v4 offset:21760
    ds_read_b128 v[98:101], v4 offset:22400
    s_mov_b64 exec, -1
    v_exp_f32 v86, v86
    v_exp_f32 v87, v87
    v_exp_f32 v56, v56
    v_exp_f32 v57, v57
    v_smfmac_f32_32x32x32_bf16 v[132:147], v[112:115], v[80:87], v1
    v_exp_f32 v58, v58
    v_exp_f32 v59, v59
    v_exp_f32 v60, v60
    v_mfma_f32_32x32x8_bf16 v[72:87], v[106:107], v[30:31], 0
    v_exp_f32 v61, v61
    v_exp_f32 v62, v62
    v_exp_f32 v63, v63
    v_exp_f32 v64, v64
    v_exp_f32 v65, v65
    v_mfma_f32_32x32x16_bf16 v[72:87], v[102:105], v[26:29], v[72:87]
    v_exp_f32 v66, v66
    v_exp_f32 v67, v67
    v_exp_f32 v68, v68
    v_exp_f32 v69, v69
    v_smfmac_f32_32x32x32_bf16 v[148:163], v[108:111], v[56:63], v1
    v_exp_f32 v70, v70
    v_exp_f32 v71, v71
    v_exp_f32 v72, v72
    v_exp_f32 v73, v73
    v_smfmac_f32_32x32x32_bf16 v[148:163], v[112:115], v[64:71], v1
    v_exp_f32 v74, v74
    v_exp_f32 v75, v75
    v_exp_f32 v76, v76
    v_mfma_f32_32x32x8_bf16 v[56:71], v[106:107], v[36:37], 0
    v_exp_f32 v77, v77
    v_exp_f32 v78, v78
    v_exp_f32 v79, v79
    v_exp_f32 v80, v80
    v_exp_f32 v81, v81
    v_mfma_f32_32x32x16_bf16 v[56:71], v[102:105], v[32:35], v[56:71]
    v_exp_f32 v82, v82
    v_exp_f32 v83, v83
    v_exp_f32 v84, v84
    v_exp_f32 v85, v85
    v_smfmac_f32_32x32x32_bf16 v[164:179], v[108:111], v[72:79], v1
    v_exp_f32 v86, v86
    v_exp_f32 v87, v87
    v_exp_f32 v56, v56
    v_exp_f32 v57, v57
    v_smfmac_f32_32x32x32_bf16 v[164:179], v[112:115], v[80:87], v1
    v_exp_f32 v58, v58
    v_exp_f32 v59, v59
    v_exp_f32 v60, v60
    v_mfma_f32_32x32x8_bf16 v[72:87], v[106:107], v[42:43], 0
    v_exp_f32 v61, v61
    v_exp_f32 v62, v62
    v_exp_f32 v63, v63
    v_exp_f32 v64, v64
    v_exp_f32 v65, v65
    v_mfma_f32_32x32x16_bf16 v[72:87], v[102:105], v[38:41], v[72:87]
    v_exp_f32 v66, v66
    v_exp_f32 v67, v67
    v_exp_f32 v68, v68
    v_exp_f32 v69, v69
    v_smfmac_f32_32x32x32_bf16 v[180:195], v[108:111], v[56:63], v1
    v_exp_f32 v70, v70
    v_exp_f32 v71, v71
    v_exp_f32 v72, v72
    v_exp_f32 v73, v73
    v_smfmac_f32_32x32x32_bf16 v[180:195], v[112:115], v[64:71], v1
    v_exp_f32 v74, v74
    v_exp_f32 v75, v75
    v_exp_f32 v76, v76
    v_mfma_f32_32x32x8_bf16 v[56:71], v[106:107], v[48:49], 0
    v_exp_f32 v77, v77
    v_exp_f32 v78, v78
    v_exp_f32 v79, v79
    v_exp_f32 v80, v80
    s_waitcnt vmcnt(0) lgkmcnt(0)
    v_exp_f32 v81, v81
    v_mfma_f32_32x32x16_bf16 v[56:71], v[102:105], v[44:47], v[56:71]
    v_exp_f32 v82, v82
    v_exp_f32 v83, v83
    v_exp_f32 v84, v84
    v_exp_f32 v85, v85
    v_smfmac_f32_32x32x32_bf16 v[196:211], v[108:111], v[72:79], v1
    v_exp_f32 v86, v86
    v_exp_f32 v87, v87
    v_exp_f32 v56, v56
    v_exp_f32 v57, v57
    v_smfmac_f32_32x32x32_bf16 v[196:211], v[112:115], v[80:87], v1
    v_exp_f32 v58, v58
    v_exp_f32 v59, v59
    v_exp_f32 v60, v60
    v_mfma_f32_32x32x8_bf16 v[72:87], v[106:107], v[54:55], 0
    v_exp_f32 v61, v61
    v_exp_f32 v62, v62
    v_exp_f32 v63, v63
    v_exp_f32 v64, v64
    v_exp_f32 v65, v65
    v_mfma_f32_32x32x16_bf16 v[72:87], v[102:105], v[50:53], v[72:87]
    v_exp_f32 v66, v66
    v_exp_f32 v67, v67
    v_exp_f32 v68, v68
    v_exp_f32 v69, v69
    v_smfmac_f32_32x32x32_bf16 v[212:227], v[108:111], v[56:63], v1
    v_exp_f32 v70, v70
    v_exp_f32 v71, v71
    v_exp_f32 v72, v72
    v_exp_f32 v73, v73
    v_smfmac_f32_32x32x32_bf16 v[212:227], v[112:115], v[64:71], v1
    v_exp_f32 v74, v74
    v_exp_f32 v75, v75
    v_exp_f32 v76, v76
    v_mfma_f32_32x32x8_bf16 v[56:71], v[92:93], v[12:13], 0
    v_exp_f32 v77, v77
    v_exp_f32 v78, v78
    v_exp_f32 v79, v79
    v_exp_f32 v80, v80
    v_exp_f32 v81, v81
    v_mfma_f32_32x32x16_bf16 v[56:71], v[88:91], v[8:11], v[56:71]
    v_exp_f32 v82, v82
    v_exp_f32 v83, v83
    v_exp_f32 v84, v84
    v_exp_f32 v85, v85
    v_smfmac_f32_32x32x32_bf16 v[228:243], v[108:111], v[72:79], v1
    v_exp_f32 v86, v86
    v_exp_f32 v87, v87
    v_exp_f32 v56, v56
    v_exp_f32 v57, v57
    v_smfmac_f32_32x32x32_bf16 v[228:243], v[112:115], v[80:87], v1
    v_exp_f32 v58, v58
    v_exp_f32 v59, v59
    v_exp_f32 v60, v60
    v_mfma_f32_32x32x8_bf16 v[72:87], v[92:93], v[18:19], 0
    v_exp_f32 v61, v61
    v_exp_f32 v62, v62
    v_exp_f32 v63, v63
    v_exp_f32 v64, v64
    v_exp_f32 v65, v65
    v_mfma_f32_32x32x16_bf16 v[72:87], v[88:91], v[14:17], v[72:87]
    v_exp_f32 v66, v66
    v_exp_f32 v67, v67
    v_exp_f32 v68, v68
    v_exp_f32 v69, v69
    v_smfmac_f32_32x32x32_bf16 v[116:131], v[94:97], v[56:63], v1
    v_exp_f32 v70, v70
    v_exp_f32 v71, v71
    v_exp_f32 v72, v72
    v_exp_f32 v73, v73
    v_smfmac_f32_32x32x32_bf16 v[116:131], v[98:101], v[64:71], v1
    v_exp_f32 v74, v74
    v_exp_f32 v75, v75
    v_exp_f32 v76, v76
    v_mfma_f32_32x32x8_bf16 v[56:71], v[92:93], v[24:25], 0
    v_exp_f32 v77, v77
    v_exp_f32 v78, v78
    v_exp_f32 v79, v79
    v_exp_f32 v80, v80
    v_exp_f32 v81, v81
    v_mfma_f32_32x32x16_bf16 v[56:71], v[88:91], v[20:23], v[56:71]
    v_exp_f32 v82, v82
    v_exp_f32 v83, v83
    v_exp_f32 v84, v84
    v_exp_f32 v85, v85
    v_smfmac_f32_32x32x32_bf16 v[132:147], v[94:97], v[72:79], v1
    ds_read_b128 v[102:105], v2 offset:23040
    ds_read_b32 v106, v3 offset:24064
    s_mov_b64 exec, s[90:91]
    ds_read_b128 v[108:111], v4 offset:24320
    ds_read_b128 v[112:115], v4 offset:24960
    s_mov_b64 exec, -1
    v_exp_f32 v86, v86
    v_exp_f32 v87, v87
    v_exp_f32 v56, v56
    v_exp_f32 v57, v57
    v_smfmac_f32_32x32x32_bf16 v[132:147], v[98:101], v[80:87], v1
    v_exp_f32 v58, v58
    v_exp_f32 v59, v59
    v_exp_f32 v60, v60
    v_mfma_f32_32x32x8_bf16 v[72:87], v[92:93], v[30:31], 0
    v_exp_f32 v61, v61
    v_exp_f32 v62, v62
    v_exp_f32 v63, v63
    v_exp_f32 v64, v64
    v_exp_f32 v65, v65
    v_mfma_f32_32x32x16_bf16 v[72:87], v[88:91], v[26:29], v[72:87]
    v_exp_f32 v66, v66
    v_exp_f32 v67, v67
    v_exp_f32 v68, v68
    v_exp_f32 v69, v69
    v_smfmac_f32_32x32x32_bf16 v[148:163], v[94:97], v[56:63], v1
    v_exp_f32 v70, v70
    v_exp_f32 v71, v71
    v_exp_f32 v72, v72
    v_exp_f32 v73, v73
    v_smfmac_f32_32x32x32_bf16 v[148:163], v[98:101], v[64:71], v1
    v_exp_f32 v74, v74
    v_add_u32 v2, s70, v2
    v_exp_f32 v75, v75
    v_exp_f32 v76, v76
    v_mfma_f32_32x32x8_bf16 v[56:71], v[92:93], v[36:37], 0
    v_exp_f32 v77, v77
    v_exp_f32 v78, v78
    v_add_u32 v3, s70, v3
    v_exp_f32 v79, v79
    v_exp_f32 v80, v80
    v_exp_f32 v81, v81
    v_mfma_f32_32x32x16_bf16 v[56:71], v[88:91], v[32:35], v[56:71]
    v_exp_f32 v82, v82
    v_add_u32 v4, s70, v4
    v_exp_f32 v83, v83
    v_exp_f32 v84, v84
    s_mov_b32 s70, 40960
    v_exp_f32 v85, v85
    v_smfmac_f32_32x32x32_bf16 v[164:179], v[94:97], v[72:79], v1
    v_exp_f32 v86, v86
    v_exp_f32 v87, v87
    v_exp_f32 v56, v56
    v_exp_f32 v57, v57
    v_smfmac_f32_32x32x32_bf16 v[164:179], v[98:101], v[80:87], v1
    v_exp_f32 v58, v58
    v_exp_f32 v59, v59
    v_exp_f32 v60, v60
    v_mfma_f32_32x32x8_bf16 v[72:87], v[92:93], v[42:43], 0
    v_exp_f32 v61, v61
    v_exp_f32 v62, v62
    v_exp_f32 v63, v63
    v_exp_f32 v64, v64
    v_exp_f32 v65, v65
    v_mfma_f32_32x32x16_bf16 v[72:87], v[88:91], v[38:41], v[72:87]
    v_exp_f32 v66, v66
    v_exp_f32 v67, v67
    v_exp_f32 v68, v68
    ds_read_b32 v7, v5 offset:16
    v_exp_f32 v69, v69
    v_smfmac_f32_32x32x32_bf16 v[180:195], v[94:97], v[56:63], v1
    v_exp_f32 v70, v70
    v_exp_f32 v71, v71
    v_exp_f32 v72, v72
    v_exp_f32 v73, v73
    v_smfmac_f32_32x32x32_bf16 v[180:195], v[98:101], v[64:71], v1
    v_exp_f32 v74, v74
    v_exp_f32 v75, v75
    v_exp_f32 v76, v76
    v_mfma_f32_32x32x8_bf16 v[56:71], v[92:93], v[48:49], 0
    v_exp_f32 v77, v77
    v_exp_f32 v78, v78
    v_exp_f32 v79, v79
    v_exp_f32 v80, v80
    s_waitcnt vmcnt(0) lgkmcnt(0)
    v_exp_f32 v81, v81
    v_mfma_f32_32x32x16_bf16 v[56:71], v[88:91], v[44:47], v[56:71]
    v_exp_f32 v82, v82
    v_readfirstlane_b32 s94, v7
    s_add_u32 s64, s64, 1
    v_exp_f32 v83, v83
    s_cmp_lt_u32 s94, s64
    s_cbranch_scc1 L_att_land2
L_att_landed2:
    v_exp_f32 v84, v84
    ds_write_b32 v5, v2
    v_exp_f32 v85, v85
    v_smfmac_f32_32x32x32_bf16 v[196:211], v[94:97], v[72:79], v1
    v_exp_f32 v86, v86
    v_exp_f32 v87, v87
    v_exp_f32 v56, v56
    v_exp_f32 v57, v57
    v_smfmac_f32_32x32x32_bf16 v[196:211], v[98:101], v[80:87], v1
    v_exp_f32 v58, v58
    v_exp_f32 v59, v59
    v_exp_f32 v60, v60
    v_mfma_f32_32x32x8_bf16 v[72:87], v[92:93], v[54:55], 0
    v_exp_f32 v61, v61
    v_exp_f32 v62, v62
    v_exp_f32 v63, v63
    v_exp_f32 v64, v64
    v_exp_f32 v65, v65
    v_mfma_f32_32x32x16_bf16 v[72:87], v[88:91], v[50:53], v[72:87]
    v_exp_f32 v66, v66
    v_exp_f32 v67, v67
    v_exp_f32 v68, v68
    v_exp_f32 v69, v69
    v_smfmac_f32_32x32x32_bf16 v[212:227], v[94:97], v[56:63], v1
    v_exp_f32 v70, v70
    v_exp_f32 v71, v71
    v_exp_f32 v72, v72
    v_exp_f32 v73, v73
    v_smfmac_f32_32x32x32_bf16 v[212:227], v[98:101], v[64:71], v1
    v_exp_f32 v74, v74
    v_exp_f32 v75, v75
    v_exp_f32 v76, v76
    v_mfma_f32_32x32x8_bf16 v[56:71], v[106:107], v[12:13], 0
    v_exp_f32 v77, v77
    v_exp_f32 v78, v78
    v_exp_f32 v79, v79
    v_exp_f32 v80, v80
    v_exp_f32 v81, v81
    v_mfma_f32_32x32x16_bf16 v[56:71], v[102:105], v[8:11], v[56:71]
    v_exp_f32 v82, v82
    v_exp_f32 v83, v83
    v_exp_f32 v84, v84
    v_exp_f32 v85, v85
    v_smfmac_f32_32x32x32_bf16 v[228:243], v[94:97], v[72:79], v1
    v_exp_f32 v86, v86
    v_exp_f32 v87, v87
    s_cmp_eq_u32 s65, 0
    s_cbranch_scc1 L_att_last
    v_exp_f32 v56, v56
    v_exp_f32 v57, v57
    v_smfmac_f32_32x32x32_bf16 v[228:243], v[98:101], v[80:87], v1
    v_exp_f32 v58, v58
    v_exp_f32 v59, v59
    v_exp_f32 v60, v60
    v_mfma_f32_32x32x8_bf16 v[72:87], v[106:107], v[18:19], 0
    v_exp_f32 v61, v61
    v_exp_f32 v62, v62
    v_exp_f32 v63, v63
    v_exp_f32 v64, v64
    v_exp_f32 v65, v65
    v_mfma_f32_32x32x16_bf16 v[72:87], v[102:105], v[14:17], v[72:87]
    v_exp_f32 v66, v66
    v_exp_f32 v67, v67
    v_exp_f32 v68, v68
    v_exp_f32 v69, v69
    v_smfmac_f32_32x32x32_bf16 v[116:131], v[108:111], v[56:63], v1
    v_exp_f32 v70, v70
    v_exp_f32 v71, v71
    v_exp_f32 v72, v72
    v_exp_f32 v73, v73
    v_smfmac_f32_32x32x32_bf16 v[116:131], v[112:115], v[64:71], v1
    v_exp_f32 v74, v74
    v_exp_f32 v75, v75
    v_exp_f32 v76, v76
    v_mfma_f32_32x32x8_bf16 v[56:71], v[106:107], v[24:25], 0
    v_exp_f32 v77, v77
    v_exp_f32 v78, v78
    v_exp_f32 v79, v79
    v_exp_f32 v80, v80
    v_exp_f32 v81, v81
    v_mfma_f32_32x32x16_bf16 v[56:71], v[102:105], v[20:23], v[56:71]
    v_exp_f32 v82, v82
    v_exp_f32 v83, v83
    v_exp_f32 v84, v84
    v_exp_f32 v85, v85
    v_smfmac_f32_32x32x32_bf16 v[132:147], v[108:111], v[72:79], v1
    ds_read_b128 v[88:91], v2 offset:0
    ds_read_b32 v92, v3 offset:1024
    s_mov_b64 exec, s[90:91]
    ds_read_b128 v[94:97], v4 offset:1280
    ds_read_b128 v[98:101], v4 offset:1920
    s_mov_b64 exec, -1
    v_exp_f32 v86, v86
    v_exp_f32 v87, v87
    v_exp_f32 v56, v56
    v_exp_f32 v57, v57
    v_smfmac_f32_32x32x32_bf16 v[132:147], v[112:115], v[80:87], v1
    v_exp_f32 v58, v58
    v_exp_f32 v59, v59
    v_exp_f32 v60, v60
    v_mfma_f32_32x32x8_bf16 v[72:87], v[106:107], v[30:31], 0
    v_exp_f32 v61, v61
    v_exp_f32 v62, v62
    v_exp_f32 v63, v63
    v_exp_f32 v64, v64
    v_exp_f32 v65, v65
    v_mfma_f32_32x32x16_bf16 v[72:87], v[102:105], v[26:29], v[72:87]
    v_exp_f32 v66, v66
    v_exp_f32 v67, v67
    v_exp_f32 v68, v68
    v_exp_f32 v69, v69
    v_smfmac_f32_32x32x32_bf16 v[148:163], v[108:111], v[56:63], v1
    v_exp_f32 v70, v70
    v_exp_f32 v71, v71
    v_exp_f32 v72, v72
    v_exp_f32 v73, v73
    v_smfmac_f32_32x32x32_bf16 v[148:163], v[112:115], v[64:71], v1
    v_exp_f32 v74, v74
    v_exp_f32 v75, v75
    v_exp_f32 v76, v76
    v_mfma_f32_32x32x8_bf16 v[56:71], v[106:107], v[36:37], 0
    v_exp_f32 v77, v77
    v_exp_f32 v78, v78
    v_exp_f32 v79, v79
    v_exp_f32 v80, v80
    v_exp_f32 v81, v81
    v_mfma_f32_32x32x16_bf16 v[56:71], v[102:105], v[32:35], v[56:71]
    v_exp_f32 v82, v82
    v_exp_f32 v83, v83
    v_exp_f32 v84, v84
    v_exp_f32 v85, v85
    v_smfmac_f32_32x32x32_bf16 v[164:179], v[108:111], v[72:79], v1
    v_exp_f32 v86, v86
    v_exp_f32 v87, v87
    v_exp_f32 v56, v56
    v_exp_f32 v57, v57
    v_smfmac_f32_32x32x32_bf16 v[164:179], v[112:115], v[80:87], v1
    v_exp_f32 v58, v58
    v_exp_f32 v59, v59
    v_exp_f32 v60, v60
    v_mfma_f32_32x32x8_bf16 v[72:87], v[106:107], v[42:43], 0
    v_exp_f32 v61, v61
    v_exp_f32 v62, v62
    v_exp_f32 v63, v63
    v_exp_f32 v64, v64
    v_exp_f32 v65, v65
    v_mfma_f32_32x32x16_bf16 v[72:87], v[102:105], v[38:41], v[72:87]
    v_exp_f32 v66, v66
    v_exp_f32 v67, v67
    v_exp_f32 v68, v68
    v_exp_f32 v69, v69
    v_smfmac_f32_32x32x32_bf16 v[180:195], v[108:111], v[56:63], v1
    v_exp_f32 v70, v70
    v_exp_f32 v71, v71
    v_exp_f32 v72, v72
    v_exp_f32 v73, v73
    v_smfmac_f32_32x32x32_bf16 v[180:195], v[112:115], v[64:71], v1
    v_exp_f32 v74, v74
    v_exp_f32 v75, v75
    v_exp_f32 v76, v76
    v_mfma_f32_32x32x8_bf16 v[56:71], v[106:107], v[48:49], 0
    v_exp_f32 v77, v77
    v_exp_f32 v78, v78
    v_exp_f32 v79, v79
    v_exp_f32 v80, v80
    s_waitcnt vmcnt(0) lgkmcnt(0)
    v_exp_f32 v81, v81
    v_mfma_f32_32x32x16_bf16 v[56:71], v[102:105], v[44:47], v[56:71]
    v_exp_f32 v82, v82
    v_exp_f32 v83, v83
    v_exp_f32 v84, v84
    v_exp_f32 v85, v85
    v_smfmac_f32_32x32x32_bf16 v[196:211], v[108:111], v[72:79], v1
    v_exp_f32 v86, v86
    v_exp_f32 v87, v87
    v_exp_f32 v56, v56
    v_exp_f32 v57, v57
    v_smfmac_f32_32x32x32_bf16 v[196:211], v[112:115], v[80:87], v1
    v_exp_f32 v58, v58
    v_exp_f32 v59, v59
    v_exp_f32 v60, v60
    v_mfma_f32_32x32x8_bf16 v[72:87], v[106:107], v[54:55], 0
    v_exp_f32 v61, v61
    v_exp_f32 v62, v62
    v_exp_f32 v63, v63
    v_exp_f32 v64, v64
    v_exp_f32 v65, v65
    v_mfma_f32_32x32x16_bf16 v[72:87], v[102:105], v[50:53], v[72:87]
    v_exp_f32 v66, v66
    v_exp_f32 v67, v67
    v_exp_f32 v68, v68
    v_exp_f32 v69, v69
    v_smfmac_f32_32x32x32_bf16 v[212:227], v[108:111], v[56:63], v1
    v_exp_f32 v70, v70
    v_exp_f32 v71, v71
    v_exp_f32 v72, v72
    v_exp_f32 v73, v73
    v_smfmac_f32_32x32x32_bf16 v[212:227], v[112:115], v[64:71], v1
    v_exp_f32 v74, v74
    v_exp_f32 v75, v75
    v_exp_f32 v76, v76
    v_mfma_f32_32x32x8_bf16 v[56:71], v[92:93], v[12:13], 0
    v_exp_f32 v77, v77
    v_exp_f32 v78, v78
    v_exp_f32 v79, v79
    v_exp_f32 v80, v80
    v_exp_f32 v81, v81
    v_mfma_f32_32x32x16_bf16 v[56:71], v[88:91], v[8:11], v[56:71]
    v_exp_f32 v82, v82
    v_exp_f32 v83, v83
    v_exp_f32 v84, v84
    v_exp_f32 v85, v85
    v_smfmac_f32_32x32x32_bf16 v[228:243], v[108:111], v[72:79], v1
    v_exp_f32 v86, v86
    v_exp_f32 v87, v87
    s_sub_u32 s65, s65, 1
    s_branch L_att_loop
L_att_land0:
    v_mov_b32 v6, s89
    s_mov_b32 s95, 0x400000
L_spin39:
    ds_read_b32 v7, v6
    s_waitcnt lgkmcnt(0)
    v_readfirstlane_b32 s94, v7
    s_nop 0
    s_cmp_ge_u32 s94, s64
    s_cbranch_scc1 L_spun39
    s_sub_u32 s95, s95, 1
    s_cbranch_scc0 L_spin39
L_spun39:
    s_branch L_att_landed0
L_att_land2:
    v_mov_b32 v6, s89
    s_mov_b32 s95, 0x400000
L_spin40:
    ds_read_b32 v7, v6
    s_waitcnt lgkmcnt(0)
    v_readfirstlane_b32 s94, v7
    s_nop 0
    s_cmp_ge_u32 s94, s64
    s_cbranch_scc1 L_spun40
    s_sub_u32 s95, s95, 1
    s_cbranch_scc0 L_spin40
L_spun40:
    s_branch L_att_landed2
L_att_last:
    v_mov_b32 v6, 161804
    v_mov_b32 v7, 1
    v_exp_f32 v56, v56
    v_exp_f32 v57, v57
    v_smfmac_f32_32x32x32_bf16 v[228:243], v[98:101], v[80:87], v1
    v_exp_f32 v58, v58
    v_exp_f32 v59, v59
    v_exp_f32 v60, v60
    v_mfma_f32_32x32x8_bf16 v[72:87], v[106:107], v[18:19], 0
    v_exp_f32 v61, v61
    v_exp_f32 v62, v62
    v_exp_f32 v63, v63
    v_exp_f32 v64, v64
    v_exp_f32 v65, v65
    v_mfma_f32_32x32x16_bf16 v[72:87], v[102:105], v[14:17], v[72:87]
    v_exp_f32 v66, v66
    v_exp_f32 v67, v67
    v_exp_f32 v68, v68
    v_exp_f32 v69, v69
    v_smfmac_f32_32x32x32_bf16 v[116:131], v[108:111], v[56:63], v1
    v_exp_f32 v70, v70
    v_exp_f32 v71, v71
    v_exp_f32 v72, v72
    v_exp_f32 v73, v73
    v_smfmac_f32_32x32x32_bf16 v[116:131], v[112:115], v[64:71], v1
    v_exp_f32 v74, v74
    v_exp_f32 v75, v75
    v_exp_f32 v76, v76
    v_mfma_f32_32x32x8_bf16 v[56:71], v[106:107], v[24:25], 0
    v_exp_f32 v77, v77
    v_exp_f32 v78, v78
    v_exp_f32 v79, v79
    v_exp_f32 v80, v80
    v_exp_f32 v81, v81
    v_mfma_f32_32x32x16_bf16 v[56:71], v[102:105], v[20:23], v[56:71]
    ds_write_b128 v244, v[116:119] offset:0
    ds_write_b128 v244, v[120:123] offset:1024
    ds_write_b96 v244, v[124:126] offset:2048
    v_exp_f32 v82, v82
    v_exp_f32 v83, v83
    v_exp_f32 v84, v84
    v_exp_f32 v85, v85
    v_smfmac_f32_32x32x32_bf16 v[132:147], v[108:111], v[72:79], v1
    v_exp_f32 v86, v86
    v_exp_f32 v87, v87
    v_exp_f32 v56, v56
    v_exp_f32 v57, v57
    v_smfmac_f32_32x32x32_bf16 v[132:147], v[112:115], v[80:87], v1
    v_exp_f32 v58, v58
    v_exp_f32 v59, v59
    v_exp_f32 v60, v60
    v_mfma_f32_32x32x8_bf16 v[72:87], v[106:107], v[30:31], 0
    v_exp_f32 v61, v61
    v_exp_f32 v62, v62
    v_exp_f32 v63, v63
    v_exp_f32 v64, v64
    v_exp_f32 v65, v65
    v_mfma_f32_32x32x16_bf16 v[72:87], v[102:105], v[26:29], v[72:87]
    ds_write_b128 v244, v[132:135] offset:3072
    ds_write_b128 v244, v[136:139] offset:4096
    ds_write_b96 v244, v[140:142] offset:20480
    v_exp_f32 v66, v66
    v_exp_f32 v67, v67
    v_exp_f32 v68, v68
    v_exp_f32 v69, v69
    v_smfmac_f32_32x32x32_bf16 v[148:163], v[108:111], v[56:63], v1
    v_exp_f32 v70, v70
    v_exp_f32 v71, v71
    v_exp_f32 v72, v72
    v_exp_f32 v73, v73
    v_smfmac_f32_32x32x32_bf16 v[148:163], v[112:115], v[64:71], v1
    v_exp_f32 v74, v74
    v_exp_f32 v75, v75
    v_exp_f32 v76, v76
    v_mfma_f32_32x32x8_bf16 v[56:71], v[106:107], v[36:37], 0
    v_exp_f32 v77, v77
    v_exp_f32 v78, v78
    v_exp_f32 v79, v79
    v_exp_f32 v80, v80
    v_exp_f32 v81, v81
    v_mfma_f32_32x32x16_bf16 v[56:71], v[102:105], v[32:35], v[56:71]
    ds_write_b128 v244, v[148:151] offset:21504
    ds_write_b128 v244, v[152:155] offset:22528
    ds_write_b96 v244, v[156:158] offset:23552
    v_exp_f32 v82, v82
    v_exp_f32 v83, v83
    v_exp_f32 v84, v84
    v_exp_f32 v85, v85
    v_smfmac_f32_32x32x32_bf16 v[164:179], v[108:111], v[72:79], v1
    v_exp_f32 v86, v86
    v_exp_f32 v87, v87
    v_exp_f32 v56, v56
    v_exp_f32 v57, v57
    v_smfmac_f32_32x32x32_bf16 v[164:179], v[112:115], v[80:87], v1
    v_exp_f32 v58, v58
    v_exp_f32 v59, v59
    v_exp_f32 v60, v60
    v_mfma_f32_32x32x8_bf16 v[72:87], v[106:107], v[42:43], 0
    v_exp_f32 v61, v61
    v_exp_f32 v62, v62
    v_exp_f32 v63, v63
    v_exp_f32 v64, v64
    v_exp_f32 v65, v65
    v_mfma_f32_32x32x16_bf16 v[72:87], v[102:105], v[38:41], v[72:87]
    ds_write_b128 v244, v[164:167] offset:24576
    ds_write_b128 v244, v[168:171] offset:40960
    ds_write_b96 v244, v[172:174] offset:41984
    v_exp_f32 v66, v66
    v_exp_f32 v67, v67
    v_exp_f32 v68, v68
    v_exp_f32 v69, v69
    v_smfmac_f32_32x32x32_bf16 v[180:195], v[108:111], v[56:63], v1
    v_exp_f32 v70, v70
    v_exp_f32 v71, v71
    v_exp_f32 v72, v72
    v_exp_f32 v73, v73
    v_smfmac_f32_32x32x32_bf16 v[180:195], v[112:115], v[64:71], v1
    v_exp_f32 v74, v74
    v_exp_f32 v75, v75
    v_exp_f32 v76, v76
    v_mfma_f32_32x32x8_bf16 v[56:71], v[106:107], v[48:49], 0
    v_exp_f32 v77, v77
    v_exp_f32 v78, v78
    v_exp_f32 v79, v79
    v_exp_f32 v80, v80
    v_exp_f32 v81, v81
    v_mfma_f32_32x32x16_bf16 v[56:71], v[102:105], v[44:47], v[56:71]
    ds_write_b128 v244, v[180:183] offset:43008
    ds_write_b128 v244, v[184:187] offset:44032
    ds_write_b96 v244, v[188:190] offset:45056
    v_exp_f32 v82, v82
    v_exp_f32 v83, v83
    v_exp_f32 v84, v84
    v_exp_f32 v85, v85
    v_smfmac_f32_32x32x32_bf16 v[196:211], v[108:111], v[72:79], v1
    v_exp_f32 v86, v86
    v_exp_f32 v87, v87
    v_exp_f32 v56, v56
    v_exp_f32 v57, v57
    v_smfmac_f32_32x32x32_bf16 v[196:211], v[112:115], v[80:87], v1
    v_exp_f32 v58, v58
    v_exp_f32 v59, v59
    v_exp_f32 v60, v60
    v_mfma_f32_32x32x8_bf16 v[72:87], v[106:107], v[54:55], 0
    v_exp_f32 v61, v61
    v_exp_f32 v62, v62
    v_exp_f32 v63, v63
    v_exp_f32 v64, v64
    v_exp_f32 v65, v65
    v_mfma_f32_32x32x16_bf16 v[72:87], v[102:105], v[50:53], v[72:87]
    ds_write_b128 v244, v[196:199] offset:61440
    ds_write_b128 v244, v[200:203] offset:62464
    ds_write_b96 v244, v[204:206] offset:63488
    v_exp_f32 v66, v66
    v_exp_f32 v67, v67
    v_exp_f32 v68, v68
    v_exp_f32 v69, v69
    v_smfmac_f32_32x32x32_bf16 v[212:227], v[108:111], v[56:63], v1
    v_exp_f32 v70, v70
    v_exp_f32 v71, v71
    v_exp_f32 v72, v72
    v_exp_f32 v73, v73
    v_smfmac_f32_32x32x32_bf16 v[212:227], v[112:115], v[64:71], v1
    v_exp_f32 v74, v74
    v_exp_f32 v75, v75
    s_waitcnt lgkmcnt(0)
    s_mov_b64 exec, 1
    ds_add_u32 v6, v7
    s_mov_b64 exec, -1
    v_exp_f32 v76, v76
    v_exp_f32 v77, v77
    v_exp_f32 v78, v78
    v_exp_f32 v79, v79
    v_exp_f32 v80, v80
    v_exp_f32 v81, v81
    v_exp_f32 v82, v82
    ds_read_b32 v7, v6
    v_exp_f32 v83, v83
    v_exp_f32 v84, v84
    v_exp_f32 v85, v85
    v_smfmac_f32_32x32x32_bf16 v[228:243], v[108:111], v[72:79], v1
    v_exp_f32 v86, v86
    v_exp_f32 v87, v87
    s_setprio 3
    s_waitcnt lgkmcnt(0)
    v_smfmac_f32_32x32x32_bf16 v[228:243], v[112:115], v[80:87], v1
    v_readfirstlane_b32 s94, v7
    s_mov_b32 s70, 4
    s_cmp_ge_u32 s94, 4
    s_cbranch_scc1 L_att_all
L_att_red:
    v_mov_b32 v6, 161804
    s_mov_b32 s95, 0x400000
L_spin41:
    ds_read_b32 v7, v6
    s_waitcnt lgkmcnt(0)
    v_readfirstlane_b32 s94, v7
    s_nop 0
    s_cmp_ge_u32 s94, s70
    s_cbranch_scc1 L_spun41
    s_sub_u32 s95, s95, 1
    s_cbranch_scc0 L_spin41
L_spun41:
L_att_all:
    ds_read_b128 v[164:167], v247 offset:0
    ds_read_b128 v[168:171], v247 offset:1024
    ds_read_b128 v[172:175], v247 offset:2048
    ds_read_b128 v[176:179], v247 offset:3072
    ds_read_b128 v[180:183], v247 offset:4096
    ds_read_b128 v[184:187], v247 offset:20480
    ds_read_b128 v[140:143], v246 offset:21504
    ds_read_b128 v[144:147], v246 offset:22528
    ds_read_b128 v[148:151], v246 offset:23552
    ds_read_b128 v[152:155], v246 offset:24576
    ds_read_b128 v[156:159], v246 offset:40960
    ds_read_b128 v[160:163], v246 offset:41984
    ds_read_b128 v[116:119], v245 offset:43008
    ds_read_b128 v[120:123], v245 offset:44032
    ds_read_b128 v[124:127], v245 offset:45056
    ds_read_b128 v[128:131], v245 offset:61440
    ds_read_b128 v[132:135], v245 offset:62464
    ds_read_b128 v[136:139], v245 offset:63488
    v_cmp_ne_u32 vcc, s3, v249
    s_nop 0
    s_cmp_eq_u64 vcc, 0
    s_cbranch_scc1 L_ok42
    s_mov_b32 s95, 0x20000
L_poll43:
    buffer_load_dwordx2 v[248:249], v251, s[72:75], s76 offen offset:0 sc1
L_pollw43:
    s_waitcnt vmcnt(0)
    v_cmp_ne_u32 vcc, s3, v249
    s_nop 0
    s_cmp_eq_u64 vcc, 0
    s_cbranch_scc1 L_polled43
    s_sleep 2
    s_sub_u32 s95, s95, 1
    s_cbranch_scc0 L_poll43
L_polled43:
L_ok42:
    v_and_b32 v69, 0xffff0000, v248
    v_max_f32 v69, 0x2b800000, v69
    v_rcp_f32 v69, v69
    v_lshlrev_b32 v68, 16, v248
    v_mul_f32 v68, v68, v69
    s_waitcnt lgkmcnt(12)
    v_add_f32 v212, v212, v164
    v_add_f32 v213, v213, v165
    v_add_f32 v214, v214, v166
    v_add_f32 v215, v215, v167
    v_add_f32 v216, v216, v168
    v_add_f32 v217, v217, v169
    v_add_f32 v218, v218, v170
    v_add_f32 v219, v219, v171
    v_add_f32 v220, v220, v172
    v_add_f32 v221, v221, v173
    v_add_f32 v222, v222, v174
    v_add_f32 v228, v228, v176
    v_add_f32 v229, v229, v177
    v_add_f32 v230, v230, v178
    v_add_f32 v231, v231, v179
    v_add_f32 v232, v232, v180
    v_add_f32 v233, v233, v181
    v_add_f32 v234, v234, v182
    v_add_f32 v235, v235, v183
    v_add_f32 v236, v236, v184
    v_add_f32 v237, v237, v185
    v_add_f32 v238, v238, v186
    s_waitcnt lgkmcnt(6)
    v_add_f32 v212, v212, v140
    v_add_f32 v213, v213, v141
    v_add_f32 v214, v214, v142
    v_add_f32 v215, v215, v143
    v_add_f32 v216, v216, v144
    v_add_f32 v217, v217, v145
    v_add_f32 v218, v218, v146
    v_add_f32 v219, v219, v147
    v_add_f32 v220, v220, v148
    v_add_f32 v221, v221, v149
    v_add_f32 v222, v222, v150
    v_add_f32 v228, v228, v152
    v_add_f32 v229, v229, v153
    v_add_f32 v230, v230, v154
    v_add_f32 v231, v231, v155
    v_add_f32 v232, v232, v156
    v_add_f32 v233, v233, v157
    v_add_f32 v234, v234, v158
    v_add_f32 v235, v235, v159
    v_add_f32 v236, v236, v160
    v_add_f32 v237, v237, v161
    v_add_f32 v238, v238, v162
    s_waitcnt lgkmcnt(0)
    v_add_f32 v212, v212, v116
    v_add_f32 v213, v213, v117
    v_add_f32 v214, v214, v118
    v_add_f32 v215, v215, v119
    v_add_f32 v216, v216, v120
    v_add_f32 v217, v217, v121
    v_add_f32 v218, v218, v122
    v_add_f32 v219, v219, v123
    v_add_f32 v220, v220, v124
    v_add_f32 v221, v221, v125
    v_add_f32 v222, v222, v126
    v_add_f32 v228, v228, v128
    v_add_f32 v229, v229, v129
    v_add_f32 v230, v230, v130
    v_add_f32 v231, v231, v131
    v_add_f32 v232, v232, v132
    v_add_f32 v233, v233, v133
    v_add_f32 v234, v234, v134
    v_add_f32 v235, v235, v135
    v_add_f32 v236, v236, v136
    v_add_f32 v237, v237, v137
    v_add_f32 v238, v238, v138
    s_cmp_lg_u32 s39, 0
    s_cbranch_scc1 L_att_ok
    s_mov_b32 s66, 0x14800000
    s_mov_b32 s67, 0x67800000
    v_cmp_nle_f32 s[80:81], s66, v222
    v_cmp_nge_f32 s[82:83], s67, v222
    v_cmp_nle_f32 s[84:85], s66, v238
    v_cmp_nge_f32 s[86:87], s67, v238
    s_nop 1
    s_or_b64 s[80:81], s[80:81], s[82:83]
    s_or_b64 s[84:85], s[84:85], s[86:87]
    s_or_b64 s[80:81], s[80:81], s[84:85]
    s_cselect_b32 s36, 0x101, 1
    v_mov_b32 v6, 161808
    v_mov_b32 v7, s36
    s_mov_b64 exec, 1
    ds_add_u32 v6, v7
    s_mov_b64 exec, -1
L_att_ok:
    v_rcp_f32 v62, v222
    v_rcp_f32 v64, v238
    s_nop 0
    v_mul_f32 v62, v62, v68
    v_mul_f32 v64, v64, v68
    v_mul_f32 v212, v212, v62
    v_mul_f32 v213, v213, v62
    v_mul_f32 v214, v214, v62
    v_mul_f32 v215, v215, v62
    v_mul_f32 v216, v216, v62
    v_mul_f32 v217, v217, v62
    v_mul_f32 v218, v218, v62
    v_mul_f32 v219, v219, v62
    v_mul_f32 v220, v220, v62
    v_mul_f32 v221, v221, v62
    v_mul_f32 v228, v228, v64
    v_mul_f32 v229, v229, v64
    v_mul_f32 v230, v230, v64
    v_mul_f32 v231, v231, v64
    v_mul_f32 v232, v232, v64
    v_mul_f32 v233, v233, v64
    v_mul_f32 v234, v234, v64
    v_mul_f32 v235, v235, v64
    v_mul_f32 v236, v236, v64
    v_mul_f32 v237, v237, v64
    v_cvt_pk_bf16_f32 v124, v220, v221
    v_cvt_pk_bf16_f32 v126, v236, v237
    v_cvt_pk_bf16_f32 v116, v212, v213
    v_cvt_pk_bf16_f32 v117, v214, v215
    v_cvt_pk_bf16_f32 v118, v216, v217
    v_cvt_pk_bf16_f32 v119, v218, v219
    v_cvt_pk_bf16_f32 v120, v228, v229
    v_cvt_pk_bf16_f32 v121, v230, v231
    v_cvt_pk_bf16_f32 v122, v232, v233
    v_cvt_pk_bf16_f32 v123, v234, v235
    v_permlane32_swap_b32 v124, v125
    v_permlane32_swap_b32 v126, v127
    buffer_store_dwordx4 v[116:119], v253, s[52:55], s69 offen sc1
    buffer_store_dwordx4 v[120:123], v253, s[52:55], s69 offen offset:512 sc1
    s_mov_b32 exec_hi, 0
    buffer_store_dwordx4 v[124:127], v252, s[52:55], s71 offen sc1
    s_mov_b64 exec, -1
    s_cmp_lg_u32 s39, 0
    s_cbranch_scc1 L_att_redo_done
    v_mov_b32 v6, 161808
    s_mov_b32 s95, 0x400000
L_spin44:
    ds_read_b32 v7, v6
    s_waitcnt lgkmcnt(0)
    v_readfirstlane_b32 s94, v7
    s_nop 0
    s_and_b32 s93, s94, 255
    s_cmp_ge_u32 s93, 4
    s_cbranch_scc1 L_spun44
    s_sub_u32 s95, s95, 1
    s_cbranch_scc0 L_spin44
L_spun44:
    s_lshr_b32 s94, s94, 8
    s_cbranch_scc0 L_att_done
    s_waitcnt vmcnt(0)
    v_lshlrev_b32 v2, 4, v0
    v_and_b32 v6, 31, v0
    v_lshrrev_b32 v7, 5, v0
    v_and_b32 v3, 15, v0
    v_lshlrev_b32 v3, 2, v3
    v_lshl_add_u32 v3, v7, 6, v3
    v_bfe_u32 v4, v0, 4, 1
    v_lshl_add_u32 v3, v4, 7, v3
    v_lshlrev_b32 v4, 8, v7
    v_lshlrev_b32 v7, 6, v7
    v_add_u32 v7, 256, v7
    v_cmp_lt_u32 vcc, 15, v6
    s_nop 1
    v_cndmask_b32 v4, v4, v7, vcc
    v_lshl_add_u32 v4, v6, 4, v4
    v_subrev_u32 v7, 32, v4
    v_cmp_lt_u32 vcc, 19, v6
    s_nop 1
    v_cndmask_b32 v4, v4, v7, vcc
    v_and_b32 v6, 27, v0
    v_cmp_eq_u32 vcc, 18, v6
    v_mov_b32 v6, 0
    v_mov_b32 v7, 0x3f803f80
    v_cndmask_b32 v6, v6, v7, vcc
    v_mov_b32 v7, v6
    v_mov_b32 v93, 0x3f803f80
    v_mov_b64 v[94:95], v[6:7]
    v_mov_b64 v[96:97], v[6:7]
    v_mov_b64 v[98:99], v[6:7]
    v_mov_b64 v[100:101], v[6:7]
    v_mov_b32 v116, 0xff800000
    v_mov_b32 v13, 0
    v_mov_b32 v117, 0xff800000
    v_mov_b32 v19, 0
    v_mov_b32 v118, 0xff800000
    v_mov_b32 v25, 0
    v_mov_b32 v119, 0xff800000
    v_mov_b32 v31, 0
    v_mov_b32 v120, 0xff800000
    v_mov_b32 v37, 0
    v_mov_b32 v121, 0xff800000
    v_mov_b32 v43, 0
    v_mov_b32 v122, 0xff800000
    v_mov_b32 v49, 0
    v_mov_b32 v123, 0xff800000
    v_mov_b32 v55, 0
    s_mov_b32 s64, 0
    s_mov_b32 s39, 1
L_slow_loop:
    buffer_load_dwordx4 v[88:91], v2, s[40:43], s64 offen sc1
    buffer_load_dword v92, v3, s[40:43], s64 offen offset:1024 sc1
    s_mov_b64 exec, s[90:91]
    buffer_load_dwordx4 v[94:97], v4, s[40:43], s64 offen offset:1280 sc1
    buffer_load_dwordx4 v[98:101], v4, s[40:43], s64 offen offset:1920 sc1
    s_mov_b64 exec, -1
    s_waitcnt vmcnt(0)
    v_mfma_f32_32x32x8_bf16 v[56:71], v[92:93], v[12:13], 0
    v_mfma_f32_32x32x16_bf16 v[56:71], v[88:91], v[8:11], v[56:71]
    s_nop 15
    v_max3_f32 v116, v116, v56, v57
    v_max3_f32 v116, v116, v58, v59
    v_max3_f32 v116, v116, v60, v61
    v_max3_f32 v116, v116, v62, v63
    v_max3_f32 v116, v116, v64, v65
    v_max3_f32 v116, v116, v66, v67
    v_max3_f32 v116, v116, v68, v69
    v_max3_f32 v116, v116, v70, v71
    v_mfma_f32_32x32x8_bf16 v[56:71], v[92:93], v[18:19], 0
    v_mfma_f32_32x32x16_bf16 v[56:71], v[88:91], v[14:17], v[56:71]
    s_nop 15
    v_max3_f32 v117, v117, v56, v57
    v_max3_f32 v117, v117, v58, v59
    v_max3_f32 v117, v117, v60, v61
    v_max3_f32 v117, v117, v62, v63
    v_max3_f32 v117, v117, v64, v65
    v_max3_f32 v117, v117, v66, v67
    v_max3_f32 v117, v117, v68, v69
    v_max3_f32 v117, v117, v70, v71
    v_mfma_f32_32x32x8_bf16 v[56:71], v[92:93], v[24:25], 0
    v_mfma_f32_32x32x16_bf16 v[56:71], v[88:91], v[20:23], v[56:71]
    s_nop 15
    v_max3_f32 v118, v118, v56, v57
    v_max3_f32 v118, v118, v58, v59
    v_max3_f32 v118, v118, v60, v61
    v_max3_f32 v118, v118, v62, v63
    v_max3_f32 v118, v118, v64, v65
    v_max3_f32 v118, v118, v66, v67
    v_max3_f32 v118, v118, v68, v69
    v_max3_f32 v118, v118, v70, v71
    v_mfma_f32_32x32x8_bf16 v[56:71], v[92:93], v[30:31], 0
    v_mfma_f32_32x32x16_bf16 v[56:71], v[88:91], v[26:29], v[56:71]
    s_nop 15
    v_max3_f32 v119, v119, v56, v57
    v_max3_f32 v119, v119, v58, v59
    v_max3_f32 v119, v119, v60, v61
    v_max3_f32 v119, v119, v62, v63
    v_max3_f32 v119, v119, v64, v65
    v_max3_f32 v119, v119, v66, v67
    v_max3_f32 v119, v119, v68, v69
    v_max3_f32 v119, v119, v70, v71
    v_mfma_f32_32x32x8_bf16 v[56:71], v[92:93], v[36:37], 0
    v_mfma_f32_32x32x16_bf16 v[56:71], v[88:91], v[32:35], v[56:71]
    s_nop 15
    v_max3_f32 v120, v120, v56, v57
    v_max3_f32 v120, v120, v58, v59
    v_max3_f32 v120, v120, v60, v61
    v_max3_f32 v120, v120, v62, v63
    v_max3_f32 v120, v120, v64, v65
    v_max3_f32 v120, v120, v66, v67
    v_max3_f32 v120, v120, v68, v69
    v_max3_f32 v120, v120, v70, v71
    v_mfma_f32_32x32x8_bf16 v[56:71], v[92:93], v[42:43], 0
    v_mfma_f32_32x32x16_bf16 v[56:71], v[88:91], v[38:41], v[56:71]
    s_nop 15
    v_max3_f32 v121, v121, v56, v57
    v_max3_f32 v121, v121, v58, v59
    v_max3_f32 v121, v121, v60, v61
    v_max3_f32 v121, v121, v62, v63
    v_max3_f32 v121, v121, v64, v65
    v_max3_f32 v121, v121, v66, v67
    v_max3_f32 v121, v121, v68, v69
    v_max3_f32 v121, v121, v70, v71
    v_mfma_f32_32x32x8_bf16 v[56:71], v[92:93], v[48:49], 0
    v_mfma_f32_32x32x16_bf16 v[56:71], v[88:91], v[44:47], v[56:71]
    s_nop 15
    v_max3_f32 v122, v122, v56, v57
    v_max3_f32 v122, v122, v58, v59
    v_max3_f32 v122, v122, v60, v61
    v_max3_f32 v122, v122, v62, v63
    v_max3_f32 v122, v122, v64, v65
    v_max3_f32 v122, v122, v66, v67
    v_max3_f32 v122, v122, v68, v69
    v_max3_f32 v122, v122, v70, v71
    v_mfma_f32_32x32x8_bf16 v[56:71], v[92:93], v[54:55], 0
    v_mfma_f32_32x32x16_bf16 v[56:71], v[88:91], v[50:53], v[56:71]
    s_nop 15
    v_max3_f32 v123, v123, v56, v57
    v_max3_f32 v123, v123, v58, v59
    v_max3_f32 v123, v123, v60, v61
    v_max3_f32 v123, v123, v62, v63
    v_max3_f32 v123, v123, v64, v65
    v_max3_f32 v123, v123, v66, v67
    v_max3_f32 v123, v123, v68, v69
    v_max3_f32 v123, v123, v70, v71
    s_add_u32 s64, s64, 2560
    s_cmp_lt_u32 s64, 40960
    s_cbranch_scc1 L_slow_loop
    v_lshlrev_b32 v56, 2, v0
    s_lshl_b32 s36, s32, 11
    s_add_u32 s36, s36, 61440
    v_add_u32 v56, s36, v56
    s_xor_b32 s36, s37, 0
    s_lshl_b32 s36, s36, 8
    v_add_u32 v57, s36, v56
    ds_write_b32 v57, v116
    s_xor_b32 s36, s37, 1
    s_lshl_b32 s36, s36, 8
    v_add_u32 v57, s36, v56
    ds_write_b32 v57, v117
    s_xor_b32 s36, s37, 2
    s_lshl_b32 s36, s36, 8
    v_add_u32 v57, s36, v56
    ds_write_b32 v57, v118
    s_xor_b32 s36, s37, 3
    s_lshl_b32 s36, s36, 8
    v_add_u32 v57, s36, v56
    ds_write_b32 v57, v119
    s_xor_b32 s36, s37, 4
    s_lshl_b32 s36, s36, 8
    v_add_u32 v57, s36, v56
    ds_write_b32 v57, v120
    s_xor_b32 s36, s37, 5
    s_lshl_b32 s36, s36, 8
    v_add_u32 v57, s36, v56
    ds_write_b32 v57, v121
    s_xor_b32 s36, s37, 6
    s_lshl_b32 s36, s36, 8
    v_add_u32 v57, s36, v56
    ds_write_b32 v57, v122
    s_xor_b32 s36, s37, 7
    s_lshl_b32 s36, s36, 8
    v_add_u32 v57, s36, v56
    ds_write_b32 v57, v123
    v_mov_b32 v6, 161804
    v_mov_b32 v7, 1
    s_waitcnt lgkmcnt(0)
    s_mov_b64 exec, 1
    ds_add_u32 v6, v7
    s_mov_b64 exec, -1
    v_mov_b32 v6, 161804
    s_mov_b32 s95, 0x400000
L_spin45:
    ds_read_b32 v7, v6
    s_waitcnt lgkmcnt(0)
    v_readfirstlane_b32 s94, v7
    s_nop 0
    s_cmp_ge_u32 s94, 8
    s_cbranch_scc1 L_spun45
    s_sub_u32 s95, s95, 1
    s_cbranch_scc0 L_spin45
L_spun45:
    v_and_b32 v56, 31, v0
    v_lshlrev_b32 v56, 2, v56
    v_add_u32 v56, 61440, v56
    s_xor_b32 s36, s37, 0
    s_lshl_b32 s36, s36, 8
    v_add_u32 v57, s36, v56
    ds_read2_b32 v[58:59], v57 offset0:0 offset1:32
    v_add_u32 v57, 2048, v57
    ds_read2_b32 v[60:61], v57 offset0:0 offset1:32
    v_add_u32 v57, 2048, v57
    ds_read2_b32 v[62:63], v57 offset0:0 offset1:32
    v_add_u32 v57, 2048, v57
    ds_read2_b32 v[64:65], v57 offset0:0 offset1:32
    v_add_u32 v57, 2048, v57
    s_waitcnt lgkmcnt(0)
    v_max3_f32 v116, v116, v58, v59
    v_max3_f32 v116, v116, v60, v61
    v_max3_f32 v116, v116, v62, v63
    v_max3_f32 v116, v116, v64, v65
    v_sub_f32 v116, 0, v116
    v_and_b32 v58, 0xffff0000, v116
    v_sub_f32 v116, v116, v58
    v_and_b32 v59, 0xffff0000, v116
    v_sub_f32 v116, v116, v59
    v_lshrrev_b32 v58, 16, v58
    v_or_b32 v58, v58, v59
    v_lshrrev_b32 v116, 16, v116
    v_mov_b32 v13, v58
    s_mov_b32 exec_lo, 0
    v_mov_b32 v13, v116
    s_mov_b32 exec_lo, -1
    s_xor_b32 s36, s37, 1
    s_lshl_b32 s36, s36, 8
    v_add_u32 v57, s36, v56
    ds_read2_b32 v[58:59], v57 offset0:0 offset1:32
    v_add_u32 v57, 2048, v57
    ds_read2_b32 v[60:61], v57 offset0:0 offset1:32
    v_add_u32 v57, 2048, v57
    ds_read2_b32 v[62:63], v57 offset0:0 offset1:32
    v_add_u32 v57, 2048, v57
    ds_read2_b32 v[64:65], v57 offset0:0 offset1:32
    v_add_u32 v57, 2048, v57
    s_waitcnt lgkmcnt(0)
    v_max3_f32 v117, v117, v58, v59
    v_max3_f32 v117, v117, v60, v61
    v_max3_f32 v117, v117, v62, v63
    v_max3_f32 v117, v117, v64, v65
    v_sub_f32 v117, 0, v117
    v_and_b32 v58, 0xffff0000, v117
    v_sub_f32 v117, v117, v58
    v_and_b32 v59, 0xffff0000, v117
    v_sub_f32 v117, v117, v59
    v_lshrrev_b32 v58, 16, v58
    v_or_b32 v58, v58, v59
    v_lshrrev_b32 v117, 16, v117
    v_mov_b32 v19, v58
    s_mov_b32 exec_lo, 0
    v_mov_b32 v19, v117
    s_mov_b32 exec_lo, -1
    s_xor_b32 s36, s37, 2
    s_lshl_b32 s36, s36, 8
    v_add_u32 v57, s36, v56
    ds_read2_b32 v[58:59], v57 offset0:0 offset1:32
    v_add_u32 v57, 2048, v57
    ds_read2_b32 v[60:61], v57 offset0:0 offset1:32
    v_add_u32 v57, 2048, v57
    ds_read2_b32 v[62:63], v57 offset0:0 offset1:32
    v_add_u32 v57, 2048, v57
    ds_read2_b32 v[64:65], v57 offset0:0 offset1:32
    v_add_u32 v57, 2048, v57
    s_waitcnt lgkmcnt(0)
    v_max3_f32 v118, v118, v58, v59
    v_max3_f32 v118, v118, v60, v61
    v_max3_f32 v118, v118, v62, v63
    v_max3_f32 v118, v118, v64, v65
    v_sub_f32 v118, 0, v118
    v_and_b32 v58, 0xffff0000, v118
    v_sub_f32 v118, v118, v58
    v_and_b32 v59, 0xffff0000, v118
    v_sub_f32 v118, v118, v59
    v_lshrrev_b32 v58, 16, v58
    v_or_b32 v58, v58, v59
    v_lshrrev_b32 v118, 16, v118
    v_mov_b32 v25, v58
    s_mov_b32 exec_lo, 0
    v_mov_b32 v25, v118
    s_mov_b32 exec_lo, -1
    s_xor_b32 s36, s37, 3
    s_lshl_b32 s36, s36, 8
    v_add_u32 v57, s36, v56
    ds_read2_b32 v[58:59], v57 offset0:0 offset1:32
    v_add_u32 v57, 2048, v57
    ds_read2_b32 v[60:61], v57 offset0:0 offset1:32
    v_add_u32 v57, 2048, v57
    ds_read2_b32 v[62:63], v57 offset0:0 offset1:32
    v_add_u32 v57, 2048, v57
    ds_read2_b32 v[64:65], v57 offset0:0 offset1:32
    v_add_u32 v57, 2048, v57
    s_waitcnt lgkmcnt(0)
    v_max3_f32 v119, v119, v58, v59
    v_max3_f32 v119, v119, v60, v61
    v_max3_f32 v119, v119, v62, v63
    v_max3_f32 v119, v119, v64, v65
    v_sub_f32 v119, 0, v119
    v_and_b32 v58, 0xffff0000, v119
    v_sub_f32 v119, v119, v58
    v_and_b32 v59, 0xffff0000, v119
    v_sub_f32 v119, v119, v59
    v_lshrrev_b32 v58, 16, v58
    v_or_b32 v58, v58, v59
    v_lshrrev_b32 v119, 16, v119
    v_mov_b32 v31, v58
    s_mov_b32 exec_lo, 0
    v_mov_b32 v31, v119
    s_mov_b32 exec_lo, -1
    s_xor_b32 s36, s37, 4
    s_lshl_b32 s36, s36, 8
    v_add_u32 v57, s36, v56
    ds_read2_b32 v[58:59], v57 offset0:0 offset1:32
    v_add_u32 v57, 2048, v57
    ds_read2_b32 v[60:61], v57 offset0:0 offset1:32
    v_add_u32 v57, 2048, v57
    ds_read2_b32 v[62:63], v57 offset0:0 offset1:32
    v_add_u32 v57, 2048, v57
    ds_read2_b32 v[64:65], v57 offset0:0 offset1:32
    v_add_u32 v57, 2048, v57
    s_waitcnt lgkmcnt(0)
    v_max3_f32 v120, v120, v58, v59
    v_max3_f32 v120, v120, v60, v61
    v_max3_f32 v120, v120, v62, v63
    v_max3_f32 v120, v120, v64, v65
    v_sub_f32 v120, 0, v120
    v_and_b32 v58, 0xffff0000, v120
    v_sub_f32 v120, v120, v58
    v_and_b32 v59, 0xffff0000, v120
    v_sub_f32 v120, v120, v59
    v_lshrrev_b32 v58, 16, v58
    v_or_b32 v58, v58, v59
    v_lshrrev_b32 v120, 16, v120
    v_mov_b32 v37, v58
    s_mov_b32 exec_lo, 0
    v_mov_b32 v37, v120
    s_mov_b32 exec_lo, -1
    s_xor_b32 s36, s37, 5
    s_lshl_b32 s36, s36, 8
    v_add_u32 v57, s36, v56
    ds_read2_b32 v[58:59], v57 offset0:0 offset1:32
    v_add_u32 v57, 2048, v57
    ds_read2_b32 v[60:61], v57 offset0:0 offset1:32
    v_add_u32 v57, 2048, v57
    ds_read2_b32 v[62:63], v57 offset0:0 offset1:32
    v_add_u32 v57, 2048, v57
    ds_read2_b32 v[64:65], v57 offset0:0 offset1:32
    v_add_u32 v57, 2048, v57
    s_waitcnt lgkmcnt(0)
    v_max3_f32 v121, v121, v58, v59
    v_max3_f32 v121, v121, v60, v61
    v_max3_f32 v121, v121, v62, v63
    v_max3_f32 v121, v121, v64, v65
    v_sub_f32 v121, 0, v121
    v_and_b32 v58, 0xffff0000, v121
    v_sub_f32 v121, v121, v58
    v_and_b32 v59, 0xffff0000, v121
    v_sub_f32 v121, v121, v59
    v_lshrrev_b32 v58, 16, v58
    v_or_b32 v58, v58, v59
    v_lshrrev_b32 v121, 16, v121
    v_mov_b32 v43, v58
    s_mov_b32 exec_lo, 0
    v_mov_b32 v43, v121
    s_mov_b32 exec_lo, -1
    s_xor_b32 s36, s37, 6
    s_lshl_b32 s36, s36, 8
    v_add_u32 v57, s36, v56
    ds_read2_b32 v[58:59], v57 offset0:0 offset1:32
    v_add_u32 v57, 2048, v57
    ds_read2_b32 v[60:61], v57 offset0:0 offset1:32
    v_add_u32 v57, 2048, v57
    ds_read2_b32 v[62:63], v57 offset0:0 offset1:32
    v_add_u32 v57, 2048, v57
    ds_read2_b32 v[64:65], v57 offset0:0 offset1:32
    v_add_u32 v57, 2048, v57
    s_waitcnt lgkmcnt(0)
    v_max3_f32 v122, v122, v58, v59
    v_max3_f32 v122, v122, v60, v61
    v_max3_f32 v122, v122, v62, v63
    v_max3_f32 v122, v122, v64, v65
    v_sub_f32 v122, 0, v122
    v_and_b32 v58, 0xffff0000, v122
    v_sub_f32 v122, v122, v58
    v_and_b32 v59, 0xffff0000, v122
    v_sub_f32 v122, v122, v59
    v_lshrrev_b32 v58, 16, v58
    v_or_b32 v58, v58, v59
    v_lshrrev_b32 v122, 16, v122
    v_mov_b32 v49, v58
    s_mov_b32 exec_lo, 0
    v_mov_b32 v49, v122
    s_mov_b32 exec_lo, -1
    s_xor_b32 s36, s37, 7
    s_lshl_b32 s36, s36, 8
    v_add_u32 v57, s36, v56
    ds_read2_b32 v[58:59], v57 offset0:0 offset1:32
    v_add_u32 v57, 2048, v57
    ds_read2_b32 v[60:61], v57 offset0:0 offset1:32
    v_add_u32 v57, 2048, v57
    ds_read2_b32 v[62:63], v57 offset0:0 offset1:32
    v_add_u32 v57, 2048, v57
    ds_read2_b32 v[64:65], v57 offset0:0 offset1:32
    v_add_u32 v57, 2048, v57
    s_waitcnt lgkmcnt(0)
    v_max3_f32 v123, v123, v58, v59
    v_max3_f32 v123, v123, v60, v61
    v_max3_f32 v123, v123, v62, v63
    v_max3_f32 v123, v123, v64, v65
    v_sub_f32 v123, 0, v123
    v_and_b32 v58, 0xffff0000, v123
    v_sub_f32 v123, v123, v58
    v_and_b32 v59, 0xffff0000, v123
    v_sub_f32 v123, v123, v59
    v_lshrrev_b32 v58, 16, v58
    v_or_b32 v58, v58, v59
    v_lshrrev_b32 v123, 16, v123
    v_mov_b32 v55, v58
    s_mov_b32 exec_lo, 0
    v_mov_b32 v55, v123
    s_mov_b32 exec_lo, -1
    v_mov_b32 v6, 161804
    v_mov_b32 v7, 1
    s_waitcnt lgkmcnt(0)
    s_mov_b64 exec, 1
    ds_add_u32 v6, v7
    s_mov_b64 exec, -1
    v_mov_b32 v6, 161804
    s_mov_b32 s95, 0x400000
L_spin46:
    ds_read_b32 v7, v6
    s_waitcnt lgkmcnt(0)
    v_readfirstlane_b32 s94, v7
    s_nop 0
    s_cmp_ge_u32 s94, 12
    s_cbranch_scc1 L_spun46
    s_sub_u32 s95, s95, 1
    s_cbranch_scc0 L_spin46
L_spun46:
    v_mov_b64 v[116:117], 0
    v_mov_b64 v[118:119], 0
    v_mov_b64 v[120:121], 0
    v_mov_b64 v[122:123], 0
    v_mov_b64 v[124:125], 0
    v_mov_b64 v[126:127], 0
    v_mov_b64 v[128:129], 0
    v_mov_b64 v[130:131], 0
    v_mov_b64 v[132:133], 0
    v_mov_b64 v[134:135], 0
    v_mov_b64 v[136:137], 0
    v_mov_b64 v[138:139], 0
    v_mov_b64 v[140:141], 0
    v_mov_b64 v[142:143], 0
    v_mov_b64 v[144:145], 0
    v_mov_b64 v[146:147], 0
    v_mov_b64 v[148:149], 0
    v_mov_b64 v[150:151], 0
    v_mov_b64 v[152:153], 0
    v_mov_b64 v[154:155], 0
    v_mov_b64 v[156:157], 0
    v_mov_b64 v[158:159], 0
    v_mov_b64 v[160:161], 0
    v_mov_b64 v[162:163], 0
    v_mov_b64 v[164:165], 0
    v_mov_b64 v[166:167], 0
    v_mov_b64 v[168:169], 0
    v_mov_b64 v[170:171], 0
    v_mov_b64 v[172:173], 0
    v_mov_b64 v[174:175], 0
    v_mov_b64 v[176:177], 0
    v_mov_b64 v[178:179], 0
    v_mov_b64 v[180:181], 0
    v_mov_b64 v[182:183], 0
    v_mov_b64 v[184:185], 0
    v_mov_b64 v[186:187], 0
    v_mov_b64 v[188:189], 0
    v_mov_b64 v[190:191], 0
    v_mov_b64 v[192:193], 0
    v_mov_b64 v[194:195], 0
    v_mov_b64 v[196:197], 0
    v_mov_b64 v[198:199], 0
    v_mov_b64 v[200:201], 0
    v_mov_b64 v[202:203], 0
    v_mov_b64 v[204:205], 0
    v_mov_b64 v[206:207], 0
    v_mov_b64 v[208:209], 0
    v_mov_b64 v[210:211], 0
    v_mov_b64 v[212:213], 0
    v_mov_b64 v[214:215], 0
    v_mov_b64 v[216:217], 0
    v_mov_b64 v[218:219], 0
    v_mov_b64 v[220:221], 0
    v_mov_b64 v[222:223], 0
    v_mov_b64 v[224:225], 0
    v_mov_b64 v[226:227], 0
    v_mov_b64 v[228:229], 0
    v_mov_b64 v[230:231], 0
    v_mov_b64 v[232:233], 0
    v_mov_b64 v[234:235], 0
    v_mov_b64 v[236:237], 0
    v_mov_b64 v[238:239], 0
    v_mov_b64 v[240:241], 0
    v_mov_b64 v[242:243], 0
    s_mov_b32 s64, 0
L_redo_loop:
    buffer_load_dwordx4 v[88:91], v2, s[40:43], s64 offen sc1
    buffer_load_dword v92, v3, s[40:43], s64 offen offset:1024 sc1
    s_mov_b64 exec, s[90:91]
    buffer_load_dwordx4 v[94:97], v4, s[40:43], s64 offen offset:1280 sc1
    buffer_load_dwordx4 v[98:101], v4, s[40:43], s64 offen offset:1920 sc1
    s_mov_b64 exec, -1
    s_waitcnt vmcnt(0)
    v_mfma_f32_32x32x8_bf16 v[56:71], v[92:93], v[12:13], 0
    v_mfma_f32_32x32x16_bf16 v[56:71], v[88:91], v[8:11], v[56:71]
    s_nop 15
    v_exp_f32 v56, v56
    v_exp_f32 v57, v57
    v_exp_f32 v58, v58
    v_exp_f32 v59, v59
    v_exp_f32 v60, v60
    v_exp_f32 v61, v61
    v_exp_f32 v62, v62
    v_exp_f32 v63, v63
    v_exp_f32 v64, v64
    v_exp_f32 v65, v65
    v_exp_f32 v66, v66
    v_exp_f32 v67, v67
    v_exp_f32 v68, v68
    v_exp_f32 v69, v69
    v_exp_f32 v70, v70
    v_exp_f32 v71, v71
    s_nop 1
    v_smfmac_f32_32x32x32_bf16 v[116:131], v[94:97], v[56:63], v1
    v_smfmac_f32_32x32x32_bf16 v[116:131], v[98:101], v[64:71], v1
    v_mfma_f32_32x32x8_bf16 v[56:71], v[92:93], v[18:19], 0
    v_mfma_f32_32x32x16_bf16 v[56:71], v[88:91], v[14:17], v[56:71]
    s_nop 15
    v_exp_f32 v56, v56
    v_exp_f32 v57, v57
    v_exp_f32 v58, v58
    v_exp_f32 v59, v59
    v_exp_f32 v60, v60
    v_exp_f32 v61, v61
    v_exp_f32 v62, v62
    v_exp_f32 v63, v63
    v_exp_f32 v64, v64
    v_exp_f32 v65, v65
    v_exp_f32 v66, v66
    v_exp_f32 v67, v67
    v_exp_f32 v68, v68
    v_exp_f32 v69, v69
    v_exp_f32 v70, v70
    v_exp_f32 v71, v71
    s_nop 1
    v_smfmac_f32_32x32x32_bf16 v[132:147], v[94:97], v[56:63], v1
    v_smfmac_f32_32x32x32_bf16 v[132:147], v[98:101], v[64:71], v1
    v_mfma_f32_32x32x8_bf16 v[56:71], v[92:93], v[24:25], 0
    v_mfma_f32_32x32x16_bf16 v[56:71], v[88:91], v[20:23], v[56:71]
    s_nop 15
    v_exp_f32 v56, v56
    v_exp_f32 v57, v57
    v_exp_f32 v58, v58
    v_exp_f32 v59, v59
    v_exp_f32 v60, v60
    v_exp_f32 v61, v61
    v_exp_f32 v62, v62
    v_exp_f32 v63, v63
    v_exp_f32 v64, v64
    v_exp_f32 v65, v65
    v_exp_f32 v66, v66
    v_exp_f32 v67, v67
    v_exp_f32 v68, v68
    v_exp_f32 v69, v69
    v_exp_f32 v70, v70
    v_exp_f32 v71, v71
    s_nop 1
    v_smfmac_f32_32x32x32_bf16 v[148:163], v[94:97], v[56:63], v1
    v_smfmac_f32_32x32x32_bf16 v[148:163], v[98:101], v[64:71], v1
    v_mfma_f32_32x32x8_bf16 v[56:71], v[92:93], v[30:31], 0
    v_mfma_f32_32x32x16_bf16 v[56:71], v[88:91], v[26:29], v[56:71]
    s_nop 15
    v_exp_f32 v56, v56
    v_exp_f32 v57, v57
    v_exp_f32 v58, v58
    v_exp_f32 v59, v59
    v_exp_f32 v60, v60
    v_exp_f32 v61, v61
    v_exp_f32 v62, v62
    v_exp_f32 v63, v63
    v_exp_f32 v64, v64
    v_exp_f32 v65, v65
    v_exp_f32 v66, v66
    v_exp_f32 v67, v67
    v_exp_f32 v68, v68
    v_exp_f32 v69, v69
    v_exp_f32 v70, v70
    v_exp_f32 v71, v71
    s_nop 1
    v_smfmac_f32_32x32x32_bf16 v[164:179], v[94:97], v[56:63], v1
    v_smfmac_f32_32x32x32_bf16 v[164:179], v[98:101], v[64:71], v1
    v_mfma_f32_32x32x8_bf16 v[56:71], v[92:93], v[36:37], 0
    v_mfma_f32_32x32x16_bf16 v[56:71], v[88:91], v[32:35], v[56:71]
    s_nop 15
    v_exp_f32 v56, v56
    v_exp_f32 v57, v57
    v_exp_f32 v58, v58
    v_exp_f32 v59, v59
    v_exp_f32 v60, v60
    v_exp_f32 v61, v61
    v_exp_f32 v62, v62
    v_exp_f32 v63, v63
    v_exp_f32 v64, v64
    v_exp_f32 v65, v65
    v_exp_f32 v66, v66
    v_exp_f32 v67, v67
    v_exp_f32 v68, v68
    v_exp_f32 v69, v69
    v_exp_f32 v70, v70
    v_exp_f32 v71, v71
    s_nop 1
    v_smfmac_f32_32x32x32_bf16 v[180:195], v[94:97], v[56:63], v1
    v_smfmac_f32_32x32x32_bf16 v[180:195], v[98:101], v[64:71], v1
    v_mfma_f32_32x32x8_bf16 v[56:71], v[92:93], v[42:43], 0
    v_mfma_f32_32x32x16_bf16 v[56:71], v[88:91], v[38:41], v[56:71]
    s_nop 15
    v_exp_f32 v56, v56
    v_exp_f32 v57, v57
    v_exp_f32 v58, v58
    v_exp_f32 v59, v59
    v_exp_f32 v60, v60
    v_exp_f32 v61, v61
    v_exp_f32 v62, v62
    v_exp_f32 v63, v63
    v_exp_f32 v64, v64
    v_exp_f32 v65, v65
    v_exp_f32 v66, v66
    v_exp_f32 v67, v67
    v_exp_f32 v68, v68
    v_exp_f32 v69, v69
    v_exp_f32 v70, v70
    v_exp_f32 v71, v71
    s_nop 1
    v_smfmac_f32_32x32x32_bf16 v[196:211], v[94:97], v[56:63], v1
    v_smfmac_f32_32x32x32_bf16 v[196:211], v[98:101], v[64:71], v1
    v_mfma_f32_32x32x8_bf16 v[56:71], v[92:93], v[48:49], 0
    v_mfma_f32_32x32x16_bf16 v[56:71], v[88:91], v[44:47], v[56:71]
    s_nop 15
    v_exp_f32 v56, v56
    v_exp_f32 v57, v57
    v_exp_f32 v58, v58
    v_exp_f32 v59, v59
    v_exp_f32 v60, v60
    v_exp_f32 v61, v61
    v_exp_f32 v62, v62
    v_exp_f32 v63, v63
    v_exp_f32 v64, v64
    v_exp_f32 v65, v65
    v_exp_f32 v66, v66
    v_exp_f32 v67, v67
    v_exp_f32 v68, v68
    v_exp_f32 v69, v69
    v_exp_f32 v70, v70
    v_exp_f32 v71, v71
    s_nop 1
    v_smfmac_f32_32x32x32_bf16 v[212:227], v[94:97], v[56:63], v1
    v_smfmac_f32_32x32x32_bf16 v[212:227], v[98:101], v[64:71], v1
    v_mfma_f32_32x32x8_bf16 v[56:71], v[92:93], v[54:55], 0
    v_mfma_f32_32x32x16_bf16 v[56:71], v[88:91], v[50:53], v[56:71]
    s_nop 15
    v_exp_f32 v56, v56
    v_exp_f32 v57, v57
    v_exp_f32 v58, v58
    v_exp_f32 v59, v59
    v_exp_f32 v60, v60
    v_exp_f32 v61, v61
    v_exp_f32 v62, v62
    v_exp_f32 v63, v63
    v_exp_f32 v64, v64
    v_exp_f32 v65, v65
    v_exp_f32 v66, v66
    v_exp_f32 v67, v67
    v_exp_f32 v68, v68
    v_exp_f32 v69, v69
    v_exp_f32 v70, v70
    v_exp_f32 v71, v71
    s_nop 1
    v_smfmac_f32_32x32x32_bf16 v[228:243], v[94:97], v[56:63], v1
    v_smfmac_f32_32x32x32_bf16 v[228:243], v[98:101], v[64:71], v1
    s_nop 15
    s_add_u32 s64, s64, 2560
    s_cmp_lt_u32 s64, 40960
    s_cbranch_scc1 L_redo_loop
    s_mul_i32 s36, s32, 5120
    s_add_u32 s36, s36, 61440
    v_add_u32 v6, s36, v2
    ds_write_b128 v6, v[116:119] offset:0
    ds_write_b128 v6, v[120:123] offset:1024
    ds_write_b128 v6, v[124:127] offset:2048
    ds_write_b128 v6, v[132:135] offset:3072
    ds_write_b128 v6, v[136:139] offset:4096
    ds_write_b128 v6, v[140:143] offset:20480
    ds_write_b128 v6, v[148:151] offset:21504
    ds_write_b128 v6, v[152:155] offset:22528
    ds_write_b128 v6, v[156:159] offset:23552
    ds_write_b128 v6, v[164:167] offset:24576
    ds_write_b128 v6, v[168:171] offset:40960
    ds_write_b128 v6, v[172:175] offset:41984
    ds_write_b128 v6, v[180:183] offset:43008
    ds_write_b128 v6, v[184:187] offset:44032
    ds_write_b128 v6, v[188:191] offset:45056
    ds_write_b128 v6, v[196:199] offset:61440
    ds_write_b128 v6, v[200:203] offset:62464
    ds_write_b128 v6, v[204:207] offset:63488
    v_mov_b32 v6, 161804
    v_mov_b32 v7, 1
    s_waitcnt lgkmcnt(0)
    s_mov_b64 exec, 1
    ds_add_u32 v6, v7
    s_mov_b64 exec, -1
    s_mov_b32 s70, 16
    s_branch L_att_red
L_att_redo_done:
L_att_done:
    v_mov_b32 v6, 161832
    v_mov_b32 v7, 1
    s_waitcnt vmcnt(0) lgkmcnt(0)
    s_mov_b64 exec, 1
    ds_add_rtn_u32 v7, v6, v7
    s_waitcnt lgkmcnt(0)
    v_readfirstlane_b32 s94, v7
    s_mov_b64 exec, -1
    s_cmp_eq_u32 s94, 3
    s_cbranch_scc0 L_j3
    v_mov_b32 v6, 0
    v_mov_b32 v7, s3
    s_waitcnt vmcnt(0)
    s_mov_b64 exec, 1
    buffer_store_dword v7, v6, s[72:75], s77 offen sc1
    s_mov_b64 exec, -1
    s_and_b32 s77, s77, 0xfffffc00
    v_and_b32 v6, 7, v0
    v_lshlrev_b32 v6, 7, v6
    s_mov_b32 s95, 0x20000
L_poll47:
    buffer_load_dword v7, v6, s[72:75], s77 offen sc1
L_pollw47:
    s_waitcnt vmcnt(0)
    v_cmp_ne_u32 vcc, s3, v7
    s_nop 0
    s_cmp_eq_u64 vcc, 0
    s_cbranch_scc1 L_polled47
    s_sleep 1
    s_sub_u32 s95, s95, 1
    s_cbranch_scc0 L_poll47
L_polled47:
    v_mov_b32 v6, 161844
    ds_write_b32 v6, v6
L_j3:
    s_or_b32 s36, s2, s32
    s_cbranch_scc1 L_fin
    v_mov_b32 v1, 196608
    v_mov_b32 v2, s3
    s_mov_b64 exec, 1
    buffer_store_dword v2, v1, s[72:75], 0 offen
    s_mov_b64 exec, -1
L_fin:
    s_endpgm
L_end:
    s_endpgm
.section .rodata,"a"
.p2align 6
.amdhsa_kernel gated_mix__grouped_kv_mqa__mixer_token_mlp__prompt_kernel
  .amdhsa_next_free_vgpr 256
  .amdhsa_next_free_sgpr 102
  .amdhsa_accum_offset 256
  .amdhsa_group_segment_fixed_size 0
  .amdhsa_kernarg_size 112
  .amdhsa_user_sgpr_count 2
  .amdhsa_user_sgpr_kernarg_segment_ptr 1
  .amdhsa_system_sgpr_workgroup_id_x 1
.end_amdhsa_kernel
```
